```python
import torch

def _softmax(x, axis=-1):
    return torch.softmax(x, dim=axis)
def _gelu(x):
    return torch.nn.functional.gelu(x, approximate="tanh")
def _silu(x):
    return torch.nn.functional.silu(x)
def _sigmoid(x):
    return torch.sigmoid(x)
def _layernorm(x, axis=-1, eps=1e-5):
    m = x.mean(dim=axis, keepdim=True)
    v = x.var(dim=axis, keepdim=True, unbiased=False)
    return (x - m) / torch.sqrt(v + eps)
def _scatter_add(tgt, idx, src, axis=0):
    return tgt.clone().index_add_(axis, idx, src)
def _segment_sum(src, seg, n):
    out = torch.zeros((n,) + src.shape[1:], dtype=src.dtype)
    return out.index_add_(0, seg, src)
def _pad(x, pw):
    flat = tuple(v for pair in reversed(pw) for v in pair)
    return torch.nn.functional.pad(x, flat)

kernel_name = 'sequential_preLN__linear_attn_block__mixer_channel_mlp__prompt'

def setup_inputs():

    _w = (lambda a: (lambda t: t.to(torch.bfloat16) if t.is_floating_point() else t)(torch.as_tensor(a)))
    def _A_setup():
        B, S, D = 1, 2048, 640
        return {
            "x": _w((lambda *s: torch.randn(*s, dtype=torch.bfloat16) * 0.05)(B, S, D)),
            "wqkv": _w((lambda *s: torch.randn(*s, dtype=torch.bfloat16) * 0.05)(D, 3 * D)),
            "wo": _w((lambda *s: torch.randn(*s, dtype=torch.bfloat16) * 0.05)(D, D)),
        }
    _A_in = _A_setup()

    def _B_setup():
        B, S, D, F = 1, 2048, 640, 1536
        return {
            "x": _w((lambda *s: torch.randn(*s, dtype=torch.bfloat16) * 0.05)(B, S, D)),
            "w1": _w((lambda *s: torch.randn(*s, dtype=torch.bfloat16) * 1.6)(D, F) * (D ** -0.5)),
            "b1": _w((lambda *s: torch.randn(*s, dtype=torch.bfloat16) * 0.4)(F)),
            "w2": _w((lambda *s: torch.randn(*s, dtype=torch.bfloat16) * 0.05)(F, D) * (F ** -0.5)),
            "b2": _w((lambda *s: torch.randn(*s, dtype=torch.bfloat16) * 0.05)(D)),
        }
    _B_in = _B_setup()

    return {
        "A_x": _A_in["x"],
        "A_wqkv": _A_in["wqkv"],
        "A_wo": _A_in["wo"],
        "B_x": _B_in["x"],
        "B_w1": _B_in["w1"],
        "B_b1": _B_in["b1"],
        "B_w2": _B_in["w2"],
        "B_b2": _B_in["b2"],
    }

def reference(A_x, A_wqkv, A_wo, B_x, B_w1, B_b1, B_w2, B_b2):
    def _A_ref(x, wqkv, wo):
        B, S, D = x.shape
        H = 32; Dh = D // H
        qkv = (lambda x, *d: x.permute(*d))((x @ wqkv).reshape(B, S, 3, H, Dh), 2, 0, 3, 1, 4)
        q, k, v = qkv[0], qkv[1], qkv[2]
        phi = lambda t: torch.where(t > 0, t + 1, torch.exp(t)) + 1e-6
        pq, pk = phi(q), phi(k)
        kv = torch.einsum("bhsd,bhse->bhde", pk, v)
        z = torch.einsum("bhsd->bhd", pk)
        num = torch.einsum("bhqd,bhde->bhqe", pq, kv)
        den = torch.einsum("bhqd,bhd->bhq", pq, z)[..., None] + 1e-6
        o = num / den
        return (lambda x, *d: x.permute(*d))(o, 0, 2, 1, 3).reshape(B, S, D) @ wo

    def _B_ref(x, w1, b1, w2, b2):
        y = _layernorm(x, axis=-1)
        h = _gelu(torch.einsum("bsd,df->bsf", y, w1) + b1)
        return torch.einsum("bsf,fd->bsd", h, w2) + b2

    x = A_x
    h = x + _A_ref(_layernorm(x, axis=-1), A_wqkv, A_wo)
    h2 = h + _B_ref(_layernorm(h, axis=-1), B_w1, B_b1, B_w2, B_b2)
    return h2
```

```asm
; @launch grid=(256,1,1) block=(768,1,1) lds=163840
.amdgcn_target "amdgcn-amd-amdhsa--gfx950"
.text
.globl sequential_preLN__linear_attn_block__mixer_channel_mlp__prompt_kernel
.p2align 8
.type sequential_preLN__linear_attn_block__mixer_channel_mlp__prompt_kernel,@function
sequential_preLN__linear_attn_block__mixer_channel_mlp__prompt_kernel:
  s_cmp_ge_u32 s2, 256
  s_cbranch_scc1 L_end
  s_load_dwordx16 s[16:31], s[0:1], 0
  s_load_dwordx4 s[32:35], s[0:1], 64
  s_load_dwordx2 s[36:37], s[0:1], 80
  s_and_b32 s4, s2, 7
  s_lshr_b32 s5, s2, 3
  s_lshr_b32 s6, s5, 4
  s_and_b32 s7, s5, 15
  s_getreg_b32 s11, hwreg(HW_REG_XCC_ID)
  s_and_b32 s11, s11, 7
  s_mov_b32 s10, 0
  s_mov_b32 s9, 0
  v_and_b32 v1, 63, v0
  v_lshrrev_b32 v5, 6, v0
  v_lshlrev_b32 v2, 4, v1
  v_readfirstlane_b32 s8, v5
  v_lshrrev_b32 v3, 4, v1
  v_and_b32 v4, 15, v1
  s_getpc_b64 s[38:39]
  s_lshl_b32 s3, s5, 3
  s_add_u32 s3, s3, s8
  s_cmp_ge_u32 s3, ((L_end-sequential_preLN__linear_attn_block__mixer_channel_mlp__prompt_kernel)>>10)
  s_cbranch_scc1 L_cpf_1
  s_lshl_b32 s3, s3, 10
  v_add_u32 v6, s3, v2
  global_load_dwordx4 v[148:151], v6, s[38:39]
L_cpf_1:
  s_waitcnt lgkmcnt(0)
  s_mov_b32 s40, s16
  s_mov_b32 s41, s17
  s_mov_b32 s42, 2621440
  s_mov_b32 s43, 0x20000
  s_mov_b32 s44, s18
  s_mov_b32 s45, s19
  s_mov_b32 s46, 2457600
  s_mov_b32 s47, 0x20000
  s_mov_b32 s48, s36
  s_mov_b32 s49, s37
  s_mov_b32 s50, 268435456
  s_mov_b32 s51, 0x20000
  s_mov_b32 s52, s32
  s_mov_b32 s53, s33
  s_mov_b32 s54, 2621440
  s_mov_b32 s55, 0x20000
  s_mov_b32 s56, s34
  s_mov_b32 s57, s35
  s_mov_b32 s58, 256
  s_mov_b32 s59, 0x20000
  s_cmp_ge_u32 s8, 8
  s_cbranch_scc1 L_helper
  s_lshl_b32 s12, s4, 8
  s_lshl_b32 s13, s5, 3
  s_add_u32 s12, s12, s13
  s_add_u32 s12, s12, s8
  s_mul_i32 s12, s12, 1280
  buffer_load_dwordx4 v[140:143], v2, s[40:43], s12 offen
  v_lshlrev_b32 v10, 4, v4
  buffer_load_dwordx4 v[144:147], v10, s[40:43], s12 offen offset:1024
  s_cmp_eq_u32 s7, 15
  s_cbranch_scc1 L_c_spare
  s_lshr_b32 s81, s8, 1
  s_and_b32 s82, s8, 1
  s_lshl_b32 s12, s81, 12
  s_lshl_b32 s13, s82, 11
  s_add_u32 s14, s12, s13
  s_sub_u32 s15, s12, s13
  s_add_u32 s15, s15, 2048
  v_and_b32 v10, 7, v4
  v_mov_b32 v11, v3
  v_xor_b32 v11, v11, v10
  v_lshlrev_b32 v11, 4, v11
  v_lshl_add_u32 v11, v4, 7, v11
  v_add_u32 v16, s14, v11
  v_add_u32 v17, 0x10000, v16
  v_add_u32 v18, 0x20000, v16
  v_add_u32 v19, s15, v11
  v_add_u32 v20, 0x10000, v19
  v_add_u32 v21, 0x20000, v19
  v_or_b32 v11, 4, v3
  v_xor_b32 v11, v11, v10
  v_lshlrev_b32 v11, 4, v11
  v_lshl_add_u32 v11, v4, 7, v11
  v_add_u32 v22, s14, v11
  v_add_u32 v23, 0x10000, v22
  v_add_u32 v24, 0x20000, v22
  v_add_u32 v25, s15, v11
  v_add_u32 v26, 0x10000, v25
  v_add_u32 v27, 0x20000, v25
  v_lshrrev_b32 v10, 2, v4
  v_and_b32 v11, 3, v4
  v_and_b32 v12, 1, v3
  v_lshlrev_b32 v12, 3, v12
  v_lshl_add_u32 v12, v10, 1, v12
  v_lshrrev_b32 v13, 1, v11
  v_xor_b32 v12, v12, v13
  v_lshl_add_u32 v13, v3, 3, v10
  v_lshlrev_b32 v13, 8, v13
  v_and_b32 v14, 1, v11
  v_lshl_add_u32 v13, v14, 3, v13
  v_add_u32 v13, 16384, v13
  v_mov_b32 v40, 0x3f803f80
  v_mov_b32 v41, 0x3f803f80
  v_mov_b32 v42, 0x3f803f80
  v_mov_b32 v43, 0x3f803f80
  s_cmp_lt_u32 s7, 5
  s_cbranch_scc0 L_p1_kv
  s_xor_b32 s12, s81, 0
  s_lshl_b32 s13, s82, 2
  s_add_u32 s12, s12, s13
  s_mov_b32 s84, s12
  s_lshl_b32 s12, s12, 1
  v_xor_b32 v14, s12, v12
  v_lshl_add_u32 v28, v14, 4, v13
  v_add_u32 v29, 0x10000, v28
  v_add_u32 v30, 0x20000, v28
  s_xor_b32 s12, s81, 1
  s_lshl_b32 s13, s82, 2
  s_add_u32 s12, s12, s13
  s_mov_b32 s85, s12
  s_lshl_b32 s12, s12, 1
  v_xor_b32 v14, s12, v12
  v_lshl_add_u32 v31, v14, 4, v13
  v_add_u32 v32, 0x10000, v31
  v_add_u32 v33, 0x20000, v31
  s_xor_b32 s12, s81, 2
  s_lshl_b32 s13, s82, 2
  s_add_u32 s12, s12, s13
  s_mov_b32 s86, s12
  s_lshl_b32 s12, s12, 1
  v_xor_b32 v14, s12, v12
  v_lshl_add_u32 v34, v14, 4, v13
  v_add_u32 v35, 0x10000, v34
  v_add_u32 v36, 0x20000, v34
  s_xor_b32 s12, s81, 3
  s_lshl_b32 s13, s82, 2
  s_add_u32 s12, s12, s13
  s_mov_b32 s87, s12
  s_lshl_b32 s12, s12, 1
  v_xor_b32 v14, s12, v12
  v_lshl_add_u32 v37, v14, 4, v13
  v_add_u32 v38, 0x10000, v37
  v_add_u32 v39, 0x20000, v37
  s_barrier
  ds_read_b128 v[44:47], v16 offset:0
  ds_read_b128 v[48:51], v19 offset:0
  ds_read_b64_tr_b16 v[52:53], v28 offset:0
  ds_read_b64_tr_b16 v[54:55], v28 offset:1024
  ds_read_b64_tr_b16 v[56:57], v31 offset:0
  ds_read_b64_tr_b16 v[58:59], v31 offset:1024
  ds_read_b64_tr_b16 v[60:61], v34 offset:0
  ds_read_b64_tr_b16 v[62:63], v34 offset:1024
  ds_read_b64_tr_b16 v[64:65], v37 offset:0
  ds_read_b64_tr_b16 v[66:67], v37 offset:1024
  s_waitcnt lgkmcnt(0)
  v_mfma_f32_16x16x32_bf16 v[96:99], v[52:55], v[44:47], 0
  ds_read_b128 v[68:71], v22 offset:0
  v_mfma_f32_16x16x32_bf16 v[100:103], v[56:59], v[44:47], 0
  ds_read_b128 v[72:75], v25 offset:0
  v_mfma_f32_16x16x32_bf16 v[104:107], v[60:63], v[44:47], 0
  ds_read_b64_tr_b16 v[76:77], v28 offset:8192
  v_mfma_f32_16x16x32_bf16 v[108:111], v[64:67], v[44:47], 0
  ds_read_b64_tr_b16 v[78:79], v28 offset:9216
  v_mfma_f32_16x16x32_bf16 v[112:115], v[52:55], v[48:51], 0
  ds_read_b64_tr_b16 v[80:81], v31 offset:8192
  v_mfma_f32_16x16x32_bf16 v[116:119], v[56:59], v[48:51], 0
  ds_read_b64_tr_b16 v[82:83], v31 offset:9216
  v_mfma_f32_16x16x32_bf16 v[120:123], v[60:63], v[48:51], 0
  ds_read_b64_tr_b16 v[84:85], v34 offset:8192
  v_mfma_f32_16x16x32_bf16 v[124:127], v[64:67], v[48:51], 0
  ds_read_b64_tr_b16 v[86:87], v34 offset:9216
  v_mfma_f32_16x16x32_bf16 v[128:131], v[44:47], v[44:47], 0
  ds_read_b64_tr_b16 v[88:89], v37 offset:8192
  v_mfma_f32_16x16x32_bf16 v[132:135], v[44:47], v[40:43], 0
  ds_read_b64_tr_b16 v[90:91], v37 offset:9216
  v_mfma_f32_16x16x32_bf16 v[136:139], v[40:43], v[52:55], 0
  s_waitcnt lgkmcnt(0)
  s_barrier
  v_mfma_f32_16x16x32_bf16 v[96:99], v[76:79], v[68:71], v[96:99]
  ds_read_b128 v[44:47], v16 offset:32768
  v_mfma_f32_16x16x32_bf16 v[100:103], v[80:83], v[68:71], v[100:103]
  ds_read_b128 v[48:51], v19 offset:32768
  v_mfma_f32_16x16x32_bf16 v[104:107], v[84:87], v[68:71], v[104:107]
  ds_read_b64_tr_b16 v[52:53], v28 offset:32768
  v_mfma_f32_16x16x32_bf16 v[108:111], v[88:91], v[68:71], v[108:111]
  ds_read_b64_tr_b16 v[54:55], v28 offset:33792
  v_mfma_f32_16x16x32_bf16 v[112:115], v[76:79], v[72:75], v[112:115]
  ds_read_b64_tr_b16 v[56:57], v31 offset:32768
  v_mfma_f32_16x16x32_bf16 v[116:119], v[80:83], v[72:75], v[116:119]
  ds_read_b64_tr_b16 v[58:59], v31 offset:33792
  v_mfma_f32_16x16x32_bf16 v[120:123], v[84:87], v[72:75], v[120:123]
  ds_read_b64_tr_b16 v[60:61], v34 offset:32768
  v_mfma_f32_16x16x32_bf16 v[124:127], v[88:91], v[72:75], v[124:127]
  ds_read_b64_tr_b16 v[62:63], v34 offset:33792
  v_mfma_f32_16x16x32_bf16 v[128:131], v[68:71], v[68:71], v[128:131]
  ds_read_b64_tr_b16 v[64:65], v37 offset:32768
  v_mfma_f32_16x16x32_bf16 v[132:135], v[68:71], v[40:43], v[132:135]
  ds_read_b64_tr_b16 v[66:67], v37 offset:33792
  v_mfma_f32_16x16x32_bf16 v[136:139], v[40:43], v[76:79], v[136:139]
  s_waitcnt lgkmcnt(0)
  v_mfma_f32_16x16x32_bf16 v[96:99], v[52:55], v[44:47], v[96:99]
  ds_read_b128 v[68:71], v22 offset:32768
  v_mfma_f32_16x16x32_bf16 v[100:103], v[56:59], v[44:47], v[100:103]
  ds_read_b128 v[72:75], v25 offset:32768
  v_mfma_f32_16x16x32_bf16 v[104:107], v[60:63], v[44:47], v[104:107]
  ds_read_b64_tr_b16 v[76:77], v28 offset:40960
  v_mfma_f32_16x16x32_bf16 v[108:111], v[64:67], v[44:47], v[108:111]
  ds_read_b64_tr_b16 v[78:79], v28 offset:41984
  v_mfma_f32_16x16x32_bf16 v[112:115], v[52:55], v[48:51], v[112:115]
  ds_read_b64_tr_b16 v[80:81], v31 offset:40960
  v_mfma_f32_16x16x32_bf16 v[116:119], v[56:59], v[48:51], v[116:119]
  ds_read_b64_tr_b16 v[82:83], v31 offset:41984
  v_mfma_f32_16x16x32_bf16 v[120:123], v[60:63], v[48:51], v[120:123]
  ds_read_b64_tr_b16 v[84:85], v34 offset:40960
  v_mfma_f32_16x16x32_bf16 v[124:127], v[64:67], v[48:51], v[124:127]
  ds_read_b64_tr_b16 v[86:87], v34 offset:41984
  v_mfma_f32_16x16x32_bf16 v[128:131], v[44:47], v[44:47], v[128:131]
  ds_read_b64_tr_b16 v[88:89], v37 offset:40960
  v_mfma_f32_16x16x32_bf16 v[132:135], v[44:47], v[40:43], v[132:135]
  ds_read_b64_tr_b16 v[90:91], v37 offset:41984
  v_mfma_f32_16x16x32_bf16 v[136:139], v[40:43], v[52:55], v[136:139]
  s_waitcnt lgkmcnt(0)
  s_barrier
  v_mfma_f32_16x16x32_bf16 v[96:99], v[76:79], v[68:71], v[96:99]
  ds_read_b128 v[44:47], v17 offset:0
  v_mfma_f32_16x16x32_bf16 v[100:103], v[80:83], v[68:71], v[100:103]
  ds_read_b128 v[48:51], v20 offset:0
  v_mfma_f32_16x16x32_bf16 v[104:107], v[84:87], v[68:71], v[104:107]
  ds_read_b64_tr_b16 v[52:53], v29 offset:0
  v_mfma_f32_16x16x32_bf16 v[108:111], v[88:91], v[68:71], v[108:111]
  ds_read_b64_tr_b16 v[54:55], v29 offset:1024
  v_mfma_f32_16x16x32_bf16 v[112:115], v[76:79], v[72:75], v[112:115]
  ds_read_b64_tr_b16 v[56:57], v32 offset:0
  v_mfma_f32_16x16x32_bf16 v[116:119], v[80:83], v[72:75], v[116:119]
  ds_read_b64_tr_b16 v[58:59], v32 offset:1024
  v_mfma_f32_16x16x32_bf16 v[120:123], v[84:87], v[72:75], v[120:123]
  ds_read_b64_tr_b16 v[60:61], v35 offset:0
  v_mfma_f32_16x16x32_bf16 v[124:127], v[88:91], v[72:75], v[124:127]
  ds_read_b64_tr_b16 v[62:63], v35 offset:1024
  v_mfma_f32_16x16x32_bf16 v[128:131], v[68:71], v[68:71], v[128:131]
  ds_read_b64_tr_b16 v[64:65], v38 offset:0
  v_mfma_f32_16x16x32_bf16 v[132:135], v[68:71], v[40:43], v[132:135]
  ds_read_b64_tr_b16 v[66:67], v38 offset:1024
  v_mfma_f32_16x16x32_bf16 v[136:139], v[40:43], v[76:79], v[136:139]
  s_waitcnt lgkmcnt(0)
  v_mfma_f32_16x16x32_bf16 v[96:99], v[52:55], v[44:47], v[96:99]
  ds_read_b128 v[68:71], v23 offset:0
  v_mfma_f32_16x16x32_bf16 v[100:103], v[56:59], v[44:47], v[100:103]
  ds_read_b128 v[72:75], v26 offset:0
  v_mfma_f32_16x16x32_bf16 v[104:107], v[60:63], v[44:47], v[104:107]
  ds_read_b64_tr_b16 v[76:77], v29 offset:8192
  v_mfma_f32_16x16x32_bf16 v[108:111], v[64:67], v[44:47], v[108:111]
  ds_read_b64_tr_b16 v[78:79], v29 offset:9216
  v_mfma_f32_16x16x32_bf16 v[112:115], v[52:55], v[48:51], v[112:115]
  ds_read_b64_tr_b16 v[80:81], v32 offset:8192
  v_mfma_f32_16x16x32_bf16 v[116:119], v[56:59], v[48:51], v[116:119]
  ds_read_b64_tr_b16 v[82:83], v32 offset:9216
  v_mfma_f32_16x16x32_bf16 v[120:123], v[60:63], v[48:51], v[120:123]
  ds_read_b64_tr_b16 v[84:85], v35 offset:8192
  v_mfma_f32_16x16x32_bf16 v[124:127], v[64:67], v[48:51], v[124:127]
  ds_read_b64_tr_b16 v[86:87], v35 offset:9216
  v_mfma_f32_16x16x32_bf16 v[128:131], v[44:47], v[44:47], v[128:131]
  ds_read_b64_tr_b16 v[88:89], v38 offset:8192
  v_mfma_f32_16x16x32_bf16 v[132:135], v[44:47], v[40:43], v[132:135]
  ds_read_b64_tr_b16 v[90:91], v38 offset:9216
  v_mfma_f32_16x16x32_bf16 v[136:139], v[40:43], v[52:55], v[136:139]
  s_waitcnt lgkmcnt(0)
  s_barrier
  v_mfma_f32_16x16x32_bf16 v[96:99], v[76:79], v[68:71], v[96:99]
  ds_read_b128 v[44:47], v17 offset:32768
  v_mfma_f32_16x16x32_bf16 v[100:103], v[80:83], v[68:71], v[100:103]
  ds_read_b128 v[48:51], v20 offset:32768
  v_mfma_f32_16x16x32_bf16 v[104:107], v[84:87], v[68:71], v[104:107]
  ds_read_b64_tr_b16 v[52:53], v29 offset:32768
  v_mfma_f32_16x16x32_bf16 v[108:111], v[88:91], v[68:71], v[108:111]
  ds_read_b64_tr_b16 v[54:55], v29 offset:33792
  v_mfma_f32_16x16x32_bf16 v[112:115], v[76:79], v[72:75], v[112:115]
  ds_read_b64_tr_b16 v[56:57], v32 offset:32768
  v_mfma_f32_16x16x32_bf16 v[116:119], v[80:83], v[72:75], v[116:119]
  ds_read_b64_tr_b16 v[58:59], v32 offset:33792
  v_mfma_f32_16x16x32_bf16 v[120:123], v[84:87], v[72:75], v[120:123]
  ds_read_b64_tr_b16 v[60:61], v35 offset:32768
  v_mfma_f32_16x16x32_bf16 v[124:127], v[88:91], v[72:75], v[124:127]
  ds_read_b64_tr_b16 v[62:63], v35 offset:33792
  v_mfma_f32_16x16x32_bf16 v[128:131], v[68:71], v[68:71], v[128:131]
  ds_read_b64_tr_b16 v[64:65], v38 offset:32768
  v_mfma_f32_16x16x32_bf16 v[132:135], v[68:71], v[40:43], v[132:135]
  ds_read_b64_tr_b16 v[66:67], v38 offset:33792
  v_mfma_f32_16x16x32_bf16 v[136:139], v[40:43], v[76:79], v[136:139]
  s_waitcnt lgkmcnt(0)
  v_mfma_f32_16x16x32_bf16 v[96:99], v[52:55], v[44:47], v[96:99]
  ds_read_b128 v[68:71], v23 offset:32768
  v_mfma_f32_16x16x32_bf16 v[100:103], v[56:59], v[44:47], v[100:103]
  ds_read_b128 v[72:75], v26 offset:32768
  v_mfma_f32_16x16x32_bf16 v[104:107], v[60:63], v[44:47], v[104:107]
  ds_read_b64_tr_b16 v[76:77], v29 offset:40960
  v_mfma_f32_16x16x32_bf16 v[108:111], v[64:67], v[44:47], v[108:111]
  ds_read_b64_tr_b16 v[78:79], v29 offset:41984
  v_mfma_f32_16x16x32_bf16 v[112:115], v[52:55], v[48:51], v[112:115]
  ds_read_b64_tr_b16 v[80:81], v32 offset:40960
  v_mfma_f32_16x16x32_bf16 v[116:119], v[56:59], v[48:51], v[116:119]
  ds_read_b64_tr_b16 v[82:83], v32 offset:41984
  v_mfma_f32_16x16x32_bf16 v[120:123], v[60:63], v[48:51], v[120:123]
  ds_read_b64_tr_b16 v[84:85], v35 offset:40960
  v_mfma_f32_16x16x32_bf16 v[124:127], v[64:67], v[48:51], v[124:127]
  ds_read_b64_tr_b16 v[86:87], v35 offset:41984
  v_mfma_f32_16x16x32_bf16 v[128:131], v[44:47], v[44:47], v[128:131]
  ds_read_b64_tr_b16 v[88:89], v38 offset:40960
  v_mfma_f32_16x16x32_bf16 v[132:135], v[44:47], v[40:43], v[132:135]
  ds_read_b64_tr_b16 v[90:91], v38 offset:41984
  v_mfma_f32_16x16x32_bf16 v[136:139], v[40:43], v[52:55], v[136:139]
  s_waitcnt lgkmcnt(0)
  s_barrier
  v_mfma_f32_16x16x32_bf16 v[96:99], v[76:79], v[68:71], v[96:99]
  ds_read_b128 v[44:47], v18 offset:0
  v_mfma_f32_16x16x32_bf16 v[100:103], v[80:83], v[68:71], v[100:103]
  ds_read_b128 v[48:51], v21 offset:0
  v_mfma_f32_16x16x32_bf16 v[104:107], v[84:87], v[68:71], v[104:107]
  ds_read_b64_tr_b16 v[52:53], v30 offset:0
  v_mfma_f32_16x16x32_bf16 v[108:111], v[88:91], v[68:71], v[108:111]
  ds_read_b64_tr_b16 v[54:55], v30 offset:1024
  v_mfma_f32_16x16x32_bf16 v[112:115], v[76:79], v[72:75], v[112:115]
  ds_read_b64_tr_b16 v[56:57], v33 offset:0
  v_mfma_f32_16x16x32_bf16 v[116:119], v[80:83], v[72:75], v[116:119]
  ds_read_b64_tr_b16 v[58:59], v33 offset:1024
  v_mfma_f32_16x16x32_bf16 v[120:123], v[84:87], v[72:75], v[120:123]
  ds_read_b64_tr_b16 v[60:61], v36 offset:0
  v_mfma_f32_16x16x32_bf16 v[124:127], v[88:91], v[72:75], v[124:127]
  ds_read_b64_tr_b16 v[62:63], v36 offset:1024
  v_mfma_f32_16x16x32_bf16 v[128:131], v[68:71], v[68:71], v[128:131]
  ds_read_b64_tr_b16 v[64:65], v39 offset:0
  v_mfma_f32_16x16x32_bf16 v[132:135], v[68:71], v[40:43], v[132:135]
  ds_read_b64_tr_b16 v[66:67], v39 offset:1024
  v_mfma_f32_16x16x32_bf16 v[136:139], v[40:43], v[76:79], v[136:139]
  s_waitcnt lgkmcnt(0)
  v_mfma_f32_16x16x32_bf16 v[96:99], v[52:55], v[44:47], v[96:99]
  ds_read_b128 v[68:71], v24 offset:0
  v_mfma_f32_16x16x32_bf16 v[100:103], v[56:59], v[44:47], v[100:103]
  ds_read_b128 v[72:75], v27 offset:0
  v_mfma_f32_16x16x32_bf16 v[104:107], v[60:63], v[44:47], v[104:107]
  ds_read_b64_tr_b16 v[76:77], v30 offset:8192
  v_mfma_f32_16x16x32_bf16 v[108:111], v[64:67], v[44:47], v[108:111]
  ds_read_b64_tr_b16 v[78:79], v30 offset:9216
  v_mfma_f32_16x16x32_bf16 v[112:115], v[52:55], v[48:51], v[112:115]
  ds_read_b64_tr_b16 v[80:81], v33 offset:8192
  v_mfma_f32_16x16x32_bf16 v[116:119], v[56:59], v[48:51], v[116:119]
  ds_read_b64_tr_b16 v[82:83], v33 offset:9216
  v_mfma_f32_16x16x32_bf16 v[120:123], v[60:63], v[48:51], v[120:123]
  ds_read_b64_tr_b16 v[84:85], v36 offset:8192
  v_mfma_f32_16x16x32_bf16 v[124:127], v[64:67], v[48:51], v[124:127]
  ds_read_b64_tr_b16 v[86:87], v36 offset:9216
  v_mfma_f32_16x16x32_bf16 v[128:131], v[44:47], v[44:47], v[128:131]
  ds_read_b64_tr_b16 v[88:89], v39 offset:8192
  v_mfma_f32_16x16x32_bf16 v[132:135], v[44:47], v[40:43], v[132:135]
  ds_read_b64_tr_b16 v[90:91], v39 offset:9216
  v_mfma_f32_16x16x32_bf16 v[136:139], v[40:43], v[52:55], v[136:139]
  s_waitcnt lgkmcnt(0)
  s_barrier
  v_mfma_f32_16x16x32_bf16 v[96:99], v[76:79], v[68:71], v[96:99]
  ds_read_b128 v[44:47], v16 offset:0
  v_mfma_f32_16x16x32_bf16 v[100:103], v[80:83], v[68:71], v[100:103]
  ds_read_b128 v[48:51], v19 offset:0
  v_mfma_f32_16x16x32_bf16 v[104:107], v[84:87], v[68:71], v[104:107]
  ds_read_b64_tr_b16 v[52:53], v28 offset:0
  v_mfma_f32_16x16x32_bf16 v[108:111], v[88:91], v[68:71], v[108:111]
  ds_read_b64_tr_b16 v[54:55], v28 offset:1024
  v_mfma_f32_16x16x32_bf16 v[112:115], v[76:79], v[72:75], v[112:115]
  ds_read_b64_tr_b16 v[56:57], v31 offset:0
  v_mfma_f32_16x16x32_bf16 v[116:119], v[80:83], v[72:75], v[116:119]
  ds_read_b64_tr_b16 v[58:59], v31 offset:1024
  v_mfma_f32_16x16x32_bf16 v[120:123], v[84:87], v[72:75], v[120:123]
  ds_read_b64_tr_b16 v[60:61], v34 offset:0
  v_mfma_f32_16x16x32_bf16 v[124:127], v[88:91], v[72:75], v[124:127]
  ds_read_b64_tr_b16 v[62:63], v34 offset:1024
  v_mfma_f32_16x16x32_bf16 v[128:131], v[68:71], v[68:71], v[128:131]
  ds_read_b64_tr_b16 v[64:65], v37 offset:0
  v_mfma_f32_16x16x32_bf16 v[132:135], v[68:71], v[40:43], v[132:135]
  ds_read_b64_tr_b16 v[66:67], v37 offset:1024
  v_mfma_f32_16x16x32_bf16 v[136:139], v[40:43], v[76:79], v[136:139]
  s_waitcnt lgkmcnt(0)
  v_mfma_f32_16x16x32_bf16 v[96:99], v[52:55], v[44:47], v[96:99]
  ds_read_b128 v[68:71], v22 offset:0
  v_mfma_f32_16x16x32_bf16 v[100:103], v[56:59], v[44:47], v[100:103]
  ds_read_b128 v[72:75], v25 offset:0
  v_mfma_f32_16x16x32_bf16 v[104:107], v[60:63], v[44:47], v[104:107]
  ds_read_b64_tr_b16 v[76:77], v28 offset:8192
  v_mfma_f32_16x16x32_bf16 v[108:111], v[64:67], v[44:47], v[108:111]
  ds_read_b64_tr_b16 v[78:79], v28 offset:9216
  v_mfma_f32_16x16x32_bf16 v[112:115], v[52:55], v[48:51], v[112:115]
  ds_read_b64_tr_b16 v[80:81], v31 offset:8192
  v_mfma_f32_16x16x32_bf16 v[116:119], v[56:59], v[48:51], v[116:119]
  ds_read_b64_tr_b16 v[82:83], v31 offset:9216
  v_mfma_f32_16x16x32_bf16 v[120:123], v[60:63], v[48:51], v[120:123]
  ds_read_b64_tr_b16 v[84:85], v34 offset:8192
  v_mfma_f32_16x16x32_bf16 v[124:127], v[64:67], v[48:51], v[124:127]
  ds_read_b64_tr_b16 v[86:87], v34 offset:9216
  v_mfma_f32_16x16x32_bf16 v[128:131], v[44:47], v[44:47], v[128:131]
  ds_read_b64_tr_b16 v[88:89], v37 offset:8192
  v_mfma_f32_16x16x32_bf16 v[132:135], v[44:47], v[40:43], v[132:135]
  ds_read_b64_tr_b16 v[90:91], v37 offset:9216
  v_mfma_f32_16x16x32_bf16 v[136:139], v[40:43], v[52:55], v[136:139]
  s_waitcnt lgkmcnt(0)
  s_barrier
  v_mfma_f32_16x16x32_bf16 v[96:99], v[76:79], v[68:71], v[96:99]
  ds_read_b128 v[44:47], v16 offset:32768
  v_mfma_f32_16x16x32_bf16 v[100:103], v[80:83], v[68:71], v[100:103]
  ds_read_b128 v[48:51], v19 offset:32768
  v_mfma_f32_16x16x32_bf16 v[104:107], v[84:87], v[68:71], v[104:107]
  ds_read_b64_tr_b16 v[52:53], v28 offset:32768
  v_mfma_f32_16x16x32_bf16 v[108:111], v[88:91], v[68:71], v[108:111]
  ds_read_b64_tr_b16 v[54:55], v28 offset:33792
  v_mfma_f32_16x16x32_bf16 v[112:115], v[76:79], v[72:75], v[112:115]
  ds_read_b64_tr_b16 v[56:57], v31 offset:32768
  v_mfma_f32_16x16x32_bf16 v[116:119], v[80:83], v[72:75], v[116:119]
  ds_read_b64_tr_b16 v[58:59], v31 offset:33792
  v_mfma_f32_16x16x32_bf16 v[120:123], v[84:87], v[72:75], v[120:123]
  ds_read_b64_tr_b16 v[60:61], v34 offset:32768
  v_mfma_f32_16x16x32_bf16 v[124:127], v[88:91], v[72:75], v[124:127]
  ds_read_b64_tr_b16 v[62:63], v34 offset:33792
  v_mfma_f32_16x16x32_bf16 v[128:131], v[68:71], v[68:71], v[128:131]
  ds_read_b64_tr_b16 v[64:65], v37 offset:32768
  v_mfma_f32_16x16x32_bf16 v[132:135], v[68:71], v[40:43], v[132:135]
  ds_read_b64_tr_b16 v[66:67], v37 offset:33792
  v_mfma_f32_16x16x32_bf16 v[136:139], v[40:43], v[76:79], v[136:139]
  s_waitcnt lgkmcnt(0)
  v_mfma_f32_16x16x32_bf16 v[96:99], v[52:55], v[44:47], v[96:99]
  ds_read_b128 v[68:71], v22 offset:32768
  v_mfma_f32_16x16x32_bf16 v[100:103], v[56:59], v[44:47], v[100:103]
  ds_read_b128 v[72:75], v25 offset:32768
  v_mfma_f32_16x16x32_bf16 v[104:107], v[60:63], v[44:47], v[104:107]
  ds_read_b64_tr_b16 v[76:77], v28 offset:40960
  v_mfma_f32_16x16x32_bf16 v[108:111], v[64:67], v[44:47], v[108:111]
  ds_read_b64_tr_b16 v[78:79], v28 offset:41984
  v_mfma_f32_16x16x32_bf16 v[112:115], v[52:55], v[48:51], v[112:115]
  ds_read_b64_tr_b16 v[80:81], v31 offset:40960
  v_mfma_f32_16x16x32_bf16 v[116:119], v[56:59], v[48:51], v[116:119]
  ds_read_b64_tr_b16 v[82:83], v31 offset:41984
  v_mfma_f32_16x16x32_bf16 v[120:123], v[60:63], v[48:51], v[120:123]
  ds_read_b64_tr_b16 v[84:85], v34 offset:40960
  v_mfma_f32_16x16x32_bf16 v[124:127], v[64:67], v[48:51], v[124:127]
  ds_read_b64_tr_b16 v[86:87], v34 offset:41984
  v_mfma_f32_16x16x32_bf16 v[128:131], v[44:47], v[44:47], v[128:131]
  ds_read_b64_tr_b16 v[88:89], v37 offset:40960
  v_mfma_f32_16x16x32_bf16 v[132:135], v[44:47], v[40:43], v[132:135]
  ds_read_b64_tr_b16 v[90:91], v37 offset:41984
  v_mfma_f32_16x16x32_bf16 v[136:139], v[40:43], v[52:55], v[136:139]
  s_waitcnt lgkmcnt(0)
  s_barrier
  v_mfma_f32_16x16x32_bf16 v[96:99], v[76:79], v[68:71], v[96:99]
  ds_read_b128 v[44:47], v17 offset:0
  v_mfma_f32_16x16x32_bf16 v[100:103], v[80:83], v[68:71], v[100:103]
  ds_read_b128 v[48:51], v20 offset:0
  v_mfma_f32_16x16x32_bf16 v[104:107], v[84:87], v[68:71], v[104:107]
  ds_read_b64_tr_b16 v[52:53], v29 offset:0
  v_mfma_f32_16x16x32_bf16 v[108:111], v[88:91], v[68:71], v[108:111]
  ds_read_b64_tr_b16 v[54:55], v29 offset:1024
  v_mfma_f32_16x16x32_bf16 v[112:115], v[76:79], v[72:75], v[112:115]
  ds_read_b64_tr_b16 v[56:57], v32 offset:0
  v_mfma_f32_16x16x32_bf16 v[116:119], v[80:83], v[72:75], v[116:119]
  ds_read_b64_tr_b16 v[58:59], v32 offset:1024
  v_mfma_f32_16x16x32_bf16 v[120:123], v[84:87], v[72:75], v[120:123]
  ds_read_b64_tr_b16 v[60:61], v35 offset:0
  v_mfma_f32_16x16x32_bf16 v[124:127], v[88:91], v[72:75], v[124:127]
  ds_read_b64_tr_b16 v[62:63], v35 offset:1024
  v_mfma_f32_16x16x32_bf16 v[128:131], v[68:71], v[68:71], v[128:131]
  ds_read_b64_tr_b16 v[64:65], v38 offset:0
  v_mfma_f32_16x16x32_bf16 v[132:135], v[68:71], v[40:43], v[132:135]
  ds_read_b64_tr_b16 v[66:67], v38 offset:1024
  v_mfma_f32_16x16x32_bf16 v[136:139], v[40:43], v[76:79], v[136:139]
  s_waitcnt lgkmcnt(0)
  v_mfma_f32_16x16x32_bf16 v[96:99], v[52:55], v[44:47], v[96:99]
  ds_read_b128 v[68:71], v23 offset:0
  v_mfma_f32_16x16x32_bf16 v[100:103], v[56:59], v[44:47], v[100:103]
  ds_read_b128 v[72:75], v26 offset:0
  v_mfma_f32_16x16x32_bf16 v[104:107], v[60:63], v[44:47], v[104:107]
  ds_read_b64_tr_b16 v[76:77], v29 offset:8192
  v_mfma_f32_16x16x32_bf16 v[108:111], v[64:67], v[44:47], v[108:111]
  ds_read_b64_tr_b16 v[78:79], v29 offset:9216
  v_mfma_f32_16x16x32_bf16 v[112:115], v[52:55], v[48:51], v[112:115]
  ds_read_b64_tr_b16 v[80:81], v32 offset:8192
  v_mfma_f32_16x16x32_bf16 v[116:119], v[56:59], v[48:51], v[116:119]
  ds_read_b64_tr_b16 v[82:83], v32 offset:9216
  v_mfma_f32_16x16x32_bf16 v[120:123], v[60:63], v[48:51], v[120:123]
  ds_read_b64_tr_b16 v[84:85], v35 offset:8192
  v_mfma_f32_16x16x32_bf16 v[124:127], v[64:67], v[48:51], v[124:127]
  ds_read_b64_tr_b16 v[86:87], v35 offset:9216
  v_mfma_f32_16x16x32_bf16 v[128:131], v[44:47], v[44:47], v[128:131]
  ds_read_b64_tr_b16 v[88:89], v38 offset:8192
  v_mfma_f32_16x16x32_bf16 v[132:135], v[44:47], v[40:43], v[132:135]
  ds_read_b64_tr_b16 v[90:91], v38 offset:9216
  v_mfma_f32_16x16x32_bf16 v[136:139], v[40:43], v[52:55], v[136:139]
  s_waitcnt lgkmcnt(0)
  s_barrier
  v_mfma_f32_16x16x32_bf16 v[96:99], v[76:79], v[68:71], v[96:99]
  ds_read_b128 v[44:47], v17 offset:32768
  v_mfma_f32_16x16x32_bf16 v[100:103], v[80:83], v[68:71], v[100:103]
  ds_read_b128 v[48:51], v20 offset:32768
  v_mfma_f32_16x16x32_bf16 v[104:107], v[84:87], v[68:71], v[104:107]
  ds_read_b64_tr_b16 v[52:53], v29 offset:32768
  v_mfma_f32_16x16x32_bf16 v[108:111], v[88:91], v[68:71], v[108:111]
  ds_read_b64_tr_b16 v[54:55], v29 offset:33792
  v_mfma_f32_16x16x32_bf16 v[112:115], v[76:79], v[72:75], v[112:115]
  ds_read_b64_tr_b16 v[56:57], v32 offset:32768
  v_mfma_f32_16x16x32_bf16 v[116:119], v[80:83], v[72:75], v[116:119]
  ds_read_b64_tr_b16 v[58:59], v32 offset:33792
  v_mfma_f32_16x16x32_bf16 v[120:123], v[84:87], v[72:75], v[120:123]
  ds_read_b64_tr_b16 v[60:61], v35 offset:32768
  v_mfma_f32_16x16x32_bf16 v[124:127], v[88:91], v[72:75], v[124:127]
  ds_read_b64_tr_b16 v[62:63], v35 offset:33792
  v_mfma_f32_16x16x32_bf16 v[128:131], v[68:71], v[68:71], v[128:131]
  ds_read_b64_tr_b16 v[64:65], v38 offset:32768
  v_mfma_f32_16x16x32_bf16 v[132:135], v[68:71], v[40:43], v[132:135]
  ds_read_b64_tr_b16 v[66:67], v38 offset:33792
  v_mfma_f32_16x16x32_bf16 v[136:139], v[40:43], v[76:79], v[136:139]
  s_waitcnt lgkmcnt(0)
  v_mfma_f32_16x16x32_bf16 v[96:99], v[52:55], v[44:47], v[96:99]
  ds_read_b128 v[68:71], v23 offset:32768
  v_mfma_f32_16x16x32_bf16 v[100:103], v[56:59], v[44:47], v[100:103]
  ds_read_b128 v[72:75], v26 offset:32768
  v_mfma_f32_16x16x32_bf16 v[104:107], v[60:63], v[44:47], v[104:107]
  ds_read_b64_tr_b16 v[76:77], v29 offset:40960
  v_mfma_f32_16x16x32_bf16 v[108:111], v[64:67], v[44:47], v[108:111]
  ds_read_b64_tr_b16 v[78:79], v29 offset:41984
  v_mfma_f32_16x16x32_bf16 v[112:115], v[52:55], v[48:51], v[112:115]
  ds_read_b64_tr_b16 v[80:81], v32 offset:40960
  v_mfma_f32_16x16x32_bf16 v[116:119], v[56:59], v[48:51], v[116:119]
  ds_read_b64_tr_b16 v[82:83], v32 offset:41984
  v_mfma_f32_16x16x32_bf16 v[120:123], v[60:63], v[48:51], v[120:123]
  ds_read_b64_tr_b16 v[84:85], v35 offset:40960
  v_mfma_f32_16x16x32_bf16 v[124:127], v[64:67], v[48:51], v[124:127]
  ds_read_b64_tr_b16 v[86:87], v35 offset:41984
  v_mfma_f32_16x16x32_bf16 v[128:131], v[44:47], v[44:47], v[128:131]
  ds_read_b64_tr_b16 v[88:89], v38 offset:40960
  v_mfma_f32_16x16x32_bf16 v[132:135], v[44:47], v[40:43], v[132:135]
  ds_read_b64_tr_b16 v[90:91], v38 offset:41984
  v_mfma_f32_16x16x32_bf16 v[136:139], v[40:43], v[52:55], v[136:139]
  s_waitcnt lgkmcnt(0)
  s_barrier
  v_mfma_f32_16x16x32_bf16 v[96:99], v[76:79], v[68:71], v[96:99]
  ds_read_b128 v[44:47], v18 offset:0
  v_mfma_f32_16x16x32_bf16 v[100:103], v[80:83], v[68:71], v[100:103]
  ds_read_b128 v[48:51], v21 offset:0
  v_mfma_f32_16x16x32_bf16 v[104:107], v[84:87], v[68:71], v[104:107]
  ds_read_b64_tr_b16 v[52:53], v30 offset:0
  v_mfma_f32_16x16x32_bf16 v[108:111], v[88:91], v[68:71], v[108:111]
  ds_read_b64_tr_b16 v[54:55], v30 offset:1024
  v_mfma_f32_16x16x32_bf16 v[112:115], v[76:79], v[72:75], v[112:115]
  ds_read_b64_tr_b16 v[56:57], v33 offset:0
  v_mfma_f32_16x16x32_bf16 v[116:119], v[80:83], v[72:75], v[116:119]
  ds_read_b64_tr_b16 v[58:59], v33 offset:1024
  v_mfma_f32_16x16x32_bf16 v[120:123], v[84:87], v[72:75], v[120:123]
  ds_read_b64_tr_b16 v[60:61], v36 offset:0
  v_mfma_f32_16x16x32_bf16 v[124:127], v[88:91], v[72:75], v[124:127]
  ds_read_b64_tr_b16 v[62:63], v36 offset:1024
  v_mfma_f32_16x16x32_bf16 v[128:131], v[68:71], v[68:71], v[128:131]
  ds_read_b64_tr_b16 v[64:65], v39 offset:0
  v_mfma_f32_16x16x32_bf16 v[132:135], v[68:71], v[40:43], v[132:135]
  ds_read_b64_tr_b16 v[66:67], v39 offset:1024
  v_mfma_f32_16x16x32_bf16 v[136:139], v[40:43], v[76:79], v[136:139]
  s_waitcnt lgkmcnt(0)
  v_mfma_f32_16x16x32_bf16 v[96:99], v[52:55], v[44:47], v[96:99]
  ds_read_b128 v[68:71], v24 offset:0
  v_mfma_f32_16x16x32_bf16 v[100:103], v[56:59], v[44:47], v[100:103]
  ds_read_b128 v[72:75], v27 offset:0
  v_mfma_f32_16x16x32_bf16 v[104:107], v[60:63], v[44:47], v[104:107]
  ds_read_b64_tr_b16 v[76:77], v30 offset:8192
  v_mfma_f32_16x16x32_bf16 v[108:111], v[64:67], v[44:47], v[108:111]
  ds_read_b64_tr_b16 v[78:79], v30 offset:9216
  v_mfma_f32_16x16x32_bf16 v[112:115], v[52:55], v[48:51], v[112:115]
  ds_read_b64_tr_b16 v[80:81], v33 offset:8192
  v_mfma_f32_16x16x32_bf16 v[116:119], v[56:59], v[48:51], v[116:119]
  ds_read_b64_tr_b16 v[82:83], v33 offset:9216
  v_mfma_f32_16x16x32_bf16 v[120:123], v[60:63], v[48:51], v[120:123]
  ds_read_b64_tr_b16 v[84:85], v36 offset:8192
  v_mfma_f32_16x16x32_bf16 v[124:127], v[64:67], v[48:51], v[124:127]
  ds_read_b64_tr_b16 v[86:87], v36 offset:9216
  v_mfma_f32_16x16x32_bf16 v[128:131], v[44:47], v[44:47], v[128:131]
  ds_read_b64_tr_b16 v[88:89], v39 offset:8192
  v_mfma_f32_16x16x32_bf16 v[132:135], v[44:47], v[40:43], v[132:135]
  ds_read_b64_tr_b16 v[90:91], v39 offset:9216
  v_mfma_f32_16x16x32_bf16 v[136:139], v[40:43], v[52:55], v[136:139]
  s_waitcnt lgkmcnt(0)
  v_mfma_f32_16x16x32_bf16 v[96:99], v[76:79], v[68:71], v[96:99]
  v_mfma_f32_16x16x32_bf16 v[100:103], v[80:83], v[68:71], v[100:103]
  v_mfma_f32_16x16x32_bf16 v[104:107], v[84:87], v[68:71], v[104:107]
  v_mfma_f32_16x16x32_bf16 v[108:111], v[88:91], v[68:71], v[108:111]
  v_mfma_f32_16x16x32_bf16 v[112:115], v[76:79], v[72:75], v[112:115]
  v_mfma_f32_16x16x32_bf16 v[116:119], v[80:83], v[72:75], v[116:119]
  v_mfma_f32_16x16x32_bf16 v[120:123], v[84:87], v[72:75], v[120:123]
  v_mfma_f32_16x16x32_bf16 v[124:127], v[88:91], v[72:75], v[124:127]
  v_mfma_f32_16x16x32_bf16 v[128:131], v[68:71], v[68:71], v[128:131]
  v_mfma_f32_16x16x32_bf16 v[132:135], v[68:71], v[40:43], v[132:135]
  v_mfma_f32_16x16x32_bf16 v[136:139], v[40:43], v[76:79], v[136:139]
  s_barrier
  s_lshl_b32 s12, s81, 1
  s_add_u32 s12, s12, s82
  s_lshl_b32 s12, s12, 6
  s_mov_b32 s88, 0x22222222
  s_mov_b32 s89, 0x22222222
  s_mov_b32 s90, 0x44444444
  s_mov_b32 s91, 0x44444444
  s_mov_b32 s92, 0x88888888
  s_mov_b32 s93, 0x88888888
  v_lshlrev_b32 v10, 2, v4
  v_add_u32 v10, s12, v10
  v_lshlrev_b32 v11, 4, v3
  v_add_u32 v11, s12, v11
  v_cndmask_b32 v14, v128, v129, s[88:89]
  v_cndmask_b32 v14, v14, v130, s[90:91]
  v_cndmask_b32 v14, v14, v131, s[92:93]
  s_lshl_b32 s13, s84, 6
  v_lshlrev_b32 v12, 2, v4
  v_add_u32 v12, s13, v12
  s_mov_b32 exec_lo, 0x00F0000F
  s_mov_b32 exec_hi, 0xF0000F00
  ds_write_b32 v10, v14 offset:512
  s_mov_b32 exec_lo, 0x00010001
  s_mov_b32 exec_hi, 0x00010001
  ds_write_b128 v11, v[132:135] offset:0
  s_mov_b32 exec_lo, 0xffff
  s_mov_b32 exec_hi, 0
  ds_write_b32 v12, v136 offset:1024
  s_mov_b64 exec, -1
  s_waitcnt lgkmcnt(0)
  s_barrier
  s_mov_b32 s88, 0x358637bd
  s_mov_b32 s89, 0x358637bd
  s_mov_b32 s90, 0x3fb8aa3b
  s_mov_b32 s91, 0x3fb8aa3b
  s_mov_b32 s92, 0x3acccccd
  s_mov_b32 s93, 0x3acccccd
  v_mov_b32 v15, 2560
  ds_read_b32 v13, v15
  s_xor_b32 s12, s82, 0
  s_lshl_b32 s13, s81, 1
  s_add_u32 s12, s12, s13
  s_lshl_b32 s12, s12, 6
  v_lshlrev_b32 v10, 2, v4
  v_add_u32 v10, s12, v10
  ds_read_b32 v44, v10 offset:0
  ds_read_b32 v48, v10 offset:512
  s_xor_b32 s12, s82, 1
  s_lshl_b32 s13, s81, 1
  s_add_u32 s12, s12, s13
  s_lshl_b32 s12, s12, 6
  v_lshlrev_b32 v10, 2, v4
  v_add_u32 v10, s12, v10
  ds_read_b32 v46, v10 offset:0
  ds_read_b32 v50, v10 offset:512
  s_lshl_b32 s13, s84, 6
  v_lshlrev_b32 v12, 4, v3
  v_add_u32 v12, s13, v12
  ds_read_b128 v[56:59], v12 offset:1024
  s_lshl_b32 s13, s85, 6
  v_lshlrev_b32 v12, 4, v3
  v_add_u32 v12, s13, v12
  ds_read_b128 v[60:63], v12 offset:1024
  s_lshl_b32 s13, s86, 6
  v_lshlrev_b32 v12, 4, v3
  v_add_u32 v12, s13, v12
  ds_read_b128 v[64:67], v12 offset:1024
  s_lshl_b32 s13, s87, 6
  v_lshlrev_b32 v12, 4, v3
  v_add_u32 v12, s13, v12
  ds_read_b128 v[68:71], v12 offset:1024
  s_waitcnt lgkmcnt(0)
  v_readfirstlane_b32 s10, v13
  s_nop 1
  s_and_b32 s10, s10, 1
  v_pk_mul_f32 v[44:45], v[44:45], s[92:93]
  v_pk_mul_f32 v[48:49], v[48:49], s[92:93]
  v_pk_fma_f32 v[48:49], v[44:45], v[44:45], v[48:49] neg_lo:[1,0,0] neg_hi:[1,0,0]
  v_pk_mul_f32 v[46:47], v[46:47], s[92:93]
  v_pk_mul_f32 v[50:51], v[50:51], s[92:93]
  v_pk_fma_f32 v[50:51], v[46:47], v[46:47], v[50:51] neg_lo:[1,0,0] neg_hi:[1,0,0]
  v_max_f32 v48, 0, v48
  v_add_f32 v48, 0x3727c5ac, v48
  v_rsq_f32 v48, v48
  v_max_f32 v50, 0, v50
  v_add_f32 v50, 0x3727c5ac, v50
  v_rsq_f32 v50, v50
  v_pk_mul_f32 v[52:53], v[48:49], s[90:91]
  v_pk_mul_f32 v[54:55], v[50:51], s[90:91]
  s_and_b32 s95, s81, 1
  v_pk_fma_f32 v[96:97], v[56:57], v[44:45], v[96:97] op_sel_hi:[1,0,1] neg_lo:[1,0,0] neg_hi:[1,0,0]
  v_pk_mul_f32 v[16:17], v[96:97], v[52:53] op_sel_hi:[1,0]
  v_pk_fma_f32 v[96:97], v[96:97], v[48:49], s[88:89] op_sel_hi:[1,0,1]
  v_pk_fma_f32 v[98:99], v[58:59], v[44:45], v[98:99] op_sel_hi:[1,0,1] neg_lo:[1,0,0] neg_hi:[1,0,0]
  v_pk_mul_f32 v[18:19], v[98:99], v[52:53] op_sel_hi:[1,0]
  v_pk_fma_f32 v[98:99], v[98:99], v[48:49], s[88:89] op_sel_hi:[1,0,1]
  v_min_f32 v16, 0, v16
  v_min_f32 v17, 0, v17
  v_min_f32 v18, 0, v18
  v_min_f32 v19, 0, v19
  v_exp_f32 v16, v16
  v_exp_f32 v17, v17
  v_exp_f32 v18, v18
  v_exp_f32 v19, v19
  v_max_f32 v96, 0x358637bd, v96
  v_max_f32 v97, 0x358637bd, v97
  v_max_f32 v98, 0x358637bd, v98
  v_max_f32 v99, 0x358637bd, v99
  v_add_f32 v96, v96, v16
  v_add_f32 v97, v97, v17
  v_add_f32 v98, v98, v18
  v_add_f32 v99, v99, v19
  v_cvt_pk_bf16_f32 v24, v96, v97
  v_cvt_pk_bf16_f32 v25, v98, v99
  v_pk_fma_f32 v[100:101], v[60:61], v[44:45], v[100:101] op_sel_hi:[1,0,1] neg_lo:[1,0,0] neg_hi:[1,0,0]
  v_pk_mul_f32 v[16:17], v[100:101], v[52:53] op_sel_hi:[1,0]
  v_pk_fma_f32 v[100:101], v[100:101], v[48:49], s[88:89] op_sel_hi:[1,0,1]
  v_pk_fma_f32 v[102:103], v[62:63], v[44:45], v[102:103] op_sel_hi:[1,0,1] neg_lo:[1,0,0] neg_hi:[1,0,0]
  v_pk_mul_f32 v[18:19], v[102:103], v[52:53] op_sel_hi:[1,0]
  v_pk_fma_f32 v[102:103], v[102:103], v[48:49], s[88:89] op_sel_hi:[1,0,1]
  v_min_f32 v16, 0, v16
  v_min_f32 v17, 0, v17
  v_min_f32 v18, 0, v18
  v_min_f32 v19, 0, v19
  v_exp_f32 v16, v16
  v_exp_f32 v17, v17
  v_exp_f32 v18, v18
  v_exp_f32 v19, v19
  v_max_f32 v100, 0x358637bd, v100
  v_max_f32 v101, 0x358637bd, v101
  v_max_f32 v102, 0x358637bd, v102
  v_max_f32 v103, 0x358637bd, v103
  v_add_f32 v100, v100, v16
  v_add_f32 v101, v101, v17
  v_add_f32 v102, v102, v18
  v_add_f32 v103, v103, v19
  v_cvt_pk_bf16_f32 v26, v100, v101
  v_cvt_pk_bf16_f32 v27, v102, v103
  s_cmp_eq_u32 s95, 0
  s_cbranch_scc1 L_sw_2
  v_swap_b32 v24, v26
  v_swap_b32 v25, v27
L_sw_2:
  s_lshl_b32 s12, s4, 4
  s_lshl_b32 s13, s6, 3
  s_add_u32 s12, s12, s13
  s_lshl_b32 s13, s81, 1
  s_add_u32 s12, s12, s13
  s_xor_b32 s13, s82, 0
  s_add_u32 s12, s12, s13
  s_mul_i32 s12, s12, 20
  s_lshl_b32 s13, s7, 2
  s_add_u32 s12, s12, s13
  s_lshl_b32 s13, s82, 1
  s_add_u32 s12, s12, s13
  s_lshr_b32 s13, s81, 1
  s_xor_b32 s13, s13, 0
  s_add_u32 s12, s12, s13
  s_lshl_b32 s12, s12, 10
  s_add_u32 s12, s12, 1048576
  s_cmp_eq_u32 s10, 0
  s_cbranch_scc1 L_hs_3
  buffer_store_dwordx4 v[24:27], v2, s[48:51], s12 offen
  s_branch L_hs_4
L_hs_3:
  buffer_store_dwordx4 v[24:27], v2, s[48:51], s12 offen sc1
L_hs_4:
  v_pk_fma_f32 v[104:105], v[64:65], v[44:45], v[104:105] op_sel_hi:[1,0,1] neg_lo:[1,0,0] neg_hi:[1,0,0]
  v_pk_mul_f32 v[16:17], v[104:105], v[52:53] op_sel_hi:[1,0]
  v_pk_fma_f32 v[104:105], v[104:105], v[48:49], s[88:89] op_sel_hi:[1,0,1]
  v_pk_fma_f32 v[106:107], v[66:67], v[44:45], v[106:107] op_sel_hi:[1,0,1] neg_lo:[1,0,0] neg_hi:[1,0,0]
  v_pk_mul_f32 v[18:19], v[106:107], v[52:53] op_sel_hi:[1,0]
  v_pk_fma_f32 v[106:107], v[106:107], v[48:49], s[88:89] op_sel_hi:[1,0,1]
  v_min_f32 v16, 0, v16
  v_min_f32 v17, 0, v17
  v_min_f32 v18, 0, v18
  v_min_f32 v19, 0, v19
  v_exp_f32 v16, v16
  v_exp_f32 v17, v17
  v_exp_f32 v18, v18
  v_exp_f32 v19, v19
  v_max_f32 v104, 0x358637bd, v104
  v_max_f32 v105, 0x358637bd, v105
  v_max_f32 v106, 0x358637bd, v106
  v_max_f32 v107, 0x358637bd, v107
  v_add_f32 v104, v104, v16
  v_add_f32 v105, v105, v17
  v_add_f32 v106, v106, v18
  v_add_f32 v107, v107, v19
  v_cvt_pk_bf16_f32 v28, v104, v105
  v_cvt_pk_bf16_f32 v29, v106, v107
  v_pk_fma_f32 v[108:109], v[68:69], v[44:45], v[108:109] op_sel_hi:[1,0,1] neg_lo:[1,0,0] neg_hi:[1,0,0]
  v_pk_mul_f32 v[16:17], v[108:109], v[52:53] op_sel_hi:[1,0]
  v_pk_fma_f32 v[108:109], v[108:109], v[48:49], s[88:89] op_sel_hi:[1,0,1]
  v_pk_fma_f32 v[110:111], v[70:71], v[44:45], v[110:111] op_sel_hi:[1,0,1] neg_lo:[1,0,0] neg_hi:[1,0,0]
  v_pk_mul_f32 v[18:19], v[110:111], v[52:53] op_sel_hi:[1,0]
  v_pk_fma_f32 v[110:111], v[110:111], v[48:49], s[88:89] op_sel_hi:[1,0,1]
  v_min_f32 v16, 0, v16
  v_min_f32 v17, 0, v17
  v_min_f32 v18, 0, v18
  v_min_f32 v19, 0, v19
  v_exp_f32 v16, v16
  v_exp_f32 v17, v17
  v_exp_f32 v18, v18
  v_exp_f32 v19, v19
  v_max_f32 v108, 0x358637bd, v108
  v_max_f32 v109, 0x358637bd, v109
  v_max_f32 v110, 0x358637bd, v110
  v_max_f32 v111, 0x358637bd, v111
  v_add_f32 v108, v108, v16
  v_add_f32 v109, v109, v17
  v_add_f32 v110, v110, v18
  v_add_f32 v111, v111, v19
  v_cvt_pk_bf16_f32 v30, v108, v109
  v_cvt_pk_bf16_f32 v31, v110, v111
  s_cmp_eq_u32 s95, 0
  s_cbranch_scc1 L_sw_5
  v_swap_b32 v28, v30
  v_swap_b32 v29, v31
L_sw_5:
  s_lshl_b32 s12, s4, 4
  s_lshl_b32 s13, s6, 3
  s_add_u32 s12, s12, s13
  s_lshl_b32 s13, s81, 1
  s_add_u32 s12, s12, s13
  s_xor_b32 s13, s82, 0
  s_add_u32 s12, s12, s13
  s_mul_i32 s12, s12, 20
  s_lshl_b32 s13, s7, 2
  s_add_u32 s12, s12, s13
  s_lshl_b32 s13, s82, 1
  s_add_u32 s12, s12, s13
  s_lshr_b32 s13, s81, 1
  s_xor_b32 s13, s13, 1
  s_add_u32 s12, s12, s13
  s_lshl_b32 s12, s12, 10
  s_add_u32 s12, s12, 1048576
  s_cmp_eq_u32 s10, 0
  s_cbranch_scc1 L_hs_6
  buffer_store_dwordx4 v[28:31], v2, s[48:51], s12 offen
  s_branch L_hs_7
L_hs_6:
  buffer_store_dwordx4 v[28:31], v2, s[48:51], s12 offen sc1
L_hs_7:
  v_pk_fma_f32 v[112:113], v[56:57], v[46:47], v[112:113] op_sel_hi:[1,0,1] neg_lo:[1,0,0] neg_hi:[1,0,0]
  v_pk_mul_f32 v[16:17], v[112:113], v[54:55] op_sel_hi:[1,0]
  v_pk_fma_f32 v[112:113], v[112:113], v[50:51], s[88:89] op_sel_hi:[1,0,1]
  v_pk_fma_f32 v[114:115], v[58:59], v[46:47], v[114:115] op_sel_hi:[1,0,1] neg_lo:[1,0,0] neg_hi:[1,0,0]
  v_pk_mul_f32 v[18:19], v[114:115], v[54:55] op_sel_hi:[1,0]
  v_pk_fma_f32 v[114:115], v[114:115], v[50:51], s[88:89] op_sel_hi:[1,0,1]
  v_min_f32 v16, 0, v16
  v_min_f32 v17, 0, v17
  v_min_f32 v18, 0, v18
  v_min_f32 v19, 0, v19
  v_exp_f32 v16, v16
  v_exp_f32 v17, v17
  v_exp_f32 v18, v18
  v_exp_f32 v19, v19
  v_max_f32 v112, 0x358637bd, v112
  v_max_f32 v113, 0x358637bd, v113
  v_max_f32 v114, 0x358637bd, v114
  v_max_f32 v115, 0x358637bd, v115
  v_add_f32 v112, v112, v16
  v_add_f32 v113, v113, v17
  v_add_f32 v114, v114, v18
  v_add_f32 v115, v115, v19
  v_cvt_pk_bf16_f32 v24, v112, v113
  v_cvt_pk_bf16_f32 v25, v114, v115
  v_pk_fma_f32 v[116:117], v[60:61], v[46:47], v[116:117] op_sel_hi:[1,0,1] neg_lo:[1,0,0] neg_hi:[1,0,0]
  v_pk_mul_f32 v[16:17], v[116:117], v[54:55] op_sel_hi:[1,0]
  v_pk_fma_f32 v[116:117], v[116:117], v[50:51], s[88:89] op_sel_hi:[1,0,1]
  v_pk_fma_f32 v[118:119], v[62:63], v[46:47], v[118:119] op_sel_hi:[1,0,1] neg_lo:[1,0,0] neg_hi:[1,0,0]
  v_pk_mul_f32 v[18:19], v[118:119], v[54:55] op_sel_hi:[1,0]
  v_pk_fma_f32 v[118:119], v[118:119], v[50:51], s[88:89] op_sel_hi:[1,0,1]
  v_min_f32 v16, 0, v16
  v_min_f32 v17, 0, v17
  v_min_f32 v18, 0, v18
  v_min_f32 v19, 0, v19
  v_exp_f32 v16, v16
  v_exp_f32 v17, v17
  v_exp_f32 v18, v18
  v_exp_f32 v19, v19
  v_max_f32 v116, 0x358637bd, v116
  v_max_f32 v117, 0x358637bd, v117
  v_max_f32 v118, 0x358637bd, v118
  v_max_f32 v119, 0x358637bd, v119
  v_add_f32 v116, v116, v16
  v_add_f32 v117, v117, v17
  v_add_f32 v118, v118, v18
  v_add_f32 v119, v119, v19
  v_cvt_pk_bf16_f32 v26, v116, v117
  v_cvt_pk_bf16_f32 v27, v118, v119
  s_cmp_eq_u32 s95, 0
  s_cbranch_scc1 L_sw_8
  v_swap_b32 v24, v26
  v_swap_b32 v25, v27
L_sw_8:
  s_lshl_b32 s12, s4, 4
  s_lshl_b32 s13, s6, 3
  s_add_u32 s12, s12, s13
  s_lshl_b32 s13, s81, 1
  s_add_u32 s12, s12, s13
  s_xor_b32 s13, s82, 1
  s_add_u32 s12, s12, s13
  s_mul_i32 s12, s12, 20
  s_lshl_b32 s13, s7, 2
  s_add_u32 s12, s12, s13
  s_lshl_b32 s13, s82, 1
  s_add_u32 s12, s12, s13
  s_lshr_b32 s13, s81, 1
  s_xor_b32 s13, s13, 0
  s_add_u32 s12, s12, s13
  s_lshl_b32 s12, s12, 10
  s_add_u32 s12, s12, 1048576
  s_cmp_eq_u32 s10, 0
  s_cbranch_scc1 L_hs_9
  buffer_store_dwordx4 v[24:27], v2, s[48:51], s12 offen
  s_branch L_hs_10
L_hs_9:
  buffer_store_dwordx4 v[24:27], v2, s[48:51], s12 offen sc1
L_hs_10:
  v_pk_fma_f32 v[120:121], v[64:65], v[46:47], v[120:121] op_sel_hi:[1,0,1] neg_lo:[1,0,0] neg_hi:[1,0,0]
  v_pk_mul_f32 v[16:17], v[120:121], v[54:55] op_sel_hi:[1,0]
  v_pk_fma_f32 v[120:121], v[120:121], v[50:51], s[88:89] op_sel_hi:[1,0,1]
  v_pk_fma_f32 v[122:123], v[66:67], v[46:47], v[122:123] op_sel_hi:[1,0,1] neg_lo:[1,0,0] neg_hi:[1,0,0]
  v_pk_mul_f32 v[18:19], v[122:123], v[54:55] op_sel_hi:[1,0]
  v_pk_fma_f32 v[122:123], v[122:123], v[50:51], s[88:89] op_sel_hi:[1,0,1]
  v_min_f32 v16, 0, v16
  v_min_f32 v17, 0, v17
  v_min_f32 v18, 0, v18
  v_min_f32 v19, 0, v19
  v_exp_f32 v16, v16
  v_exp_f32 v17, v17
  v_exp_f32 v18, v18
  v_exp_f32 v19, v19
  v_max_f32 v120, 0x358637bd, v120
  v_max_f32 v121, 0x358637bd, v121
  v_max_f32 v122, 0x358637bd, v122
  v_max_f32 v123, 0x358637bd, v123
  v_add_f32 v120, v120, v16
  v_add_f32 v121, v121, v17
  v_add_f32 v122, v122, v18
  v_add_f32 v123, v123, v19
  v_cvt_pk_bf16_f32 v28, v120, v121
  v_cvt_pk_bf16_f32 v29, v122, v123
  v_pk_fma_f32 v[124:125], v[68:69], v[46:47], v[124:125] op_sel_hi:[1,0,1] neg_lo:[1,0,0] neg_hi:[1,0,0]
  v_pk_mul_f32 v[16:17], v[124:125], v[54:55] op_sel_hi:[1,0]
  v_pk_fma_f32 v[124:125], v[124:125], v[50:51], s[88:89] op_sel_hi:[1,0,1]
  v_pk_fma_f32 v[126:127], v[70:71], v[46:47], v[126:127] op_sel_hi:[1,0,1] neg_lo:[1,0,0] neg_hi:[1,0,0]
  v_pk_mul_f32 v[18:19], v[126:127], v[54:55] op_sel_hi:[1,0]
  v_pk_fma_f32 v[126:127], v[126:127], v[50:51], s[88:89] op_sel_hi:[1,0,1]
  v_min_f32 v16, 0, v16
  v_min_f32 v17, 0, v17
  v_min_f32 v18, 0, v18
  v_min_f32 v19, 0, v19
  v_exp_f32 v16, v16
  v_exp_f32 v17, v17
  v_exp_f32 v18, v18
  v_exp_f32 v19, v19
  v_max_f32 v124, 0x358637bd, v124
  v_max_f32 v125, 0x358637bd, v125
  v_max_f32 v126, 0x358637bd, v126
  v_max_f32 v127, 0x358637bd, v127
  v_add_f32 v124, v124, v16
  v_add_f32 v125, v125, v17
  v_add_f32 v126, v126, v18
  v_add_f32 v127, v127, v19
  v_cvt_pk_bf16_f32 v30, v124, v125
  v_cvt_pk_bf16_f32 v31, v126, v127
  s_cmp_eq_u32 s95, 0
  s_cbranch_scc1 L_sw_11
  v_swap_b32 v28, v30
  v_swap_b32 v29, v31
L_sw_11:
  s_lshl_b32 s12, s4, 4
  s_lshl_b32 s13, s6, 3
  s_add_u32 s12, s12, s13
  s_lshl_b32 s13, s81, 1
  s_add_u32 s12, s12, s13
  s_xor_b32 s13, s82, 1
  s_add_u32 s12, s12, s13
  s_mul_i32 s12, s12, 20
  s_lshl_b32 s13, s7, 2
  s_add_u32 s12, s12, s13
  s_lshl_b32 s13, s82, 1
  s_add_u32 s12, s12, s13
  s_lshr_b32 s13, s81, 1
  s_xor_b32 s13, s13, 1
  s_add_u32 s12, s12, s13
  s_lshl_b32 s12, s12, 10
  s_add_u32 s12, s12, 1048576
  s_cmp_eq_u32 s10, 0
  s_cbranch_scc1 L_hs_12
  buffer_store_dwordx4 v[28:31], v2, s[48:51], s12 offen
  s_branch L_hs_13
L_hs_12:
  buffer_store_dwordx4 v[28:31], v2, s[48:51], s12 offen sc1
L_hs_13:
  s_branch L_p1_done
L_p1_kv:
  s_nop 3
  s_and_b32 s12, s81, 1
  s_xor_b32 s12, s12, 0
  s_lshl_b32 s13, s82, 1
  s_add_u32 s12, s12, s13
  s_mov_b32 s84, s12
  s_lshl_b32 s12, s12, 1
  v_xor_b32 v14, s12, v12
  v_lshl_add_u32 v28, v14, 4, v13
  v_add_u32 v29, 0x10000, v28
  v_add_u32 v30, 0x20000, v28
  s_and_b32 s12, s81, 1
  s_xor_b32 s12, s12, 1
  s_lshl_b32 s13, s82, 1
  s_add_u32 s12, s12, s13
  s_mov_b32 s85, s12
  s_lshl_b32 s12, s12, 1
  v_xor_b32 v14, s12, v12
  v_lshl_add_u32 v31, v14, 4, v13
  v_add_u32 v32, 0x10000, v31
  v_add_u32 v33, 0x20000, v31
  s_and_b32 s12, s81, 1
  s_xor_b32 s12, s12, 0
  s_lshl_b32 s13, s82, 1
  s_add_u32 s12, s12, s13
  s_add_u32 s12, s12, 4
  s_mov_b32 s86, s12
  s_lshl_b32 s12, s12, 1
  v_xor_b32 v14, s12, v12
  v_lshl_add_u32 v34, v14, 4, v13
  v_add_u32 v35, 0x10000, v34
  v_add_u32 v36, 0x20000, v34
  s_and_b32 s12, s81, 1
  s_xor_b32 s12, s12, 1
  s_lshl_b32 s13, s82, 1
  s_add_u32 s12, s12, s13
  s_add_u32 s12, s12, 4
  s_mov_b32 s87, s12
  s_lshl_b32 s12, s12, 1
  v_xor_b32 v14, s12, v12
  v_lshl_add_u32 v37, v14, 4, v13
  v_add_u32 v38, 0x10000, v37
  v_add_u32 v39, 0x20000, v37
  s_barrier
  ds_read_b128 v[44:47], v16 offset:0
  ds_read_b128 v[48:51], v19 offset:0
  ds_read_b64_tr_b16 v[52:53], v28 offset:0
  ds_read_b64_tr_b16 v[54:55], v28 offset:1024
  ds_read_b64_tr_b16 v[56:57], v31 offset:0
  ds_read_b64_tr_b16 v[58:59], v31 offset:1024
  ds_read_b64_tr_b16 v[60:61], v34 offset:0
  ds_read_b64_tr_b16 v[62:63], v34 offset:1024
  ds_read_b64_tr_b16 v[64:65], v37 offset:0
  ds_read_b64_tr_b16 v[66:67], v37 offset:1024
  s_waitcnt lgkmcnt(0)
  v_mfma_f32_16x16x32_bf16 v[96:99], v[44:47], v[52:55], 0
  ds_read_b128 v[68:71], v22 offset:0
  v_mfma_f32_16x16x32_bf16 v[100:103], v[44:47], v[56:59], 0
  ds_read_b128 v[72:75], v25 offset:0
  v_mfma_f32_16x16x32_bf16 v[104:107], v[44:47], v[60:63], 0
  ds_read_b64_tr_b16 v[76:77], v28 offset:8192
  v_mfma_f32_16x16x32_bf16 v[108:111], v[44:47], v[64:67], 0
  ds_read_b64_tr_b16 v[78:79], v28 offset:9216
  v_mfma_f32_16x16x32_bf16 v[112:115], v[48:51], v[52:55], 0
  ds_read_b64_tr_b16 v[80:81], v31 offset:8192
  v_mfma_f32_16x16x32_bf16 v[116:119], v[48:51], v[56:59], 0
  ds_read_b64_tr_b16 v[82:83], v31 offset:9216
  v_mfma_f32_16x16x32_bf16 v[120:123], v[48:51], v[60:63], 0
  ds_read_b64_tr_b16 v[84:85], v34 offset:8192
  v_mfma_f32_16x16x32_bf16 v[124:127], v[48:51], v[64:67], 0
  ds_read_b64_tr_b16 v[86:87], v34 offset:9216
  v_mfma_f32_16x16x32_bf16 v[128:131], v[44:47], v[44:47], 0
  ds_read_b64_tr_b16 v[88:89], v37 offset:8192
  v_mfma_f32_16x16x32_bf16 v[132:135], v[44:47], v[40:43], 0
  ds_read_b64_tr_b16 v[90:91], v37 offset:9216
  s_cmp_lt_u32 s81, 2
  s_cbranch_scc0 L_cs_14
  v_mfma_f32_16x16x32_bf16 v[136:139], v[40:43], v[52:55], 0
  s_branch L_cs_15
L_cs_14:
  s_nop 6
  v_mfma_f32_16x16x32_bf16 v[136:139], v[40:43], v[60:63], 0
L_cs_15:
  s_waitcnt lgkmcnt(0)
  s_barrier
  v_mfma_f32_16x16x32_bf16 v[96:99], v[68:71], v[76:79], v[96:99]
  ds_read_b128 v[44:47], v16 offset:32768
  v_mfma_f32_16x16x32_bf16 v[100:103], v[68:71], v[80:83], v[100:103]
  ds_read_b128 v[48:51], v19 offset:32768
  v_mfma_f32_16x16x32_bf16 v[104:107], v[68:71], v[84:87], v[104:107]
  ds_read_b64_tr_b16 v[52:53], v28 offset:32768
  v_mfma_f32_16x16x32_bf16 v[108:111], v[68:71], v[88:91], v[108:111]
  ds_read_b64_tr_b16 v[54:55], v28 offset:33792
  v_mfma_f32_16x16x32_bf16 v[112:115], v[72:75], v[76:79], v[112:115]
  ds_read_b64_tr_b16 v[56:57], v31 offset:32768
  v_mfma_f32_16x16x32_bf16 v[116:119], v[72:75], v[80:83], v[116:119]
  ds_read_b64_tr_b16 v[58:59], v31 offset:33792
  v_mfma_f32_16x16x32_bf16 v[120:123], v[72:75], v[84:87], v[120:123]
  ds_read_b64_tr_b16 v[60:61], v34 offset:32768
  v_mfma_f32_16x16x32_bf16 v[124:127], v[72:75], v[88:91], v[124:127]
  ds_read_b64_tr_b16 v[62:63], v34 offset:33792
  v_mfma_f32_16x16x32_bf16 v[128:131], v[68:71], v[68:71], v[128:131]
  ds_read_b64_tr_b16 v[64:65], v37 offset:32768
  v_mfma_f32_16x16x32_bf16 v[132:135], v[68:71], v[40:43], v[132:135]
  ds_read_b64_tr_b16 v[66:67], v37 offset:33792
  s_cmp_lt_u32 s81, 2
  s_cbranch_scc0 L_cs_16
  v_mfma_f32_16x16x32_bf16 v[136:139], v[40:43], v[76:79], v[136:139]
  s_branch L_cs_17
L_cs_16:
  v_mfma_f32_16x16x32_bf16 v[136:139], v[40:43], v[84:87], v[136:139]
L_cs_17:
  s_waitcnt lgkmcnt(0)
  v_mfma_f32_16x16x32_bf16 v[96:99], v[44:47], v[52:55], v[96:99]
  ds_read_b128 v[68:71], v22 offset:32768
  v_mfma_f32_16x16x32_bf16 v[100:103], v[44:47], v[56:59], v[100:103]
  ds_read_b128 v[72:75], v25 offset:32768
  v_mfma_f32_16x16x32_bf16 v[104:107], v[44:47], v[60:63], v[104:107]
  ds_read_b64_tr_b16 v[76:77], v28 offset:40960
  v_mfma_f32_16x16x32_bf16 v[108:111], v[44:47], v[64:67], v[108:111]
  ds_read_b64_tr_b16 v[78:79], v28 offset:41984
  v_mfma_f32_16x16x32_bf16 v[112:115], v[48:51], v[52:55], v[112:115]
  ds_read_b64_tr_b16 v[80:81], v31 offset:40960
  v_mfma_f32_16x16x32_bf16 v[116:119], v[48:51], v[56:59], v[116:119]
  ds_read_b64_tr_b16 v[82:83], v31 offset:41984
  v_mfma_f32_16x16x32_bf16 v[120:123], v[48:51], v[60:63], v[120:123]
  ds_read_b64_tr_b16 v[84:85], v34 offset:40960
  v_mfma_f32_16x16x32_bf16 v[124:127], v[48:51], v[64:67], v[124:127]
  ds_read_b64_tr_b16 v[86:87], v34 offset:41984
  v_mfma_f32_16x16x32_bf16 v[128:131], v[44:47], v[44:47], v[128:131]
  ds_read_b64_tr_b16 v[88:89], v37 offset:40960
  v_mfma_f32_16x16x32_bf16 v[132:135], v[44:47], v[40:43], v[132:135]
  ds_read_b64_tr_b16 v[90:91], v37 offset:41984
  s_cmp_lt_u32 s81, 2
  s_cbranch_scc0 L_cs_18
  v_mfma_f32_16x16x32_bf16 v[136:139], v[40:43], v[52:55], v[136:139]
  s_branch L_cs_19
L_cs_18:
  v_mfma_f32_16x16x32_bf16 v[136:139], v[40:43], v[60:63], v[136:139]
L_cs_19:
  s_waitcnt lgkmcnt(0)
  s_barrier
  v_mfma_f32_16x16x32_bf16 v[96:99], v[68:71], v[76:79], v[96:99]
  ds_read_b128 v[44:47], v17 offset:0
  v_mfma_f32_16x16x32_bf16 v[100:103], v[68:71], v[80:83], v[100:103]
  ds_read_b128 v[48:51], v20 offset:0
  v_mfma_f32_16x16x32_bf16 v[104:107], v[68:71], v[84:87], v[104:107]
  ds_read_b64_tr_b16 v[52:53], v29 offset:0
  v_mfma_f32_16x16x32_bf16 v[108:111], v[68:71], v[88:91], v[108:111]
  ds_read_b64_tr_b16 v[54:55], v29 offset:1024
  v_mfma_f32_16x16x32_bf16 v[112:115], v[72:75], v[76:79], v[112:115]
  ds_read_b64_tr_b16 v[56:57], v32 offset:0
  v_mfma_f32_16x16x32_bf16 v[116:119], v[72:75], v[80:83], v[116:119]
  ds_read_b64_tr_b16 v[58:59], v32 offset:1024
  v_mfma_f32_16x16x32_bf16 v[120:123], v[72:75], v[84:87], v[120:123]
  ds_read_b64_tr_b16 v[60:61], v35 offset:0
  v_mfma_f32_16x16x32_bf16 v[124:127], v[72:75], v[88:91], v[124:127]
  ds_read_b64_tr_b16 v[62:63], v35 offset:1024
  v_mfma_f32_16x16x32_bf16 v[128:131], v[68:71], v[68:71], v[128:131]
  ds_read_b64_tr_b16 v[64:65], v38 offset:0
  v_mfma_f32_16x16x32_bf16 v[132:135], v[68:71], v[40:43], v[132:135]
  ds_read_b64_tr_b16 v[66:67], v38 offset:1024
  s_cmp_lt_u32 s81, 2
  s_cbranch_scc0 L_cs_20
  v_mfma_f32_16x16x32_bf16 v[136:139], v[40:43], v[76:79], v[136:139]
  s_branch L_cs_21
L_cs_20:
  v_mfma_f32_16x16x32_bf16 v[136:139], v[40:43], v[84:87], v[136:139]
L_cs_21:
  s_waitcnt lgkmcnt(0)
  v_mfma_f32_16x16x32_bf16 v[96:99], v[44:47], v[52:55], v[96:99]
  ds_read_b128 v[68:71], v23 offset:0
  v_mfma_f32_16x16x32_bf16 v[100:103], v[44:47], v[56:59], v[100:103]
  ds_read_b128 v[72:75], v26 offset:0
  v_mfma_f32_16x16x32_bf16 v[104:107], v[44:47], v[60:63], v[104:107]
  ds_read_b64_tr_b16 v[76:77], v29 offset:8192
  v_mfma_f32_16x16x32_bf16 v[108:111], v[44:47], v[64:67], v[108:111]
  ds_read_b64_tr_b16 v[78:79], v29 offset:9216
  v_mfma_f32_16x16x32_bf16 v[112:115], v[48:51], v[52:55], v[112:115]
  ds_read_b64_tr_b16 v[80:81], v32 offset:8192
  v_mfma_f32_16x16x32_bf16 v[116:119], v[48:51], v[56:59], v[116:119]
  ds_read_b64_tr_b16 v[82:83], v32 offset:9216
  v_mfma_f32_16x16x32_bf16 v[120:123], v[48:51], v[60:63], v[120:123]
  ds_read_b64_tr_b16 v[84:85], v35 offset:8192
  v_mfma_f32_16x16x32_bf16 v[124:127], v[48:51], v[64:67], v[124:127]
  ds_read_b64_tr_b16 v[86:87], v35 offset:9216
  v_mfma_f32_16x16x32_bf16 v[128:131], v[44:47], v[44:47], v[128:131]
  ds_read_b64_tr_b16 v[88:89], v38 offset:8192
  v_mfma_f32_16x16x32_bf16 v[132:135], v[44:47], v[40:43], v[132:135]
  ds_read_b64_tr_b16 v[90:91], v38 offset:9216
  s_cmp_lt_u32 s81, 2
  s_cbranch_scc0 L_cs_22
  v_mfma_f32_16x16x32_bf16 v[136:139], v[40:43], v[52:55], v[136:139]
  s_branch L_cs_23
L_cs_22:
  v_mfma_f32_16x16x32_bf16 v[136:139], v[40:43], v[60:63], v[136:139]
L_cs_23:
  s_waitcnt lgkmcnt(0)
  s_barrier
  v_mfma_f32_16x16x32_bf16 v[96:99], v[68:71], v[76:79], v[96:99]
  ds_read_b128 v[44:47], v17 offset:32768
  v_mfma_f32_16x16x32_bf16 v[100:103], v[68:71], v[80:83], v[100:103]
  ds_read_b128 v[48:51], v20 offset:32768
  v_mfma_f32_16x16x32_bf16 v[104:107], v[68:71], v[84:87], v[104:107]
  ds_read_b64_tr_b16 v[52:53], v29 offset:32768
  v_mfma_f32_16x16x32_bf16 v[108:111], v[68:71], v[88:91], v[108:111]
  ds_read_b64_tr_b16 v[54:55], v29 offset:33792
  v_mfma_f32_16x16x32_bf16 v[112:115], v[72:75], v[76:79], v[112:115]
  ds_read_b64_tr_b16 v[56:57], v32 offset:32768
  v_mfma_f32_16x16x32_bf16 v[116:119], v[72:75], v[80:83], v[116:119]
  ds_read_b64_tr_b16 v[58:59], v32 offset:33792
  v_mfma_f32_16x16x32_bf16 v[120:123], v[72:75], v[84:87], v[120:123]
  ds_read_b64_tr_b16 v[60:61], v35 offset:32768
  v_mfma_f32_16x16x32_bf16 v[124:127], v[72:75], v[88:91], v[124:127]
  ds_read_b64_tr_b16 v[62:63], v35 offset:33792
  v_mfma_f32_16x16x32_bf16 v[128:131], v[68:71], v[68:71], v[128:131]
  ds_read_b64_tr_b16 v[64:65], v38 offset:32768
  v_mfma_f32_16x16x32_bf16 v[132:135], v[68:71], v[40:43], v[132:135]
  ds_read_b64_tr_b16 v[66:67], v38 offset:33792
  s_cmp_lt_u32 s81, 2
  s_cbranch_scc0 L_cs_24
  v_mfma_f32_16x16x32_bf16 v[136:139], v[40:43], v[76:79], v[136:139]
  s_branch L_cs_25
L_cs_24:
  v_mfma_f32_16x16x32_bf16 v[136:139], v[40:43], v[84:87], v[136:139]
L_cs_25:
  s_waitcnt lgkmcnt(0)
  v_mfma_f32_16x16x32_bf16 v[96:99], v[44:47], v[52:55], v[96:99]
  ds_read_b128 v[68:71], v23 offset:32768
  v_mfma_f32_16x16x32_bf16 v[100:103], v[44:47], v[56:59], v[100:103]
  ds_read_b128 v[72:75], v26 offset:32768
  v_mfma_f32_16x16x32_bf16 v[104:107], v[44:47], v[60:63], v[104:107]
  ds_read_b64_tr_b16 v[76:77], v29 offset:40960
  v_mfma_f32_16x16x32_bf16 v[108:111], v[44:47], v[64:67], v[108:111]
  ds_read_b64_tr_b16 v[78:79], v29 offset:41984
  v_mfma_f32_16x16x32_bf16 v[112:115], v[48:51], v[52:55], v[112:115]
  ds_read_b64_tr_b16 v[80:81], v32 offset:40960
  v_mfma_f32_16x16x32_bf16 v[116:119], v[48:51], v[56:59], v[116:119]
  ds_read_b64_tr_b16 v[82:83], v32 offset:41984
  v_mfma_f32_16x16x32_bf16 v[120:123], v[48:51], v[60:63], v[120:123]
  ds_read_b64_tr_b16 v[84:85], v35 offset:40960
  v_mfma_f32_16x16x32_bf16 v[124:127], v[48:51], v[64:67], v[124:127]
  ds_read_b64_tr_b16 v[86:87], v35 offset:41984
  v_mfma_f32_16x16x32_bf16 v[128:131], v[44:47], v[44:47], v[128:131]
  ds_read_b64_tr_b16 v[88:89], v38 offset:40960
  v_mfma_f32_16x16x32_bf16 v[132:135], v[44:47], v[40:43], v[132:135]
  ds_read_b64_tr_b16 v[90:91], v38 offset:41984
  s_cmp_lt_u32 s81, 2
  s_cbranch_scc0 L_cs_26
  v_mfma_f32_16x16x32_bf16 v[136:139], v[40:43], v[52:55], v[136:139]
  s_branch L_cs_27
L_cs_26:
  v_mfma_f32_16x16x32_bf16 v[136:139], v[40:43], v[60:63], v[136:139]
L_cs_27:
  s_waitcnt lgkmcnt(0)
  s_barrier
  v_mfma_f32_16x16x32_bf16 v[96:99], v[68:71], v[76:79], v[96:99]
  ds_read_b128 v[44:47], v18 offset:0
  v_mfma_f32_16x16x32_bf16 v[100:103], v[68:71], v[80:83], v[100:103]
  ds_read_b128 v[48:51], v21 offset:0
  v_mfma_f32_16x16x32_bf16 v[104:107], v[68:71], v[84:87], v[104:107]
  ds_read_b64_tr_b16 v[52:53], v30 offset:0
  v_mfma_f32_16x16x32_bf16 v[108:111], v[68:71], v[88:91], v[108:111]
  ds_read_b64_tr_b16 v[54:55], v30 offset:1024
  v_mfma_f32_16x16x32_bf16 v[112:115], v[72:75], v[76:79], v[112:115]
  ds_read_b64_tr_b16 v[56:57], v33 offset:0
  v_mfma_f32_16x16x32_bf16 v[116:119], v[72:75], v[80:83], v[116:119]
  ds_read_b64_tr_b16 v[58:59], v33 offset:1024
  v_mfma_f32_16x16x32_bf16 v[120:123], v[72:75], v[84:87], v[120:123]
  ds_read_b64_tr_b16 v[60:61], v36 offset:0
  v_mfma_f32_16x16x32_bf16 v[124:127], v[72:75], v[88:91], v[124:127]
  ds_read_b64_tr_b16 v[62:63], v36 offset:1024
  v_mfma_f32_16x16x32_bf16 v[128:131], v[68:71], v[68:71], v[128:131]
  ds_read_b64_tr_b16 v[64:65], v39 offset:0
  v_mfma_f32_16x16x32_bf16 v[132:135], v[68:71], v[40:43], v[132:135]
  ds_read_b64_tr_b16 v[66:67], v39 offset:1024
  s_cmp_lt_u32 s81, 2
  s_cbranch_scc0 L_cs_28
  v_mfma_f32_16x16x32_bf16 v[136:139], v[40:43], v[76:79], v[136:139]
  s_branch L_cs_29
L_cs_28:
  v_mfma_f32_16x16x32_bf16 v[136:139], v[40:43], v[84:87], v[136:139]
L_cs_29:
  s_waitcnt lgkmcnt(0)
  v_mfma_f32_16x16x32_bf16 v[96:99], v[44:47], v[52:55], v[96:99]
  ds_read_b128 v[68:71], v24 offset:0
  v_mfma_f32_16x16x32_bf16 v[100:103], v[44:47], v[56:59], v[100:103]
  ds_read_b128 v[72:75], v27 offset:0
  v_mfma_f32_16x16x32_bf16 v[104:107], v[44:47], v[60:63], v[104:107]
  ds_read_b64_tr_b16 v[76:77], v30 offset:8192
  v_mfma_f32_16x16x32_bf16 v[108:111], v[44:47], v[64:67], v[108:111]
  ds_read_b64_tr_b16 v[78:79], v30 offset:9216
  v_mfma_f32_16x16x32_bf16 v[112:115], v[48:51], v[52:55], v[112:115]
  ds_read_b64_tr_b16 v[80:81], v33 offset:8192
  v_mfma_f32_16x16x32_bf16 v[116:119], v[48:51], v[56:59], v[116:119]
  ds_read_b64_tr_b16 v[82:83], v33 offset:9216
  v_mfma_f32_16x16x32_bf16 v[120:123], v[48:51], v[60:63], v[120:123]
  ds_read_b64_tr_b16 v[84:85], v36 offset:8192
  v_mfma_f32_16x16x32_bf16 v[124:127], v[48:51], v[64:67], v[124:127]
  ds_read_b64_tr_b16 v[86:87], v36 offset:9216
  v_mfma_f32_16x16x32_bf16 v[128:131], v[44:47], v[44:47], v[128:131]
  ds_read_b64_tr_b16 v[88:89], v39 offset:8192
  v_mfma_f32_16x16x32_bf16 v[132:135], v[44:47], v[40:43], v[132:135]
  ds_read_b64_tr_b16 v[90:91], v39 offset:9216
  s_cmp_lt_u32 s81, 2
  s_cbranch_scc0 L_cs_30
  v_mfma_f32_16x16x32_bf16 v[136:139], v[40:43], v[52:55], v[136:139]
  s_branch L_cs_31
L_cs_30:
  v_mfma_f32_16x16x32_bf16 v[136:139], v[40:43], v[60:63], v[136:139]
L_cs_31:
  s_waitcnt lgkmcnt(0)
  s_barrier
  v_mfma_f32_16x16x32_bf16 v[96:99], v[68:71], v[76:79], v[96:99]
  ds_read_b128 v[44:47], v16 offset:0
  v_mfma_f32_16x16x32_bf16 v[100:103], v[68:71], v[80:83], v[100:103]
  ds_read_b128 v[48:51], v19 offset:0
  v_mfma_f32_16x16x32_bf16 v[104:107], v[68:71], v[84:87], v[104:107]
  ds_read_b64_tr_b16 v[52:53], v28 offset:0
  v_mfma_f32_16x16x32_bf16 v[108:111], v[68:71], v[88:91], v[108:111]
  ds_read_b64_tr_b16 v[54:55], v28 offset:1024
  v_mfma_f32_16x16x32_bf16 v[112:115], v[72:75], v[76:79], v[112:115]
  ds_read_b64_tr_b16 v[56:57], v31 offset:0
  v_mfma_f32_16x16x32_bf16 v[116:119], v[72:75], v[80:83], v[116:119]
  ds_read_b64_tr_b16 v[58:59], v31 offset:1024
  v_mfma_f32_16x16x32_bf16 v[120:123], v[72:75], v[84:87], v[120:123]
  ds_read_b64_tr_b16 v[60:61], v34 offset:0
  v_mfma_f32_16x16x32_bf16 v[124:127], v[72:75], v[88:91], v[124:127]
  ds_read_b64_tr_b16 v[62:63], v34 offset:1024
  v_mfma_f32_16x16x32_bf16 v[128:131], v[68:71], v[68:71], v[128:131]
  ds_read_b64_tr_b16 v[64:65], v37 offset:0
  v_mfma_f32_16x16x32_bf16 v[132:135], v[68:71], v[40:43], v[132:135]
  ds_read_b64_tr_b16 v[66:67], v37 offset:1024
  s_cmp_lt_u32 s81, 2
  s_cbranch_scc0 L_cs_32
  v_mfma_f32_16x16x32_bf16 v[136:139], v[40:43], v[76:79], v[136:139]
  s_branch L_cs_33
L_cs_32:
  v_mfma_f32_16x16x32_bf16 v[136:139], v[40:43], v[84:87], v[136:139]
L_cs_33:
  s_waitcnt lgkmcnt(0)
  v_mfma_f32_16x16x32_bf16 v[96:99], v[44:47], v[52:55], v[96:99]
  ds_read_b128 v[68:71], v22 offset:0
  v_mfma_f32_16x16x32_bf16 v[100:103], v[44:47], v[56:59], v[100:103]
  ds_read_b128 v[72:75], v25 offset:0
  v_mfma_f32_16x16x32_bf16 v[104:107], v[44:47], v[60:63], v[104:107]
  ds_read_b64_tr_b16 v[76:77], v28 offset:8192
  v_mfma_f32_16x16x32_bf16 v[108:111], v[44:47], v[64:67], v[108:111]
  ds_read_b64_tr_b16 v[78:79], v28 offset:9216
  v_mfma_f32_16x16x32_bf16 v[112:115], v[48:51], v[52:55], v[112:115]
  ds_read_b64_tr_b16 v[80:81], v31 offset:8192
  v_mfma_f32_16x16x32_bf16 v[116:119], v[48:51], v[56:59], v[116:119]
  ds_read_b64_tr_b16 v[82:83], v31 offset:9216
  v_mfma_f32_16x16x32_bf16 v[120:123], v[48:51], v[60:63], v[120:123]
  ds_read_b64_tr_b16 v[84:85], v34 offset:8192
  v_mfma_f32_16x16x32_bf16 v[124:127], v[48:51], v[64:67], v[124:127]
  ds_read_b64_tr_b16 v[86:87], v34 offset:9216
  v_mfma_f32_16x16x32_bf16 v[128:131], v[44:47], v[44:47], v[128:131]
  ds_read_b64_tr_b16 v[88:89], v37 offset:8192
  v_mfma_f32_16x16x32_bf16 v[132:135], v[44:47], v[40:43], v[132:135]
  ds_read_b64_tr_b16 v[90:91], v37 offset:9216
  s_cmp_lt_u32 s81, 2
  s_cbranch_scc0 L_cs_34
  v_mfma_f32_16x16x32_bf16 v[136:139], v[40:43], v[52:55], v[136:139]
  s_branch L_cs_35
L_cs_34:
  v_mfma_f32_16x16x32_bf16 v[136:139], v[40:43], v[60:63], v[136:139]
L_cs_35:
  s_waitcnt lgkmcnt(0)
  s_barrier
  v_mfma_f32_16x16x32_bf16 v[96:99], v[68:71], v[76:79], v[96:99]
  ds_read_b128 v[44:47], v16 offset:32768
  v_mfma_f32_16x16x32_bf16 v[100:103], v[68:71], v[80:83], v[100:103]
  ds_read_b128 v[48:51], v19 offset:32768
  v_mfma_f32_16x16x32_bf16 v[104:107], v[68:71], v[84:87], v[104:107]
  ds_read_b64_tr_b16 v[52:53], v28 offset:32768
  v_mfma_f32_16x16x32_bf16 v[108:111], v[68:71], v[88:91], v[108:111]
  ds_read_b64_tr_b16 v[54:55], v28 offset:33792
  v_mfma_f32_16x16x32_bf16 v[112:115], v[72:75], v[76:79], v[112:115]
  ds_read_b64_tr_b16 v[56:57], v31 offset:32768
  v_mfma_f32_16x16x32_bf16 v[116:119], v[72:75], v[80:83], v[116:119]
  ds_read_b64_tr_b16 v[58:59], v31 offset:33792
  v_mfma_f32_16x16x32_bf16 v[120:123], v[72:75], v[84:87], v[120:123]
  ds_read_b64_tr_b16 v[60:61], v34 offset:32768
  v_mfma_f32_16x16x32_bf16 v[124:127], v[72:75], v[88:91], v[124:127]
  ds_read_b64_tr_b16 v[62:63], v34 offset:33792
  v_mfma_f32_16x16x32_bf16 v[128:131], v[68:71], v[68:71], v[128:131]
  ds_read_b64_tr_b16 v[64:65], v37 offset:32768
  v_mfma_f32_16x16x32_bf16 v[132:135], v[68:71], v[40:43], v[132:135]
  ds_read_b64_tr_b16 v[66:67], v37 offset:33792
  s_cmp_lt_u32 s81, 2
  s_cbranch_scc0 L_cs_36
  v_mfma_f32_16x16x32_bf16 v[136:139], v[40:43], v[76:79], v[136:139]
  s_branch L_cs_37
L_cs_36:
  v_mfma_f32_16x16x32_bf16 v[136:139], v[40:43], v[84:87], v[136:139]
L_cs_37:
  s_waitcnt lgkmcnt(0)
  v_mfma_f32_16x16x32_bf16 v[96:99], v[44:47], v[52:55], v[96:99]
  ds_read_b128 v[68:71], v22 offset:32768
  v_mfma_f32_16x16x32_bf16 v[100:103], v[44:47], v[56:59], v[100:103]
  ds_read_b128 v[72:75], v25 offset:32768
  v_mfma_f32_16x16x32_bf16 v[104:107], v[44:47], v[60:63], v[104:107]
  ds_read_b64_tr_b16 v[76:77], v28 offset:40960
  v_mfma_f32_16x16x32_bf16 v[108:111], v[44:47], v[64:67], v[108:111]
  ds_read_b64_tr_b16 v[78:79], v28 offset:41984
  v_mfma_f32_16x16x32_bf16 v[112:115], v[48:51], v[52:55], v[112:115]
  ds_read_b64_tr_b16 v[80:81], v31 offset:40960
  v_mfma_f32_16x16x32_bf16 v[116:119], v[48:51], v[56:59], v[116:119]
  ds_read_b64_tr_b16 v[82:83], v31 offset:41984
  v_mfma_f32_16x16x32_bf16 v[120:123], v[48:51], v[60:63], v[120:123]
  ds_read_b64_tr_b16 v[84:85], v34 offset:40960
  v_mfma_f32_16x16x32_bf16 v[124:127], v[48:51], v[64:67], v[124:127]
  ds_read_b64_tr_b16 v[86:87], v34 offset:41984
  v_mfma_f32_16x16x32_bf16 v[128:131], v[44:47], v[44:47], v[128:131]
  ds_read_b64_tr_b16 v[88:89], v37 offset:40960
  v_mfma_f32_16x16x32_bf16 v[132:135], v[44:47], v[40:43], v[132:135]
  ds_read_b64_tr_b16 v[90:91], v37 offset:41984
  s_cmp_lt_u32 s81, 2
  s_cbranch_scc0 L_cs_38
  v_mfma_f32_16x16x32_bf16 v[136:139], v[40:43], v[52:55], v[136:139]
  s_branch L_cs_39
L_cs_38:
  v_mfma_f32_16x16x32_bf16 v[136:139], v[40:43], v[60:63], v[136:139]
L_cs_39:
  s_waitcnt lgkmcnt(0)
  s_barrier
  v_mfma_f32_16x16x32_bf16 v[96:99], v[68:71], v[76:79], v[96:99]
  ds_read_b128 v[44:47], v17 offset:0
  v_mfma_f32_16x16x32_bf16 v[100:103], v[68:71], v[80:83], v[100:103]
  ds_read_b128 v[48:51], v20 offset:0
  v_mfma_f32_16x16x32_bf16 v[104:107], v[68:71], v[84:87], v[104:107]
  ds_read_b64_tr_b16 v[52:53], v29 offset:0
  v_mfma_f32_16x16x32_bf16 v[108:111], v[68:71], v[88:91], v[108:111]
  ds_read_b64_tr_b16 v[54:55], v29 offset:1024
  v_mfma_f32_16x16x32_bf16 v[112:115], v[72:75], v[76:79], v[112:115]
  ds_read_b64_tr_b16 v[56:57], v32 offset:0
  v_mfma_f32_16x16x32_bf16 v[116:119], v[72:75], v[80:83], v[116:119]
  ds_read_b64_tr_b16 v[58:59], v32 offset:1024
  v_mfma_f32_16x16x32_bf16 v[120:123], v[72:75], v[84:87], v[120:123]
  ds_read_b64_tr_b16 v[60:61], v35 offset:0
  v_mfma_f32_16x16x32_bf16 v[124:127], v[72:75], v[88:91], v[124:127]
  ds_read_b64_tr_b16 v[62:63], v35 offset:1024
  v_mfma_f32_16x16x32_bf16 v[128:131], v[68:71], v[68:71], v[128:131]
  ds_read_b64_tr_b16 v[64:65], v38 offset:0
  v_mfma_f32_16x16x32_bf16 v[132:135], v[68:71], v[40:43], v[132:135]
  ds_read_b64_tr_b16 v[66:67], v38 offset:1024
  s_cmp_lt_u32 s81, 2
  s_cbranch_scc0 L_cs_40
  v_mfma_f32_16x16x32_bf16 v[136:139], v[40:43], v[76:79], v[136:139]
  s_branch L_cs_41
L_cs_40:
  v_mfma_f32_16x16x32_bf16 v[136:139], v[40:43], v[84:87], v[136:139]
L_cs_41:
  s_waitcnt lgkmcnt(0)
  v_mfma_f32_16x16x32_bf16 v[96:99], v[44:47], v[52:55], v[96:99]
  ds_read_b128 v[68:71], v23 offset:0
  v_mfma_f32_16x16x32_bf16 v[100:103], v[44:47], v[56:59], v[100:103]
  ds_read_b128 v[72:75], v26 offset:0
  v_mfma_f32_16x16x32_bf16 v[104:107], v[44:47], v[60:63], v[104:107]
  ds_read_b64_tr_b16 v[76:77], v29 offset:8192
  v_mfma_f32_16x16x32_bf16 v[108:111], v[44:47], v[64:67], v[108:111]
  ds_read_b64_tr_b16 v[78:79], v29 offset:9216
  v_mfma_f32_16x16x32_bf16 v[112:115], v[48:51], v[52:55], v[112:115]
  ds_read_b64_tr_b16 v[80:81], v32 offset:8192
  v_mfma_f32_16x16x32_bf16 v[116:119], v[48:51], v[56:59], v[116:119]
  ds_read_b64_tr_b16 v[82:83], v32 offset:9216
  v_mfma_f32_16x16x32_bf16 v[120:123], v[48:51], v[60:63], v[120:123]
  ds_read_b64_tr_b16 v[84:85], v35 offset:8192
  v_mfma_f32_16x16x32_bf16 v[124:127], v[48:51], v[64:67], v[124:127]
  ds_read_b64_tr_b16 v[86:87], v35 offset:9216
  v_mfma_f32_16x16x32_bf16 v[128:131], v[44:47], v[44:47], v[128:131]
  ds_read_b64_tr_b16 v[88:89], v38 offset:8192
  v_mfma_f32_16x16x32_bf16 v[132:135], v[44:47], v[40:43], v[132:135]
  ds_read_b64_tr_b16 v[90:91], v38 offset:9216
  s_cmp_lt_u32 s81, 2
  s_cbranch_scc0 L_cs_42
  v_mfma_f32_16x16x32_bf16 v[136:139], v[40:43], v[52:55], v[136:139]
  s_branch L_cs_43
L_cs_42:
  v_mfma_f32_16x16x32_bf16 v[136:139], v[40:43], v[60:63], v[136:139]
L_cs_43:
  s_waitcnt lgkmcnt(0)
  s_barrier
  v_mfma_f32_16x16x32_bf16 v[96:99], v[68:71], v[76:79], v[96:99]
  ds_read_b128 v[44:47], v17 offset:32768
  v_mfma_f32_16x16x32_bf16 v[100:103], v[68:71], v[80:83], v[100:103]
  ds_read_b128 v[48:51], v20 offset:32768
  v_mfma_f32_16x16x32_bf16 v[104:107], v[68:71], v[84:87], v[104:107]
  ds_read_b64_tr_b16 v[52:53], v29 offset:32768
  v_mfma_f32_16x16x32_bf16 v[108:111], v[68:71], v[88:91], v[108:111]
  ds_read_b64_tr_b16 v[54:55], v29 offset:33792
  v_mfma_f32_16x16x32_bf16 v[112:115], v[72:75], v[76:79], v[112:115]
  ds_read_b64_tr_b16 v[56:57], v32 offset:32768
  v_mfma_f32_16x16x32_bf16 v[116:119], v[72:75], v[80:83], v[116:119]
  ds_read_b64_tr_b16 v[58:59], v32 offset:33792
  v_mfma_f32_16x16x32_bf16 v[120:123], v[72:75], v[84:87], v[120:123]
  ds_read_b64_tr_b16 v[60:61], v35 offset:32768
  v_mfma_f32_16x16x32_bf16 v[124:127], v[72:75], v[88:91], v[124:127]
  ds_read_b64_tr_b16 v[62:63], v35 offset:33792
  v_mfma_f32_16x16x32_bf16 v[128:131], v[68:71], v[68:71], v[128:131]
  ds_read_b64_tr_b16 v[64:65], v38 offset:32768
  v_mfma_f32_16x16x32_bf16 v[132:135], v[68:71], v[40:43], v[132:135]
  ds_read_b64_tr_b16 v[66:67], v38 offset:33792
  s_cmp_lt_u32 s81, 2
  s_cbranch_scc0 L_cs_44
  v_mfma_f32_16x16x32_bf16 v[136:139], v[40:43], v[76:79], v[136:139]
  s_branch L_cs_45
L_cs_44:
  v_mfma_f32_16x16x32_bf16 v[136:139], v[40:43], v[84:87], v[136:139]
L_cs_45:
  s_waitcnt lgkmcnt(0)
  v_mfma_f32_16x16x32_bf16 v[96:99], v[44:47], v[52:55], v[96:99]
  ds_read_b128 v[68:71], v23 offset:32768
  v_mfma_f32_16x16x32_bf16 v[100:103], v[44:47], v[56:59], v[100:103]
  ds_read_b128 v[72:75], v26 offset:32768
  v_mfma_f32_16x16x32_bf16 v[104:107], v[44:47], v[60:63], v[104:107]
  ds_read_b64_tr_b16 v[76:77], v29 offset:40960
  v_mfma_f32_16x16x32_bf16 v[108:111], v[44:47], v[64:67], v[108:111]
  ds_read_b64_tr_b16 v[78:79], v29 offset:41984
  v_mfma_f32_16x16x32_bf16 v[112:115], v[48:51], v[52:55], v[112:115]
  ds_read_b64_tr_b16 v[80:81], v32 offset:40960
  v_mfma_f32_16x16x32_bf16 v[116:119], v[48:51], v[56:59], v[116:119]
  ds_read_b64_tr_b16 v[82:83], v32 offset:41984
  v_mfma_f32_16x16x32_bf16 v[120:123], v[48:51], v[60:63], v[120:123]
  ds_read_b64_tr_b16 v[84:85], v35 offset:40960
  v_mfma_f32_16x16x32_bf16 v[124:127], v[48:51], v[64:67], v[124:127]
  ds_read_b64_tr_b16 v[86:87], v35 offset:41984
  v_mfma_f32_16x16x32_bf16 v[128:131], v[44:47], v[44:47], v[128:131]
  ds_read_b64_tr_b16 v[88:89], v38 offset:40960
  v_mfma_f32_16x16x32_bf16 v[132:135], v[44:47], v[40:43], v[132:135]
  ds_read_b64_tr_b16 v[90:91], v38 offset:41984
  s_cmp_lt_u32 s81, 2
  s_cbranch_scc0 L_cs_46
  v_mfma_f32_16x16x32_bf16 v[136:139], v[40:43], v[52:55], v[136:139]
  s_branch L_cs_47
L_cs_46:
  v_mfma_f32_16x16x32_bf16 v[136:139], v[40:43], v[60:63], v[136:139]
L_cs_47:
  s_waitcnt lgkmcnt(0)
  s_barrier
  v_mfma_f32_16x16x32_bf16 v[96:99], v[68:71], v[76:79], v[96:99]
  ds_read_b128 v[44:47], v18 offset:0
  v_mfma_f32_16x16x32_bf16 v[100:103], v[68:71], v[80:83], v[100:103]
  ds_read_b128 v[48:51], v21 offset:0
  v_mfma_f32_16x16x32_bf16 v[104:107], v[68:71], v[84:87], v[104:107]
  ds_read_b64_tr_b16 v[52:53], v30 offset:0
  v_mfma_f32_16x16x32_bf16 v[108:111], v[68:71], v[88:91], v[108:111]
  ds_read_b64_tr_b16 v[54:55], v30 offset:1024
  v_mfma_f32_16x16x32_bf16 v[112:115], v[72:75], v[76:79], v[112:115]
  ds_read_b64_tr_b16 v[56:57], v33 offset:0
  v_mfma_f32_16x16x32_bf16 v[116:119], v[72:75], v[80:83], v[116:119]
  ds_read_b64_tr_b16 v[58:59], v33 offset:1024
  v_mfma_f32_16x16x32_bf16 v[120:123], v[72:75], v[84:87], v[120:123]
  ds_read_b64_tr_b16 v[60:61], v36 offset:0
  v_mfma_f32_16x16x32_bf16 v[124:127], v[72:75], v[88:91], v[124:127]
  ds_read_b64_tr_b16 v[62:63], v36 offset:1024
  v_mfma_f32_16x16x32_bf16 v[128:131], v[68:71], v[68:71], v[128:131]
  ds_read_b64_tr_b16 v[64:65], v39 offset:0
  v_mfma_f32_16x16x32_bf16 v[132:135], v[68:71], v[40:43], v[132:135]
  ds_read_b64_tr_b16 v[66:67], v39 offset:1024
  s_cmp_lt_u32 s81, 2
  s_cbranch_scc0 L_cs_48
  v_mfma_f32_16x16x32_bf16 v[136:139], v[40:43], v[76:79], v[136:139]
  s_branch L_cs_49
L_cs_48:
  v_mfma_f32_16x16x32_bf16 v[136:139], v[40:43], v[84:87], v[136:139]
L_cs_49:
  s_waitcnt lgkmcnt(0)
  v_mfma_f32_16x16x32_bf16 v[96:99], v[44:47], v[52:55], v[96:99]
  ds_read_b128 v[68:71], v24 offset:0
  v_mfma_f32_16x16x32_bf16 v[100:103], v[44:47], v[56:59], v[100:103]
  ds_read_b128 v[72:75], v27 offset:0
  v_mfma_f32_16x16x32_bf16 v[104:107], v[44:47], v[60:63], v[104:107]
  ds_read_b64_tr_b16 v[76:77], v30 offset:8192
  v_mfma_f32_16x16x32_bf16 v[108:111], v[44:47], v[64:67], v[108:111]
  ds_read_b64_tr_b16 v[78:79], v30 offset:9216
  v_mfma_f32_16x16x32_bf16 v[112:115], v[48:51], v[52:55], v[112:115]
  ds_read_b64_tr_b16 v[80:81], v33 offset:8192
  v_mfma_f32_16x16x32_bf16 v[116:119], v[48:51], v[56:59], v[116:119]
  ds_read_b64_tr_b16 v[82:83], v33 offset:9216
  v_mfma_f32_16x16x32_bf16 v[120:123], v[48:51], v[60:63], v[120:123]
  ds_read_b64_tr_b16 v[84:85], v36 offset:8192
  v_mfma_f32_16x16x32_bf16 v[124:127], v[48:51], v[64:67], v[124:127]
  ds_read_b64_tr_b16 v[86:87], v36 offset:9216
  v_mfma_f32_16x16x32_bf16 v[128:131], v[44:47], v[44:47], v[128:131]
  ds_read_b64_tr_b16 v[88:89], v39 offset:8192
  v_mfma_f32_16x16x32_bf16 v[132:135], v[44:47], v[40:43], v[132:135]
  ds_read_b64_tr_b16 v[90:91], v39 offset:9216
  s_cmp_lt_u32 s81, 2
  s_cbranch_scc0 L_cs_50
  v_mfma_f32_16x16x32_bf16 v[136:139], v[40:43], v[52:55], v[136:139]
  s_branch L_cs_51
L_cs_50:
  v_mfma_f32_16x16x32_bf16 v[136:139], v[40:43], v[60:63], v[136:139]
L_cs_51:
  s_waitcnt lgkmcnt(0)
  v_mfma_f32_16x16x32_bf16 v[96:99], v[68:71], v[76:79], v[96:99]
  v_mfma_f32_16x16x32_bf16 v[100:103], v[68:71], v[80:83], v[100:103]
  v_mfma_f32_16x16x32_bf16 v[104:107], v[68:71], v[84:87], v[104:107]
  v_mfma_f32_16x16x32_bf16 v[108:111], v[68:71], v[88:91], v[108:111]
  v_mfma_f32_16x16x32_bf16 v[112:115], v[72:75], v[76:79], v[112:115]
  v_mfma_f32_16x16x32_bf16 v[116:119], v[72:75], v[80:83], v[116:119]
  v_mfma_f32_16x16x32_bf16 v[120:123], v[72:75], v[84:87], v[120:123]
  v_mfma_f32_16x16x32_bf16 v[124:127], v[72:75], v[88:91], v[124:127]
  v_mfma_f32_16x16x32_bf16 v[128:131], v[68:71], v[68:71], v[128:131]
  v_mfma_f32_16x16x32_bf16 v[132:135], v[68:71], v[40:43], v[132:135]
  s_cmp_lt_u32 s81, 2
  s_cbranch_scc0 L_cs_52
  v_mfma_f32_16x16x32_bf16 v[136:139], v[40:43], v[76:79], v[136:139]
  s_branch L_cs_53
L_cs_52:
  v_mfma_f32_16x16x32_bf16 v[136:139], v[40:43], v[84:87], v[136:139]
L_cs_53:
  s_barrier
  s_lshl_b32 s12, s81, 1
  s_add_u32 s12, s12, s82
  s_lshl_b32 s12, s12, 6
  s_mov_b32 s88, 0x22222222
  s_mov_b32 s89, 0x22222222
  s_mov_b32 s90, 0x44444444
  s_mov_b32 s91, 0x44444444
  s_mov_b32 s92, 0x88888888
  s_mov_b32 s93, 0x88888888
  v_lshlrev_b32 v10, 2, v4
  v_add_u32 v10, s12, v10
  v_lshlrev_b32 v11, 4, v3
  v_add_u32 v11, s12, v11
  v_cndmask_b32 v14, v128, v129, s[88:89]
  v_cndmask_b32 v14, v14, v130, s[90:91]
  v_cndmask_b32 v14, v14, v131, s[92:93]
  s_cmp_lt_u32 s81, 2
  s_cselect_b32 s13, s84, s86
  s_lshl_b32 s13, s13, 6
  v_lshlrev_b32 v12, 2, v4
  v_add_u32 v12, s13, v12
  s_mov_b32 exec_lo, 0x00F0000F
  s_mov_b32 exec_hi, 0xF0000F00
  ds_write_b32 v10, v14 offset:512
  s_mov_b32 exec_lo, 0x00010001
  s_mov_b32 exec_hi, 0x00010001
  ds_write_b128 v11, v[132:135] offset:0
  s_mov_b32 exec_lo, 0xffff
  s_mov_b32 exec_hi, 0
  ds_write_b32 v12, v136 offset:1024
  s_mov_b64 exec, -1
  s_waitcnt lgkmcnt(0)
  s_barrier
  s_mov_b32 s88, 0x358637bd
  s_mov_b32 s89, 0x358637bd
  s_mov_b32 s90, 0x3fb8aa3b
  s_mov_b32 s91, 0x3fb8aa3b
  s_mov_b32 s92, 0x3acccccd
  s_mov_b32 s93, 0x3acccccd
  v_mov_b32 v15, 2560
  ds_read_b32 v13, v15
  s_xor_b32 s12, s82, 0
  s_lshl_b32 s13, s81, 1
  s_add_u32 s12, s12, s13
  s_lshl_b32 s12, s12, 6
  v_lshlrev_b32 v10, 4, v3
  v_add_u32 v10, s12, v10
  ds_read_b128 v[44:47], v10 offset:0
  ds_read_b128 v[52:55], v10 offset:512
  s_xor_b32 s12, s82, 1
  s_lshl_b32 s13, s81, 1
  s_add_u32 s12, s12, s13
  s_lshl_b32 s12, s12, 6
  v_lshlrev_b32 v10, 4, v3
  v_add_u32 v10, s12, v10
  ds_read_b128 v[48:51], v10 offset:0
  ds_read_b128 v[56:59], v10 offset:512
  s_lshl_b32 s13, s84, 6
  v_lshlrev_b32 v12, 2, v4
  v_add_u32 v12, s13, v12
  ds_read_b32 v68, v12 offset:1024
  s_lshl_b32 s13, s85, 6
  v_lshlrev_b32 v12, 2, v4
  v_add_u32 v12, s13, v12
  ds_read_b32 v70, v12 offset:1024
  s_lshl_b32 s13, s86, 6
  v_lshlrev_b32 v12, 2, v4
  v_add_u32 v12, s13, v12
  ds_read_b32 v72, v12 offset:1024
  s_lshl_b32 s13, s87, 6
  v_lshlrev_b32 v12, 2, v4
  v_add_u32 v12, s13, v12
  ds_read_b32 v74, v12 offset:1024
  s_waitcnt lgkmcnt(0)
  v_readfirstlane_b32 s10, v13
  s_nop 1
  s_and_b32 s10, s10, 1
  v_pk_mul_f32 v[44:45], v[44:45], s[92:93]
  v_pk_mul_f32 v[52:53], v[52:53], s[92:93]
  v_pk_fma_f32 v[52:53], v[44:45], v[44:45], v[52:53] neg_lo:[1,0,0] neg_hi:[1,0,0]
  v_pk_mul_f32 v[46:47], v[46:47], s[92:93]
  v_pk_mul_f32 v[54:55], v[54:55], s[92:93]
  v_pk_fma_f32 v[54:55], v[46:47], v[46:47], v[54:55] neg_lo:[1,0,0] neg_hi:[1,0,0]
  v_pk_mul_f32 v[48:49], v[48:49], s[92:93]
  v_pk_mul_f32 v[56:57], v[56:57], s[92:93]
  v_pk_fma_f32 v[56:57], v[48:49], v[48:49], v[56:57] neg_lo:[1,0,0] neg_hi:[1,0,0]
  v_pk_mul_f32 v[50:51], v[50:51], s[92:93]
  v_pk_mul_f32 v[58:59], v[58:59], s[92:93]
  v_pk_fma_f32 v[58:59], v[50:51], v[50:51], v[58:59] neg_lo:[1,0,0] neg_hi:[1,0,0]
  v_max_f32 v52, 0, v52
  v_add_f32 v52, 0x3727c5ac, v52
  v_rsq_f32 v52, v52
  v_max_f32 v53, 0, v53
  v_add_f32 v53, 0x3727c5ac, v53
  v_rsq_f32 v53, v53
  v_max_f32 v54, 0, v54
  v_add_f32 v54, 0x3727c5ac, v54
  v_rsq_f32 v54, v54
  v_max_f32 v55, 0, v55
  v_add_f32 v55, 0x3727c5ac, v55
  v_rsq_f32 v55, v55
  v_max_f32 v56, 0, v56
  v_add_f32 v56, 0x3727c5ac, v56
  v_rsq_f32 v56, v56
  v_max_f32 v57, 0, v57
  v_add_f32 v57, 0x3727c5ac, v57
  v_rsq_f32 v57, v57
  v_max_f32 v58, 0, v58
  v_add_f32 v58, 0x3727c5ac, v58
  v_rsq_f32 v58, v58
  v_max_f32 v59, 0, v59
  v_add_f32 v59, 0x3727c5ac, v59
  v_rsq_f32 v59, v59
  v_pk_mul_f32 v[60:61], v[52:53], s[90:91]
  v_pk_mul_f32 v[62:63], v[54:55], s[90:91]
  v_pk_mul_f32 v[64:65], v[56:57], s[90:91]
  v_pk_mul_f32 v[66:67], v[58:59], s[90:91]
  s_lshl_b32 s12, s4, 3
  s_lshl_b32 s13, s6, 2
  s_add_u32 s12, s12, s13
  s_add_u32 s12, s12, s81
  s_mul_i32 s12, s12, 40
  s_sub_u32 s13, s7, 5
  s_lshl_b32 s13, s13, 2
  s_add_u32 s94, s12, s13
  v_pk_fma_f32 v[96:97], v[44:45], v[68:69], v[96:97] op_sel_hi:[1,0,1] neg_lo:[1,0,0] neg_hi:[1,0,0]
  v_pk_mul_f32 v[16:17], v[96:97], v[60:61]
  v_pk_fma_f32 v[96:97], v[96:97], v[52:53], s[88:89]
  v_pk_fma_f32 v[98:99], v[46:47], v[68:69], v[98:99] op_sel_hi:[1,0,1] neg_lo:[1,0,0] neg_hi:[1,0,0]
  v_pk_mul_f32 v[18:19], v[98:99], v[62:63]
  v_pk_fma_f32 v[98:99], v[98:99], v[54:55], s[88:89]
  v_min_f32 v16, 0, v16
  v_min_f32 v17, 0, v17
  v_min_f32 v18, 0, v18
  v_min_f32 v19, 0, v19
  v_exp_f32 v16, v16
  v_exp_f32 v17, v17
  v_exp_f32 v18, v18
  v_exp_f32 v19, v19
  v_max_f32 v96, 0x358637bd, v96
  v_max_f32 v97, 0x358637bd, v97
  v_max_f32 v98, 0x358637bd, v98
  v_max_f32 v99, 0x358637bd, v99
  v_add_f32 v96, v96, v16
  v_add_f32 v97, v97, v17
  v_add_f32 v98, v98, v18
  v_add_f32 v99, v99, v19
  v_cvt_pk_bf16_f32 v24, v96, v97
  v_cvt_pk_bf16_f32 v25, v98, v99
  v_pk_fma_f32 v[112:113], v[48:49], v[68:69], v[112:113] op_sel_hi:[1,0,1] neg_lo:[1,0,0] neg_hi:[1,0,0]
  v_pk_mul_f32 v[16:17], v[112:113], v[64:65]
  v_pk_fma_f32 v[112:113], v[112:113], v[56:57], s[88:89]
  v_pk_fma_f32 v[114:115], v[50:51], v[68:69], v[114:115] op_sel_hi:[1,0,1] neg_lo:[1,0,0] neg_hi:[1,0,0]
  v_pk_mul_f32 v[18:19], v[114:115], v[66:67]
  v_pk_fma_f32 v[114:115], v[114:115], v[58:59], s[88:89]
  v_min_f32 v16, 0, v16
  v_min_f32 v17, 0, v17
  v_min_f32 v18, 0, v18
  v_min_f32 v19, 0, v19
  v_exp_f32 v16, v16
  v_exp_f32 v17, v17
  v_exp_f32 v18, v18
  v_exp_f32 v19, v19
  v_max_f32 v112, 0x358637bd, v112
  v_max_f32 v113, 0x358637bd, v113
  v_max_f32 v114, 0x358637bd, v114
  v_max_f32 v115, 0x358637bd, v115
  v_add_f32 v112, v112, v16
  v_add_f32 v113, v113, v17
  v_add_f32 v114, v114, v18
  v_add_f32 v115, v115, v19
  v_cvt_pk_bf16_f32 v26, v112, v113
  v_cvt_pk_bf16_f32 v27, v114, v115
  s_cmp_eq_u32 s82, 0
  s_cbranch_scc1 L_sw_54
  v_swap_b32 v24, v26
  v_swap_b32 v25, v27
L_sw_54:
  s_and_b32 s13, s84, 3
  s_add_u32 s12, s94, s13
  s_lshl_b32 s12, s12, 10
  s_add_u32 s12, s12, 4194304
  s_cmp_eq_u32 s10, 0
  s_cbranch_scc1 L_hs_55
  buffer_store_dwordx4 v[24:27], v2, s[48:51], s12 offen
  s_branch L_hs_56
L_hs_55:
  buffer_store_dwordx4 v[24:27], v2, s[48:51], s12 offen sc1
L_hs_56:
  v_pk_fma_f32 v[100:101], v[44:45], v[70:71], v[100:101] op_sel_hi:[1,0,1] neg_lo:[1,0,0] neg_hi:[1,0,0]
  v_pk_mul_f32 v[16:17], v[100:101], v[60:61]
  v_pk_fma_f32 v[100:101], v[100:101], v[52:53], s[88:89]
  v_pk_fma_f32 v[102:103], v[46:47], v[70:71], v[102:103] op_sel_hi:[1,0,1] neg_lo:[1,0,0] neg_hi:[1,0,0]
  v_pk_mul_f32 v[18:19], v[102:103], v[62:63]
  v_pk_fma_f32 v[102:103], v[102:103], v[54:55], s[88:89]
  v_min_f32 v16, 0, v16
  v_min_f32 v17, 0, v17
  v_min_f32 v18, 0, v18
  v_min_f32 v19, 0, v19
  v_exp_f32 v16, v16
  v_exp_f32 v17, v17
  v_exp_f32 v18, v18
  v_exp_f32 v19, v19
  v_max_f32 v100, 0x358637bd, v100
  v_max_f32 v101, 0x358637bd, v101
  v_max_f32 v102, 0x358637bd, v102
  v_max_f32 v103, 0x358637bd, v103
  v_add_f32 v100, v100, v16
  v_add_f32 v101, v101, v17
  v_add_f32 v102, v102, v18
  v_add_f32 v103, v103, v19
  v_cvt_pk_bf16_f32 v28, v100, v101
  v_cvt_pk_bf16_f32 v29, v102, v103
  v_pk_fma_f32 v[116:117], v[48:49], v[70:71], v[116:117] op_sel_hi:[1,0,1] neg_lo:[1,0,0] neg_hi:[1,0,0]
  v_pk_mul_f32 v[16:17], v[116:117], v[64:65]
  v_pk_fma_f32 v[116:117], v[116:117], v[56:57], s[88:89]
  v_pk_fma_f32 v[118:119], v[50:51], v[70:71], v[118:119] op_sel_hi:[1,0,1] neg_lo:[1,0,0] neg_hi:[1,0,0]
  v_pk_mul_f32 v[18:19], v[118:119], v[66:67]
  v_pk_fma_f32 v[118:119], v[118:119], v[58:59], s[88:89]
  v_min_f32 v16, 0, v16
  v_min_f32 v17, 0, v17
  v_min_f32 v18, 0, v18
  v_min_f32 v19, 0, v19
  v_exp_f32 v16, v16
  v_exp_f32 v17, v17
  v_exp_f32 v18, v18
  v_exp_f32 v19, v19
  v_max_f32 v116, 0x358637bd, v116
  v_max_f32 v117, 0x358637bd, v117
  v_max_f32 v118, 0x358637bd, v118
  v_max_f32 v119, 0x358637bd, v119
  v_add_f32 v116, v116, v16
  v_add_f32 v117, v117, v17
  v_add_f32 v118, v118, v18
  v_add_f32 v119, v119, v19
  v_cvt_pk_bf16_f32 v30, v116, v117
  v_cvt_pk_bf16_f32 v31, v118, v119
  s_cmp_eq_u32 s82, 0
  s_cbranch_scc1 L_sw_57
  v_swap_b32 v28, v30
  v_swap_b32 v29, v31
L_sw_57:
  s_and_b32 s13, s85, 3
  s_add_u32 s12, s94, s13
  s_lshl_b32 s12, s12, 10
  s_add_u32 s12, s12, 4194304
  s_cmp_eq_u32 s10, 0
  s_cbranch_scc1 L_hs_58
  buffer_store_dwordx4 v[28:31], v2, s[48:51], s12 offen
  s_branch L_hs_59
L_hs_58:
  buffer_store_dwordx4 v[28:31], v2, s[48:51], s12 offen sc1
L_hs_59:
  v_pk_fma_f32 v[104:105], v[44:45], v[72:73], v[104:105] op_sel_hi:[1,0,1] neg_lo:[1,0,0] neg_hi:[1,0,0]
  v_pk_mul_f32 v[104:105], v[104:105], v[52:53]
  v_pk_fma_f32 v[106:107], v[46:47], v[72:73], v[106:107] op_sel_hi:[1,0,1] neg_lo:[1,0,0] neg_hi:[1,0,0]
  v_pk_mul_f32 v[106:107], v[106:107], v[54:55]
  v_cvt_pk_bf16_f32 v24, v104, v105
  v_cvt_pk_bf16_f32 v25, v106, v107
  v_pk_fma_f32 v[120:121], v[48:49], v[72:73], v[120:121] op_sel_hi:[1,0,1] neg_lo:[1,0,0] neg_hi:[1,0,0]
  v_pk_mul_f32 v[120:121], v[120:121], v[56:57]
  v_pk_fma_f32 v[122:123], v[50:51], v[72:73], v[122:123] op_sel_hi:[1,0,1] neg_lo:[1,0,0] neg_hi:[1,0,0]
  v_pk_mul_f32 v[122:123], v[122:123], v[58:59]
  v_cvt_pk_bf16_f32 v26, v120, v121
  v_cvt_pk_bf16_f32 v27, v122, v123
  s_cmp_eq_u32 s82, 0
  s_cbranch_scc1 L_sw_60
  v_swap_b32 v24, v26
  v_swap_b32 v25, v27
L_sw_60:
  s_and_b32 s13, s86, 3
  s_add_u32 s12, s94, s13
  s_lshl_b32 s12, s12, 10
  s_add_u32 s12, s12, 7340032
  s_cmp_eq_u32 s10, 0
  s_cbranch_scc1 L_hs_61
  buffer_store_dwordx4 v[24:27], v2, s[48:51], s12 offen
  s_branch L_hs_62
L_hs_61:
  buffer_store_dwordx4 v[24:27], v2, s[48:51], s12 offen sc1
L_hs_62:
  v_pk_fma_f32 v[108:109], v[44:45], v[74:75], v[108:109] op_sel_hi:[1,0,1] neg_lo:[1,0,0] neg_hi:[1,0,0]
  v_pk_mul_f32 v[108:109], v[108:109], v[52:53]
  v_pk_fma_f32 v[110:111], v[46:47], v[74:75], v[110:111] op_sel_hi:[1,0,1] neg_lo:[1,0,0] neg_hi:[1,0,0]
  v_pk_mul_f32 v[110:111], v[110:111], v[54:55]
  v_cvt_pk_bf16_f32 v28, v108, v109
  v_cvt_pk_bf16_f32 v29, v110, v111
  v_pk_fma_f32 v[124:125], v[48:49], v[74:75], v[124:125] op_sel_hi:[1,0,1] neg_lo:[1,0,0] neg_hi:[1,0,0]
  v_pk_mul_f32 v[124:125], v[124:125], v[56:57]
  v_pk_fma_f32 v[126:127], v[50:51], v[74:75], v[126:127] op_sel_hi:[1,0,1] neg_lo:[1,0,0] neg_hi:[1,0,0]
  v_pk_mul_f32 v[126:127], v[126:127], v[58:59]
  v_cvt_pk_bf16_f32 v30, v124, v125
  v_cvt_pk_bf16_f32 v31, v126, v127
  s_cmp_eq_u32 s82, 0
  s_cbranch_scc1 L_sw_63
  v_swap_b32 v28, v30
  v_swap_b32 v29, v31
L_sw_63:
  s_and_b32 s13, s87, 3
  s_add_u32 s12, s94, s13
  s_lshl_b32 s12, s12, 10
  s_add_u32 s12, s12, 7340032
  s_cmp_eq_u32 s10, 0
  s_cbranch_scc1 L_hs_64
  buffer_store_dwordx4 v[28:31], v2, s[48:51], s12 offen
  s_branch L_hs_65
L_hs_64:
  buffer_store_dwordx4 v[28:31], v2, s[48:51], s12 offen sc1
L_hs_65:
  s_branch L_p1_done
L_c_spare:
  s_nop 3
  s_mov_b32 s60, s20
  s_mov_b32 s61, s21
  s_mov_b32 s62, 819200
  s_mov_b32 s63, 0x20000
  s_mov_b32 s64, s24
  s_mov_b32 s65, s25
  s_mov_b32 s66, 1966080
  s_mov_b32 s67, 0x20000
  s_mov_b32 s88, s28
  s_mov_b32 s89, s29
  s_mov_b32 s90, 1966080
  s_mov_b32 s91, 0x20000
  s_lshl_b32 s69, s4, 1
  s_add_u32 s69, s69, s6
  s_mov_b32 s68, 0
L_sp_66:
  s_lshl_b32 s97, s68, 4
  s_add_u32 s97, s97, s69
  s_cmp_ge_u32 s97, 50
  s_cbranch_scc1 L_sp_68
  s_lshl_b32 s98, s68, 14
  s_cmp_lt_u32 s97, 50
  s_cbranch_scc0 L_dc_70
  s_mov_b32 s70, 0
  s_mul_hi_u32 s74, s97, 429496730
  s_mul_i32 s71, s74, 10
  s_sub_u32 s71, s97, s71
  s_branch L_dc_72
L_dc_70:
  s_cmp_lt_u32 s97, 170
  s_cbranch_scc0 L_dc_71
  s_mov_b32 s70, 1
  s_sub_u32 s75, s97, 50
  s_mul_hi_u32 s74, s75, 178956971
  s_mul_i32 s71, s74, 24
  s_sub_u32 s71, s75, s71
  s_branch L_dc_72
L_dc_71:
  s_mov_b32 s70, 2
  s_sub_u32 s75, s97, 170
  s_mul_hi_u32 s74, s75, 429496730
  s_mul_i32 s71, s74, 10
  s_sub_u32 s71, s75, s71
L_dc_72:
  v_lshrrev_b32 v100, 3, v1
  v_and_b32 v101, 7, v1
  v_lshrrev_b32 v102, 1, v100
  v_and_b32 v102, 3, v102
  v_lshlrev_b32 v102, 1, v102
  v_xor_b32 v101, v101, v102
  v_lshlrev_b32 v101, 4, v101
  s_lshl_b32 s12, s8, 4
  s_add_u32 s12, s12, 0
  v_add_u32 v102, s12, v100
  s_cmp_lg_u32 s70, 0
  s_cbranch_scc1 L_r_73
  s_lshl_b32 s13, s74, 2
  v_lshrrev_b32 v103, 5, v102
  v_add_u32 v103, s13, v103
  v_and_b32 v104, 31, v102
  v_lshrrev_b32 v105, 4, v104
  v_and_b32 v106, 15, v104
  v_mul_u32_u24 v107, 40, v103
  v_mul_u32_u24 v108, 20, v105
  v_add3_u32 v107, v107, v108, v106
  v_subrev_u32 v108, 16, v103
  v_mul_u32_u24 v108, 160, v108
  v_mul_u32_u24 v109, 80, v105
  v_lshrrev_b32 v110, 2, v106
  v_mul_u32_u24 v110, 20, v110
  v_add3_u32 v108, v108, v109, v110
  v_and_b32 v109, 3, v106
  v_add3_u32 v108, v108, v109, 16
  v_cmp_gt_u32 vcc, 16, v103
  s_nop 1
  v_cndmask_b32 v103, v108, v107, vcc
  s_branch L_r_74
L_r_73:
  s_lshl_b32 s13, s74, 7
  v_add_u32 v103, s13, v102
L_r_74:
  s_cmp_eq_u32 s70, 1
  s_movk_i32 s13, 1280
  s_cselect_b32 s13, 3072, s13
  v_mul_lo_u32 v103, v103, s13
  v_add_u32 v103, v103, v101
  s_lshl_b32 s13, s71, 7
  s_lshl_b32 s14, s8, 11
  s_add_u32 s14, s14, s98
  s_add_u32 m0, s14, 0
  s_cmp_eq_u32 s70, 1
  s_cbranch_scc1 L_k_75
  s_cmp_eq_u32 s70, 2
  s_cbranch_scc1 L_k_76
  buffer_load_dwordx4 v103, s[60:63], s13 offen lds
  s_branch L_k_77
L_k_75:
  buffer_load_dwordx4 v103, s[64:67], s13 offen lds
  s_branch L_k_77
L_k_76:
  buffer_load_dwordx4 v103, s[88:91], s13 offen lds
L_k_77:
  s_lshl_b32 s12, s8, 4
  s_add_u32 s12, s12, 8
  v_add_u32 v102, s12, v100
  s_cmp_lg_u32 s70, 0
  s_cbranch_scc1 L_r_78
  s_lshl_b32 s13, s74, 2
  v_lshrrev_b32 v103, 5, v102
  v_add_u32 v103, s13, v103
  v_and_b32 v104, 31, v102
  v_lshrrev_b32 v105, 4, v104
  v_and_b32 v106, 15, v104
  v_mul_u32_u24 v107, 40, v103
  v_mul_u32_u24 v108, 20, v105
  v_add3_u32 v107, v107, v108, v106
  v_subrev_u32 v108, 16, v103
  v_mul_u32_u24 v108, 160, v108
  v_mul_u32_u24 v109, 80, v105
  v_lshrrev_b32 v110, 2, v106
  v_mul_u32_u24 v110, 20, v110
  v_add3_u32 v108, v108, v109, v110
  v_and_b32 v109, 3, v106
  v_add3_u32 v108, v108, v109, 16
  v_cmp_gt_u32 vcc, 16, v103
  s_nop 1
  v_cndmask_b32 v103, v108, v107, vcc
  s_branch L_r_79
L_r_78:
  s_lshl_b32 s13, s74, 7
  v_add_u32 v103, s13, v102
L_r_79:
  s_cmp_eq_u32 s70, 1
  s_movk_i32 s13, 1280
  s_cselect_b32 s13, 3072, s13
  v_mul_lo_u32 v103, v103, s13
  v_add_u32 v103, v103, v101
  s_lshl_b32 s13, s71, 7
  s_lshl_b32 s14, s8, 11
  s_add_u32 s14, s14, s98
  s_add_u32 m0, s14, 1024
  s_cmp_eq_u32 s70, 1
  s_cbranch_scc1 L_k_80
  s_cmp_eq_u32 s70, 2
  s_cbranch_scc1 L_k_81
  buffer_load_dwordx4 v103, s[60:63], s13 offen lds
  s_branch L_k_82
L_k_80:
  buffer_load_dwordx4 v103, s[64:67], s13 offen lds
  s_branch L_k_82
L_k_81:
  buffer_load_dwordx4 v103, s[88:91], s13 offen lds
L_k_82:
  s_and_b32 s78, s8, 3
  s_lshr_b32 s79, s8, 2
  s_lshl_b32 s12, s71, 2
  s_add_u32 s12, s12, s78
  s_lshl_b32 s13, s74, 2
  s_lshl_b32 s14, s79, 1
  s_add_u32 s13, s13, s14
  s_cmp_eq_u32 s70, 1
  s_cbranch_scc1 L_d_83
  s_cmp_eq_u32 s70, 2
  s_cbranch_scc1 L_d_84
  s_mul_hi_u32 s3, s12, 858993460
  s_mul_i32 s83, s3, 5
  s_sub_u32 s83, s12, s83
  s_mul_hi_u32 s92, s13, 429496730
  s_mul_i32 s93, s92, 10
  s_sub_u32 s93, s13, s93
  s_mul_i32 s3, s3, 100
  s_mul_i32 s93, s93, 10
  s_mul_i32 s92, s92, 5
  s_add_u32 s3, s3, s83
  s_add_u32 s3, s3, s92
  s_add_u32 s3, s3, s93
  s_lshl_b32 s3, s3, 10
  s_add_u32 s3, s3, 25165824
  s_branch L_d_85
L_d_83:
  s_mul_hi_u32 s3, s12, 715827883
  s_mul_i32 s83, s3, 6
  s_sub_u32 s83, s12, s83
  s_mul_hi_u32 s92, s13, 429496730
  s_mul_i32 s93, s92, 10
  s_sub_u32 s93, s13, s93
  s_mul_i32 s3, s3, 120
  s_mul_i32 s93, s93, 12
  s_mul_i32 s92, s92, 6
  s_add_u32 s3, s3, s83
  s_add_u32 s3, s3, s92
  s_add_u32 s3, s3, s93
  s_lshl_b32 s3, s3, 10
  s_add_u32 s3, s3, 26214400
  s_branch L_d_85
L_d_84:
  s_mul_hi_u32 s3, s12, 858993460
  s_mul_i32 s83, s3, 5
  s_sub_u32 s83, s12, s83
  s_mul_hi_u32 s92, s13, 357913942
  s_mul_i32 s93, s92, 12
  s_sub_u32 s93, s13, s93
  s_mul_i32 s3, s3, 240
  s_mul_i32 s93, s93, 20
  s_mul_i32 s92, s92, 5
  s_add_u32 s3, s3, s83
  s_add_u32 s3, s3, s92
  s_add_u32 s3, s3, s93
  s_lshl_b32 s3, s3, 10
  s_add_u32 s3, s3, 29360128
L_d_85:
  s_lshl_b32 s86, s68, 2
  s_add_u32 m0, s86, 0
  s_nop 3
  v_writelane_b32 v122, s3, m0
  s_lshl_b32 s13, s74, 2
  s_lshl_b32 s14, s79, 1
  s_add_u32 s13, s13, s14
  s_add_u32 s13, s13, 1
  s_cmp_eq_u32 s70, 1
  s_cbranch_scc1 L_d_86
  s_cmp_eq_u32 s70, 2
  s_cbranch_scc1 L_d_87
  s_mul_hi_u32 s3, s12, 858993460
  s_mul_i32 s83, s3, 5
  s_sub_u32 s83, s12, s83
  s_mul_hi_u32 s92, s13, 429496730
  s_mul_i32 s93, s92, 10
  s_sub_u32 s93, s13, s93
  s_mul_i32 s3, s3, 100
  s_mul_i32 s93, s93, 10
  s_mul_i32 s92, s92, 5
  s_add_u32 s3, s3, s83
  s_add_u32 s3, s3, s92
  s_add_u32 s3, s3, s93
  s_lshl_b32 s3, s3, 10
  s_add_u32 s3, s3, 25165824
  s_branch L_d_88
L_d_86:
  s_mul_hi_u32 s3, s12, 715827883
  s_mul_i32 s83, s3, 6
  s_sub_u32 s83, s12, s83
  s_mul_hi_u32 s92, s13, 429496730
  s_mul_i32 s93, s92, 10
  s_sub_u32 s93, s13, s93
  s_mul_i32 s3, s3, 120
  s_mul_i32 s93, s93, 12
  s_mul_i32 s92, s92, 6
  s_add_u32 s3, s3, s83
  s_add_u32 s3, s3, s92
  s_add_u32 s3, s3, s93
  s_lshl_b32 s3, s3, 10
  s_add_u32 s3, s3, 26214400
  s_branch L_d_88
L_d_87:
  s_mul_hi_u32 s3, s12, 858993460
  s_mul_i32 s83, s3, 5
  s_sub_u32 s83, s12, s83
  s_mul_hi_u32 s92, s13, 357913942
  s_mul_i32 s93, s92, 12
  s_sub_u32 s93, s13, s93
  s_mul_i32 s3, s3, 240
  s_mul_i32 s93, s93, 20
  s_mul_i32 s92, s92, 5
  s_add_u32 s3, s3, s83
  s_add_u32 s3, s3, s92
  s_add_u32 s3, s3, s93
  s_lshl_b32 s3, s3, 10
  s_add_u32 s3, s3, 29360128
L_d_88:
  s_lshl_b32 s86, s68, 2
  s_add_u32 m0, s86, 1
  s_nop 3
  v_writelane_b32 v122, s3, m0
  s_lshl_b32 s13, s74, 1
  s_add_u32 s13, s13, s79
  s_mul_i32 s13, s13, 1536
  s_lshl_b32 s14, s12, 4
  s_add_u32 s13, s13, s14
  s_lshl_b32 s13, s13, 2
  s_add_u32 s13, s13, 32505856
  s_cmp_eq_u32 s70, 1
  s_cselect_b32 s13, s13, 0
  s_lshl_b32 s86, s68, 2
  s_add_u32 m0, s86, 2
  s_nop 3
  v_writelane_b32 v122, s13, m0
  s_add_u32 s68, s68, 1
  s_cmp_lt_u32 s68, 4
  s_cbranch_scc1 L_sp_66
L_sp_68:
  s_waitcnt vmcnt(0)
  s_barrier
  s_mov_b32 s68, 0
L_sp_67:
  s_lshl_b32 s97, s68, 4
  s_add_u32 s97, s97, s69
  s_cmp_ge_u32 s97, 50
  s_cbranch_scc1 L_sp_69
  s_lshl_b32 s98, s68, 14
  s_lshl_b32 s85, s68, 2
  v_lshrrev_b32 v100, 2, v4
  v_and_b32 v101, 3, v4
  v_lshl_add_u32 v102, v3, 2, v100
  v_lshrrev_b32 v103, 1, v102
  v_and_b32 v103, 3, v103
  v_lshlrev_b32 v103, 1, v103
  s_and_b32 s12, s8, 3
  s_lshl_b32 s12, s12, 1
  v_lshrrev_b32 v104, 1, v101
  v_or_b32 v104, s12, v104
  v_xor_b32 v104, v104, v103
  v_lshlrev_b32 v104, 4, v104
  v_lshl_add_u32 v104, v102, 7, v104
  v_and_b32 v101, 1, v101
  v_lshl_add_u32 v104, v101, 3, v104
  s_lshr_b32 s12, s8, 2
  s_lshl_b32 s12, s12, 13
  s_add_u32 s12, s12, s98
  v_add_u32 v104, s12, v104
  ds_read_b64_tr_b16 v[106:107], v104
  ds_read_b64_tr_b16 v[108:109], v104 offset:2048
  ds_read_b64_tr_b16 v[110:111], v104 offset:4096
  ds_read_b64_tr_b16 v[112:113], v104 offset:6144
  v_readlane_b32 s12, v122, s85
  s_add_u32 s15, s85, 1
  v_readlane_b32 s13, v122, s15
  s_add_u32 s15, s85, 2
  v_readlane_b32 s14, v122, s15
  s_waitcnt lgkmcnt(0)
  buffer_store_dwordx4 v[106:109], v2, s[48:51], s12 offen sc1
  s_nop 0
  buffer_store_dwordx4 v[110:113], v2, s[48:51], s13 offen sc1
  s_cmp_eq_u32 s14, 0
  s_cbranch_scc1 L_cs_89
  v_mov_b32 v114, 0x3f803f80
  v_mov_b32 v115, 0x3f803f80
  v_mov_b32 v116, 0x3f803f80
  v_mov_b32 v117, 0x3f803f80
  s_nop 1
  v_mfma_f32_16x16x32_bf16 v[118:121], v[106:109], v[114:117], 0
  v_mfma_f32_16x16x32_bf16 v[118:121], v[110:113], v[114:117], v[118:121]
  v_lshlrev_b32 v100, 4, v3
  v_mov_b32 v101, 0x20000000
  v_cmp_eq_u32 vcc, 0, v4
  s_nop 1
  v_cndmask_b32 v100, v101, v100, vcc
  s_nop 1
  buffer_store_dwordx4 v[118:121], v100, s[48:51], s14 offen sc1
L_cs_89:
  s_nop 1
  s_add_u32 s68, s68, 1
  s_cmp_lt_u32 s68, 4
  s_cbranch_scc1 L_sp_67
L_sp_69:
  s_waitcnt vmcnt(0)
  s_barrier
  s_barrier
  s_barrier
  v_mov_b32 v15, 2560
  ds_read_b32 v13, v15
  s_waitcnt lgkmcnt(0)
  v_readfirstlane_b32 s10, v13
  s_nop 1
  s_and_b32 s10, s10, 1
L_p1_done:
  s_nop 7
  s_waitcnt vmcnt(0)
  s_barrier
  s_bfe_u32 s70, s8, 0x10001
  s_and_b32 s71, s8, 1
  s_lshr_b32 s72, s8, 2
  s_mul_i32 s73, s5, 5
  s_lshr_b32 s73, s73, 2
  s_and_b32 s74, s5, 3
  s_lshl_b32 s74, s74, 2
  s_lshl_b32 s12, s4, 3
  s_lshl_b32 s13, s72, 2
  s_add_u32 s12, s12, s13
  s_mul_i32 s12, s12, 40
  s_add_u32 s12, s12, s73
  s_add_u32 s75, s12, s70
  s_add_u32 s76, s12, s71
  s_lshl_b32 s75, s75, 10
  s_lshl_b32 s76, s76, 10
  s_add_u32 s75, s75, 4194304
  s_add_u32 s76, s76, 7340032
  v_mov_b32 v48, 0x3f803f80
  v_mov_b32 v49, 0x3f803f80
  v_mov_b32 v50, 0x3f803f80
  v_mov_b32 v51, 0x3f803f80
  s_lshl_b32 s12, s70, 4
  s_sub_u32 s12, s12, s74
  v_lshl_add_u32 v60, v3, 2, s12
  s_lshl_b32 s13, s71, 4
  s_sub_u32 s13, s13, s74
  v_add_u32 v61, s13, v4
  v_mul_u32_u24 v62, 20, v61
  v_add_u32 v62, v62, v60
  v_lshlrev_b32 v62, 2, v62
  v_cmp_gt_u32 vcc, 20, v60
  v_cmp_gt_u32 s[12:13], 20, v61
  s_nop 1
  s_and_b64 s[12:13], s[12:13], vcc
  v_mov_b32 v63, 0x20000000
  v_cndmask_b32 v62, v63, v62, s[12:13]
  v_add_u32 v64, 400, v60
  v_lshlrev_b32 v64, 2, v64
  v_cmp_eq_u32 s[12:13], 0, v4
  s_nop 1
  s_and_b64 s[12:13], s[12:13], vcc
  s_cmp_eq_u32 s71, 0
  s_cselect_b64 s[12:13], s[12:13], 0
  v_cndmask_b32 v64, v63, v64, s[12:13]
  s_lshl_b32 s77, s4, 5
  s_add_u32 s77, s77, s5
  s_lshl_b32 s77, s77, 11
  s_add_u32 s77, s77, 10485760
  s_and_b32 s12, s8, 3
  s_lshl_b32 s12, s12, 11
  s_add_u32 s12, s12, 4096
  v_add_u32 v65, s12, v2
  s_barrier
  buffer_load_dwordx4 v[16:19], v2, s[48:51], s75 offen sc1
  buffer_load_dwordx4 v[32:35], v2, s[48:51], s76 offen sc1
  s_add_u32 s75, s75, 40960
  s_add_u32 s76, s76, 40960
  buffer_load_dwordx4 v[20:23], v2, s[48:51], s75 offen sc1
  buffer_load_dwordx4 v[36:39], v2, s[48:51], s76 offen sc1
  s_add_u32 s75, s75, 40960
  s_add_u32 s76, s76, 40960
  buffer_load_dwordx4 v[24:27], v2, s[48:51], s75 offen sc1
  buffer_load_dwordx4 v[40:43], v2, s[48:51], s76 offen sc1
  s_add_u32 s75, s75, 40960
  s_add_u32 s76, s76, 40960
  buffer_load_dwordx4 v[28:31], v2, s[48:51], s75 offen sc1
  buffer_load_dwordx4 v[44:47], v2, s[48:51], s76 offen sc1
  s_add_u32 s75, s75, 40960
  s_add_u32 s76, s76, 40960
  s_waitcnt vmcnt(6)
  v_mfma_f32_16x16x32_bf16 v[52:55], v[16:19], v[32:35], 0
  v_mfma_f32_16x16x32_bf16 v[56:59], v[16:19], v[48:51], 0
  s_waitcnt vmcnt(4)
  v_mfma_f32_16x16x32_bf16 v[52:55], v[20:23], v[36:39], v[52:55]
  v_mfma_f32_16x16x32_bf16 v[56:59], v[20:23], v[48:51], v[56:59]
  s_waitcnt vmcnt(2)
  v_mfma_f32_16x16x32_bf16 v[52:55], v[24:27], v[40:43], v[52:55]
  v_mfma_f32_16x16x32_bf16 v[56:59], v[24:27], v[48:51], v[56:59]
  s_waitcnt vmcnt(0)
  v_mfma_f32_16x16x32_bf16 v[52:55], v[28:31], v[44:47], v[52:55]
  v_mfma_f32_16x16x32_bf16 v[56:59], v[28:31], v[48:51], v[56:59]
  s_cmp_lt_u32 s8, 4
  s_cbranch_scc1 L_p1b_90
  s_nop 4
  ds_write_b128 v65, v[52:55]
  ds_write_b128 v65, v[56:59] offset:1024
  s_waitcnt lgkmcnt(0)
L_p1b_90:
  s_barrier
  s_cmp_ge_u32 s8, 4
  s_cbranch_scc1 L_p1b_91
  ds_read_b128 v[16:19], v65
  ds_read_b128 v[20:23], v65 offset:1024
  s_waitcnt lgkmcnt(0)
  v_pk_add_f32 v[52:53], v[52:53], v[16:17]
  v_pk_add_f32 v[56:57], v[56:57], v[20:21]
  v_pk_add_f32 v[54:55], v[54:55], v[18:19]
  v_pk_add_f32 v[58:59], v[58:59], v[22:23]
  buffer_store_dwordx4 v[52:55], v62, s[48:51], s77 offen sc1
  buffer_store_dwordx4 v[56:59], v64, s[48:51], s77 offen sc1
L_p1b_91:
  s_waitcnt vmcnt(0)
  s_barrier
  s_mul_i32 s12, s5, 5
  s_lshr_b32 s80, s12, 3
  s_and_b32 s81, s12, 7
  s_lshl_b32 s81, s81, 2
  s_cmp_gt_u32 s81, 12
  s_cselect_b32 s82, 1, 0
  s_lshl_b32 s12, s4, 4
  s_lshl_b32 s13, s8, 1
  s_add_u32 s83, s12, s13
  s_mul_i32 s12, s83, 20
  s_add_u32 s12, s12, s80
  s_lshl_b32 s12, s12, 10
  s_add_u32 s12, s12, 1048576
  s_add_u32 s13, s12, 20480
  buffer_load_dwordx4 v[64:67], v2, s[48:51], s12 offen sc1
  buffer_load_dwordx4 v[72:75], v2, s[48:51], s13 offen sc1
  buffer_load_dwordx4 v[68:71], v2, s[48:51], s12 offen offset:1024 sc1
  buffer_load_dwordx4 v[76:79], v2, s[48:51], s13 offen offset:1024 sc1
  s_lshl_b32 s12, s4, 4
  s_lshr_b32 s13, s5, 3
  s_lshl_b32 s13, s13, 2
  s_add_u32 s12, s12, s13
  s_lshr_b32 s13, s8, 1
  s_add_u32 s12, s12, s13
  s_mul_i32 s12, s12, 20480
  s_and_b32 s13, s5, 7
  s_mul_i32 s13, s13, 160
  s_add_u32 s12, s12, s13
  v_mul_u32_u24 v12, 1280, v4
  v_lshl_add_u32 v12, v3, 3, v12
  buffer_load_dwordx2 v[150:151], v12, s[40:43], s12 offen offset:0
  buffer_load_dwordx2 v[152:153], v12, s[40:43], s12 offen offset:32
  buffer_load_dwordx2 v[154:155], v12, s[40:43], s12 offen offset:64
  buffer_load_dwordx2 v[156:157], v12, s[40:43], s12 offen offset:96
  buffer_load_dwordx2 v[158:159], v12, s[40:43], s12 offen offset:128
  v_mul_u32_u24 v61, 136, v4
  v_lshl_add_u32 v61, v3, 3, v61
  s_and_b32 s12, s5, 3
  v_lshrrev_b32 v20, 2, v4
  v_cmp_eq_u32 vcc, s12, v20
  v_and_b32 v20, 3, v4
  v_add_u32 v20, 16, v20
  v_mov_b32 v21, 21
  v_cndmask_b32 v20, v21, v20, vcc
  v_mul_u32_u24 v20, 136, v20
  v_lshl_add_u32 v62, v3, 3, v20
  v_lshlrev_b32 v63, 3, v3
  v_add_u32 v63, 2720, v63
  s_and_b32 s12, s5, 1
  s_lshl_b32 s12, s12, 3
  v_add_u32 v10, s12, v2
  s_bfe_u32 s12, s5, 0x10002
  s_lshl_b32 s12, s12, 3
  v_add_u32 v11, s12, v2
  s_and_b32 s12, s5, 3
  v_cmp_eq_u32 vcc, s12, v3
  v_mov_b32 v12, 0x20000000
  s_nop 0
  v_cndmask_b32 v11, v12, v11, vcc
  s_barrier
  s_barrier
  ds_read_b64 v[16:17], v61 offset:0
  ds_read_b64 v[18:19], v61 offset:32
  ds_read_b64 v[20:21], v61 offset:64
  ds_read_b64 v[22:23], v61 offset:96
  ds_read_b64 v[24:25], v62 offset:0
  ds_read_b64 v[26:27], v62 offset:32
  ds_read_b64 v[28:29], v62 offset:64
  ds_read_b64 v[30:31], v62 offset:96
  ds_read_b64 v[32:33], v63 offset:0
  ds_read_b64 v[34:35], v63 offset:32
  ds_read_b64 v[36:37], v63 offset:64
  ds_read_b64 v[38:39], v63 offset:96
  s_waitcnt vmcnt(5) lgkmcnt(0)
  v_mfma_f32_16x16x32_bf16 v[40:43], v[16:19], v[64:67], 0
  v_mfma_f32_16x16x32_bf16 v[44:47], v[24:27], v[64:67], 0
  v_mfma_f32_16x16x32_bf16 v[48:51], v[32:35], v[64:67], 0
  v_mfma_f32_16x16x32_bf16 v[52:55], v[16:19], v[72:75], 0
  v_mfma_f32_16x16x32_bf16 v[56:59], v[24:27], v[72:75], 0
  v_mfma_f32_16x16x32_bf16 v[60:63], v[32:35], v[72:75], 0
  s_cmp_eq_u32 s82, 0
  s_cbranch_scc1 L_cr_92
  v_mfma_f32_16x16x32_bf16 v[40:43], v[20:23], v[68:71], v[40:43]
  v_mfma_f32_16x16x32_bf16 v[44:47], v[28:31], v[68:71], v[44:47]
  v_mfma_f32_16x16x32_bf16 v[48:51], v[36:39], v[68:71], v[48:51]
  v_mfma_f32_16x16x32_bf16 v[52:55], v[20:23], v[76:79], v[52:55]
  v_mfma_f32_16x16x32_bf16 v[56:59], v[28:31], v[76:79], v[56:59]
  v_mfma_f32_16x16x32_bf16 v[60:63], v[36:39], v[76:79], v[60:63]
L_cr_92:
  s_nop 7
  v_add_f32 v48, 0x358637bd, v48
  v_rcp_f32 v48, v48
  s_nop 0
  v_pk_mul_f32 v[40:41], v[40:41], v[48:49] op_sel_hi:[1,0]
  v_pk_mul_f32 v[42:43], v[42:43], v[48:49] op_sel_hi:[1,0]
  v_cvt_pk_bf16_f32 v40, v40, v41
  v_cvt_pk_bf16_f32 v41, v42, v43
  v_pk_mul_f32 v[44:45], v[44:45], v[48:49] op_sel_hi:[1,0]
  v_pk_mul_f32 v[46:47], v[46:47], v[48:49] op_sel_hi:[1,0]
  v_cvt_pk_bf16_f32 v44, v44, v45
  v_cvt_pk_bf16_f32 v45, v46, v47
  s_add_u32 s12, s83, 0
  s_mul_i32 s12, s12, 20
  s_lshr_b32 s13, s5, 1
  s_add_u32 s13, s13, s12
  s_lshl_b32 s13, s13, 10
  s_add_u32 s13, s13, 11534336
  s_cmp_eq_u32 s10, 0
  s_cbranch_scc1 L_hs_93
  buffer_store_dwordx2 v[40:41], v10, s[48:51], s13 offen
  s_branch L_hs_94
L_hs_93:
  buffer_store_dwordx2 v[40:41], v10, s[48:51], s13 offen sc1
L_hs_94:
  s_lshr_b32 s13, s5, 3
  s_add_u32 s13, s13, s12
  s_add_u32 s13, s13, 16
  s_lshl_b32 s13, s13, 10
  s_add_u32 s13, s13, 11534336
  s_cmp_eq_u32 s10, 0
  s_cbranch_scc1 L_hs_95
  buffer_store_dwordx2 v[44:45], v11, s[48:51], s13 offen
  s_branch L_hs_96
L_hs_95:
  buffer_store_dwordx2 v[44:45], v11, s[48:51], s13 offen sc1
L_hs_96:
  v_add_f32 v60, 0x358637bd, v60
  v_rcp_f32 v60, v60
  s_nop 0
  v_pk_mul_f32 v[52:53], v[52:53], v[60:61] op_sel_hi:[1,0]
  v_pk_mul_f32 v[54:55], v[54:55], v[60:61] op_sel_hi:[1,0]
  v_cvt_pk_bf16_f32 v52, v52, v53
  v_cvt_pk_bf16_f32 v53, v54, v55
  v_pk_mul_f32 v[56:57], v[56:57], v[60:61] op_sel_hi:[1,0]
  v_pk_mul_f32 v[58:59], v[58:59], v[60:61] op_sel_hi:[1,0]
  v_cvt_pk_bf16_f32 v56, v56, v57
  v_cvt_pk_bf16_f32 v57, v58, v59
  s_add_u32 s12, s83, 1
  s_mul_i32 s12, s12, 20
  s_lshr_b32 s13, s5, 1
  s_add_u32 s13, s13, s12
  s_lshl_b32 s13, s13, 10
  s_add_u32 s13, s13, 11534336
  s_cmp_eq_u32 s10, 0
  s_cbranch_scc1 L_hs_97
  buffer_store_dwordx2 v[52:53], v10, s[48:51], s13 offen
  s_branch L_hs_98
L_hs_97:
  buffer_store_dwordx2 v[52:53], v10, s[48:51], s13 offen sc1
L_hs_98:
  s_lshr_b32 s13, s5, 3
  s_add_u32 s13, s13, s12
  s_add_u32 s13, s13, 16
  s_lshl_b32 s13, s13, 10
  s_add_u32 s13, s13, 11534336
  s_cmp_eq_u32 s10, 0
  s_cbranch_scc1 L_hs_99
  buffer_store_dwordx2 v[56:57], v11, s[48:51], s13 offen
  s_branch L_hs_100
L_hs_99:
  buffer_store_dwordx2 v[56:57], v11, s[48:51], s13 offen sc1
L_hs_100:
  s_waitcnt vmcnt(0)
  s_barrier
  s_lshr_b32 s70, s5, 3
  s_and_b32 s71, s5, 7
  s_lshr_b32 s72, s8, 1
  s_and_b32 s73, s8, 1
  s_lshl_b32 s77, s4, 4
  s_lshl_b32 s12, s70, 2
  s_add_u32 s77, s77, s12
  s_add_u32 s77, s77, s72
  s_mul_i32 s12, s77, 20
  s_mul_i32 s13, s73, 10
  s_add_u32 s12, s12, s13
  s_lshl_b32 s12, s12, 10
  s_add_u32 s80, s12, 11534336
  s_mul_i32 s12, s73, 5120
  s_add_u32 s12, s12, 12288
  v_add_u32 v13, s12, v2
  v_add_u32 v14, 51200, v13
  s_mul_i32 s12, s8, 5120
  s_add_u32 s12, s12, 73728
  v_add_u32 v10, s12, v2
  s_xor_b32 s13, s8, 1
  s_mul_i32 s13, s13, 5120
  s_add_u32 s13, s13, 73728
  v_add_u32 v11, s13, v2
  s_barrier
  buffer_load_dwordx4 v[16:19], v2, s[48:51], s80 offen offset:0 sc1
  buffer_load_dwordx4 v[20:23], v2, s[48:51], s80 offen offset:1024 sc1
  buffer_load_dwordx4 v[24:27], v2, s[48:51], s80 offen offset:2048 sc1
  buffer_load_dwordx4 v[28:31], v2, s[48:51], s80 offen offset:3072 sc1
  s_add_u32 s80, s80, 4096
  buffer_load_dwordx4 v[32:35], v2, s[48:51], s80 offen offset:0 sc1
  buffer_load_dwordx4 v[36:39], v2, s[48:51], s80 offen offset:1024 sc1
  ds_read_b128 v[56:59], v13 offset:0
  ds_read_b128 v[60:63], v13 offset:1024
  ds_read_b128 v[64:67], v13 offset:2048
  ds_read_b128 v[68:71], v13 offset:3072
  ds_read_b128 v[72:75], v13 offset:4096
  s_waitcnt vmcnt(5) lgkmcnt(0)
  v_mfma_f32_16x16x32_bf16 v[96:99], v[56:59], v[16:19], 0
  ds_read_b128 v[76:79], v13 offset:10240
  v_mfma_f32_16x16x32_bf16 v[100:103], v[60:63], v[16:19], 0
  ds_read_b128 v[80:83], v13 offset:11264
  v_mfma_f32_16x16x32_bf16 v[104:107], v[64:67], v[16:19], 0
  ds_read_b128 v[84:87], v13 offset:12288
  v_mfma_f32_16x16x32_bf16 v[108:111], v[68:71], v[16:19], 0
  ds_read_b128 v[88:91], v13 offset:13312
  v_mfma_f32_16x16x32_bf16 v[112:115], v[72:75], v[16:19], 0
  ds_read_b128 v[92:95], v13 offset:14336
  buffer_load_dwordx4 v[40:43], v2, s[48:51], s80 offen offset:2048 sc1
  s_waitcnt vmcnt(5) lgkmcnt(0)
  v_mfma_f32_16x16x32_bf16 v[96:99], v[76:79], v[20:23], v[96:99]
  ds_read_b128 v[56:59], v13 offset:20480
  v_mfma_f32_16x16x32_bf16 v[100:103], v[80:83], v[20:23], v[100:103]
  ds_read_b128 v[60:63], v13 offset:21504
  v_mfma_f32_16x16x32_bf16 v[104:107], v[84:87], v[20:23], v[104:107]
  ds_read_b128 v[64:67], v13 offset:22528
  v_mfma_f32_16x16x32_bf16 v[108:111], v[88:91], v[20:23], v[108:111]
  ds_read_b128 v[68:71], v13 offset:23552
  v_mfma_f32_16x16x32_bf16 v[112:115], v[92:95], v[20:23], v[112:115]
  ds_read_b128 v[72:75], v13 offset:24576
  buffer_load_dwordx4 v[44:47], v2, s[48:51], s80 offen offset:3072 sc1
  s_waitcnt vmcnt(5) lgkmcnt(0)
  v_mfma_f32_16x16x32_bf16 v[96:99], v[56:59], v[24:27], v[96:99]
  ds_read_b128 v[76:79], v13 offset:30720
  v_mfma_f32_16x16x32_bf16 v[100:103], v[60:63], v[24:27], v[100:103]
  ds_read_b128 v[80:83], v13 offset:31744
  v_mfma_f32_16x16x32_bf16 v[104:107], v[64:67], v[24:27], v[104:107]
  ds_read_b128 v[84:87], v13 offset:32768
  v_mfma_f32_16x16x32_bf16 v[108:111], v[68:71], v[24:27], v[108:111]
  ds_read_b128 v[88:91], v13 offset:33792
  v_mfma_f32_16x16x32_bf16 v[112:115], v[72:75], v[24:27], v[112:115]
  ds_read_b128 v[92:95], v13 offset:34816
  s_add_u32 s80, s80, 4096
  buffer_load_dwordx4 v[48:51], v2, s[48:51], s80 offen offset:0 sc1
  s_waitcnt vmcnt(5) lgkmcnt(0)
  v_mfma_f32_16x16x32_bf16 v[96:99], v[76:79], v[28:31], v[96:99]
  ds_read_b128 v[56:59], v13 offset:40960
  v_mfma_f32_16x16x32_bf16 v[100:103], v[80:83], v[28:31], v[100:103]
  ds_read_b128 v[60:63], v13 offset:41984
  v_mfma_f32_16x16x32_bf16 v[104:107], v[84:87], v[28:31], v[104:107]
  ds_read_b128 v[64:67], v13 offset:43008
  v_mfma_f32_16x16x32_bf16 v[108:111], v[88:91], v[28:31], v[108:111]
  ds_read_b128 v[68:71], v13 offset:44032
  v_mfma_f32_16x16x32_bf16 v[112:115], v[92:95], v[28:31], v[112:115]
  ds_read_b128 v[72:75], v13 offset:45056
  buffer_load_dwordx4 v[52:55], v2, s[48:51], s80 offen offset:1024 sc1
  s_waitcnt vmcnt(5) lgkmcnt(0)
  v_mfma_f32_16x16x32_bf16 v[96:99], v[56:59], v[32:35], v[96:99]
  ds_read_b128 v[76:79], v14 offset:0
  v_mfma_f32_16x16x32_bf16 v[100:103], v[60:63], v[32:35], v[100:103]
  ds_read_b128 v[80:83], v14 offset:1024
  v_mfma_f32_16x16x32_bf16 v[104:107], v[64:67], v[32:35], v[104:107]
  ds_read_b128 v[84:87], v14 offset:2048
  v_mfma_f32_16x16x32_bf16 v[108:111], v[68:71], v[32:35], v[108:111]
  ds_read_b128 v[88:91], v14 offset:3072
  v_mfma_f32_16x16x32_bf16 v[112:115], v[72:75], v[32:35], v[112:115]
  ds_read_b128 v[92:95], v14 offset:4096
  s_waitcnt vmcnt(4) lgkmcnt(0)
  v_mfma_f32_16x16x32_bf16 v[96:99], v[76:79], v[36:39], v[96:99]
  ds_read_b128 v[56:59], v14 offset:10240
  v_mfma_f32_16x16x32_bf16 v[100:103], v[80:83], v[36:39], v[100:103]
  ds_read_b128 v[60:63], v14 offset:11264
  v_mfma_f32_16x16x32_bf16 v[104:107], v[84:87], v[36:39], v[104:107]
  ds_read_b128 v[64:67], v14 offset:12288
  v_mfma_f32_16x16x32_bf16 v[108:111], v[88:91], v[36:39], v[108:111]
  ds_read_b128 v[68:71], v14 offset:13312
  v_mfma_f32_16x16x32_bf16 v[112:115], v[92:95], v[36:39], v[112:115]
  ds_read_b128 v[72:75], v14 offset:14336
  s_waitcnt vmcnt(3) lgkmcnt(0)
  v_mfma_f32_16x16x32_bf16 v[96:99], v[56:59], v[40:43], v[96:99]
  ds_read_b128 v[76:79], v14 offset:20480
  v_mfma_f32_16x16x32_bf16 v[100:103], v[60:63], v[40:43], v[100:103]
  ds_read_b128 v[80:83], v14 offset:21504
  v_mfma_f32_16x16x32_bf16 v[104:107], v[64:67], v[40:43], v[104:107]
  ds_read_b128 v[84:87], v14 offset:22528
  v_mfma_f32_16x16x32_bf16 v[108:111], v[68:71], v[40:43], v[108:111]
  ds_read_b128 v[88:91], v14 offset:23552
  v_mfma_f32_16x16x32_bf16 v[112:115], v[72:75], v[40:43], v[112:115]
  ds_read_b128 v[92:95], v14 offset:24576
  s_waitcnt vmcnt(2) lgkmcnt(0)
  v_mfma_f32_16x16x32_bf16 v[96:99], v[76:79], v[44:47], v[96:99]
  ds_read_b128 v[56:59], v14 offset:30720
  v_mfma_f32_16x16x32_bf16 v[100:103], v[80:83], v[44:47], v[100:103]
  ds_read_b128 v[60:63], v14 offset:31744
  v_mfma_f32_16x16x32_bf16 v[104:107], v[84:87], v[44:47], v[104:107]
  ds_read_b128 v[64:67], v14 offset:32768
  v_mfma_f32_16x16x32_bf16 v[108:111], v[88:91], v[44:47], v[108:111]
  ds_read_b128 v[68:71], v14 offset:33792
  v_mfma_f32_16x16x32_bf16 v[112:115], v[92:95], v[44:47], v[112:115]
  ds_read_b128 v[72:75], v14 offset:34816
  s_waitcnt vmcnt(1) lgkmcnt(0)
  v_mfma_f32_16x16x32_bf16 v[96:99], v[56:59], v[48:51], v[96:99]
  ds_read_b128 v[76:79], v14 offset:40960
  v_mfma_f32_16x16x32_bf16 v[100:103], v[60:63], v[48:51], v[100:103]
  ds_read_b128 v[80:83], v14 offset:41984
  v_mfma_f32_16x16x32_bf16 v[104:107], v[64:67], v[48:51], v[104:107]
  ds_read_b128 v[84:87], v14 offset:43008
  v_mfma_f32_16x16x32_bf16 v[108:111], v[68:71], v[48:51], v[108:111]
  ds_read_b128 v[88:91], v14 offset:44032
  v_mfma_f32_16x16x32_bf16 v[112:115], v[72:75], v[48:51], v[112:115]
  ds_read_b128 v[92:95], v14 offset:45056
  s_waitcnt vmcnt(0) lgkmcnt(0)
  v_mfma_f32_16x16x32_bf16 v[96:99], v[76:79], v[52:55], v[96:99]
  v_mfma_f32_16x16x32_bf16 v[100:103], v[80:83], v[52:55], v[100:103]
  v_mfma_f32_16x16x32_bf16 v[104:107], v[84:87], v[52:55], v[104:107]
  v_mfma_f32_16x16x32_bf16 v[108:111], v[88:91], v[52:55], v[108:111]
  v_mfma_f32_16x16x32_bf16 v[112:115], v[92:95], v[52:55], v[112:115]
  s_barrier
  s_cmp_eq_u32 s73, 1
  s_cbranch_scc1 L_k1_101
  s_nop 3
  ds_write_b128 v10, v[108:111] offset:3072
  ds_write_b128 v10, v[112:115] offset:4096
  s_branch L_kj_102
L_k1_101:
  ds_write_b128 v10, v[96:99] offset:0
  ds_write_b128 v10, v[100:103] offset:1024
  ds_write_b128 v10, v[104:107] offset:2048
L_kj_102:
  s_waitcnt lgkmcnt(0)
  s_barrier
  s_cmp_eq_u32 s73, 1
  s_cbranch_scc1 L_e1_104
  ds_read_b128 v[120:123], v11 offset:0
  ds_read_b128 v[124:127], v11 offset:1024
  ds_read_b128 v[128:131], v11 offset:2048
  v_mov_b32 v16, 0
  v_mov_b32 v17, 0
  v_mov_b32 v18, 0
  v_mov_b32 v19, 0
  s_waitcnt lgkmcnt(0)
  v_lshlrev_b32 v20, 16, v150
  v_and_b32 v21, 0xffff0000, v150
  v_pk_add_f32 v[96:97], v[96:97], v[120:121]
  v_pk_add_f32 v[96:97], v[96:97], v[20:21]
  v_pk_add_f32 v[16:17], v[16:17], v[96:97]
  v_pk_fma_f32 v[18:19], v[96:97], v[96:97], v[18:19]
  v_lshlrev_b32 v20, 16, v151
  v_and_b32 v21, 0xffff0000, v151
  v_pk_add_f32 v[98:99], v[98:99], v[122:123]
  v_pk_add_f32 v[98:99], v[98:99], v[20:21]
  v_pk_add_f32 v[16:17], v[16:17], v[98:99]
  v_pk_fma_f32 v[18:19], v[98:99], v[98:99], v[18:19]
  v_cvt_pk_bf16_f32 v96, v96, v97
  v_cvt_pk_bf16_f32 v97, v98, v99
  s_mul_i32 s12, s71, 5
  s_add_u32 s12, s12, 0
  s_and_b32 s13, s12, 1
  s_lshl_b32 s13, s13, 3
  s_lshr_b32 s12, s12, 1
  s_mul_i32 s14, s77, 20
  s_add_u32 s12, s12, s14
  s_lshl_b32 s12, s12, 10
  s_add_u32 s12, s12, s13
  s_add_u32 s12, s12, 14680064
  s_cmp_eq_u32 s10, 0
  s_cbranch_scc1 L_hs_105
  buffer_store_dwordx2 v[96:97], v2, s[48:51], s12 offen
  s_branch L_hs_106
L_hs_105:
  buffer_store_dwordx2 v[96:97], v2, s[48:51], s12 offen sc1
L_hs_106:
  v_lshlrev_b32 v20, 16, v152
  v_and_b32 v21, 0xffff0000, v152
  v_pk_add_f32 v[100:101], v[100:101], v[124:125]
  v_pk_add_f32 v[100:101], v[100:101], v[20:21]
  v_pk_add_f32 v[16:17], v[16:17], v[100:101]
  v_pk_fma_f32 v[18:19], v[100:101], v[100:101], v[18:19]
  v_lshlrev_b32 v20, 16, v153
  v_and_b32 v21, 0xffff0000, v153
  v_pk_add_f32 v[102:103], v[102:103], v[126:127]
  v_pk_add_f32 v[102:103], v[102:103], v[20:21]
  v_pk_add_f32 v[16:17], v[16:17], v[102:103]
  v_pk_fma_f32 v[18:19], v[102:103], v[102:103], v[18:19]
  v_cvt_pk_bf16_f32 v100, v100, v101
  v_cvt_pk_bf16_f32 v101, v102, v103
  s_mul_i32 s12, s71, 5
  s_add_u32 s12, s12, 1
  s_and_b32 s13, s12, 1
  s_lshl_b32 s13, s13, 3
  s_lshr_b32 s12, s12, 1
  s_mul_i32 s14, s77, 20
  s_add_u32 s12, s12, s14
  s_lshl_b32 s12, s12, 10
  s_add_u32 s12, s12, s13
  s_add_u32 s12, s12, 14680064
  s_cmp_eq_u32 s10, 0
  s_cbranch_scc1 L_hs_107
  buffer_store_dwordx2 v[100:101], v2, s[48:51], s12 offen
  s_branch L_hs_108
L_hs_107:
  buffer_store_dwordx2 v[100:101], v2, s[48:51], s12 offen sc1
L_hs_108:
  v_lshlrev_b32 v20, 16, v154
  v_and_b32 v21, 0xffff0000, v154
  v_pk_add_f32 v[104:105], v[104:105], v[128:129]
  v_pk_add_f32 v[104:105], v[104:105], v[20:21]
  v_pk_add_f32 v[16:17], v[16:17], v[104:105]
  v_pk_fma_f32 v[18:19], v[104:105], v[104:105], v[18:19]
  v_lshlrev_b32 v20, 16, v155
  v_and_b32 v21, 0xffff0000, v155
  v_pk_add_f32 v[106:107], v[106:107], v[130:131]
  v_pk_add_f32 v[106:107], v[106:107], v[20:21]
  v_pk_add_f32 v[16:17], v[16:17], v[106:107]
  v_pk_fma_f32 v[18:19], v[106:107], v[106:107], v[18:19]
  v_cvt_pk_bf16_f32 v104, v104, v105
  v_cvt_pk_bf16_f32 v105, v106, v107
  s_mul_i32 s12, s71, 5
  s_add_u32 s12, s12, 2
  s_and_b32 s13, s12, 1
  s_lshl_b32 s13, s13, 3
  s_lshr_b32 s12, s12, 1
  s_mul_i32 s14, s77, 20
  s_add_u32 s12, s12, s14
  s_lshl_b32 s12, s12, 10
  s_add_u32 s12, s12, s13
  s_add_u32 s12, s12, 14680064
  s_cmp_eq_u32 s10, 0
  s_cbranch_scc1 L_hs_109
  buffer_store_dwordx2 v[104:105], v2, s[48:51], s12 offen
  s_branch L_hs_110
L_hs_109:
  buffer_store_dwordx2 v[104:105], v2, s[48:51], s12 offen sc1
L_hs_110:
  s_branch L_p2e_103
L_e1_104:
  s_nop 1
  ds_read_b128 v[132:135], v11 offset:3072
  ds_read_b128 v[136:139], v11 offset:4096
  v_mov_b32 v16, 0
  v_mov_b32 v17, 0
  v_mov_b32 v18, 0
  v_mov_b32 v19, 0
  s_waitcnt lgkmcnt(0)
  v_lshlrev_b32 v20, 16, v156
  v_and_b32 v21, 0xffff0000, v156
  v_pk_add_f32 v[108:109], v[108:109], v[132:133]
  v_pk_add_f32 v[108:109], v[108:109], v[20:21]
  v_pk_add_f32 v[16:17], v[16:17], v[108:109]
  v_pk_fma_f32 v[18:19], v[108:109], v[108:109], v[18:19]
  v_lshlrev_b32 v20, 16, v157
  v_and_b32 v21, 0xffff0000, v157
  v_pk_add_f32 v[110:111], v[110:111], v[134:135]
  v_pk_add_f32 v[110:111], v[110:111], v[20:21]
  v_pk_add_f32 v[16:17], v[16:17], v[110:111]
  v_pk_fma_f32 v[18:19], v[110:111], v[110:111], v[18:19]
  v_cvt_pk_bf16_f32 v108, v108, v109
  v_cvt_pk_bf16_f32 v109, v110, v111
  s_mul_i32 s12, s71, 5
  s_add_u32 s12, s12, 3
  s_and_b32 s13, s12, 1
  s_lshl_b32 s13, s13, 3
  s_lshr_b32 s12, s12, 1
  s_mul_i32 s14, s77, 20
  s_add_u32 s12, s12, s14
  s_lshl_b32 s12, s12, 10
  s_add_u32 s12, s12, s13
  s_add_u32 s12, s12, 14680064
  s_cmp_eq_u32 s10, 0
  s_cbranch_scc1 L_hs_111
  buffer_store_dwordx2 v[108:109], v2, s[48:51], s12 offen
  s_branch L_hs_112
L_hs_111:
  buffer_store_dwordx2 v[108:109], v2, s[48:51], s12 offen sc1
L_hs_112:
  v_lshlrev_b32 v20, 16, v158
  v_and_b32 v21, 0xffff0000, v158
  v_pk_add_f32 v[112:113], v[112:113], v[136:137]
  v_pk_add_f32 v[112:113], v[112:113], v[20:21]
  v_pk_add_f32 v[16:17], v[16:17], v[112:113]
  v_pk_fma_f32 v[18:19], v[112:113], v[112:113], v[18:19]
  v_lshlrev_b32 v20, 16, v159
  v_and_b32 v21, 0xffff0000, v159
  v_pk_add_f32 v[114:115], v[114:115], v[138:139]
  v_pk_add_f32 v[114:115], v[114:115], v[20:21]
  v_pk_add_f32 v[16:17], v[16:17], v[114:115]
  v_pk_fma_f32 v[18:19], v[114:115], v[114:115], v[18:19]
  v_cvt_pk_bf16_f32 v112, v112, v113
  v_cvt_pk_bf16_f32 v113, v114, v115
  s_mul_i32 s12, s71, 5
  s_add_u32 s12, s12, 4
  s_and_b32 s13, s12, 1
  s_lshl_b32 s13, s13, 3
  s_lshr_b32 s12, s12, 1
  s_mul_i32 s14, s77, 20
  s_add_u32 s12, s12, s14
  s_lshl_b32 s12, s12, 10
  s_add_u32 s12, s12, s13
  s_add_u32 s12, s12, 14680064
  s_cmp_eq_u32 s10, 0
  s_cbranch_scc1 L_hs_113
  buffer_store_dwordx2 v[112:113], v2, s[48:51], s12 offen
  s_branch L_hs_114
L_hs_113:
  buffer_store_dwordx2 v[112:113], v2, s[48:51], s12 offen sc1
L_hs_114:
L_p2e_103:
  s_nop 1
  v_add_f32 v16, v16, v17
  v_add_f32 v18, v18, v19
  v_mov_b32 v20, v16
  v_mov_b32 v21, v18
  s_nop 0
  v_permlane32_swap_b32 v16, v20
  v_permlane32_swap_b32 v18, v21
  v_add_f32 v16, v16, v20
  v_add_f32 v18, v18, v21
  v_mov_b32 v20, v16
  v_mov_b32 v21, v18
  s_nop 0
  v_permlane16_swap_b32 v16, v20
  v_permlane16_swap_b32 v18, v21
  v_add_f32 v16, v16, v20
  v_add_f32 v18, v18, v21
  v_mov_b32 v17, v18
  v_lshlrev_b32 v20, 4, v4
  v_mov_b32 v21, 0x20000000
  v_cmp_eq_u32 vcc, 0, v3
  s_nop 1
  v_cndmask_b32 v20, v21, v20, vcc
  s_lshl_b32 s12, s77, 11
  s_lshl_b32 s13, s71, 8
  s_add_u32 s12, s12, s13
  s_lshl_b32 s13, s73, 3
  s_add_u32 s12, s12, s13
  s_add_u32 s12, s12, 17825792
  s_cmp_eq_u32 s10, 0
  s_cbranch_scc1 L_hs_115
  buffer_store_dwordx2 v[16:17], v20, s[48:51], s12 offen
  s_branch L_hs_116
L_hs_115:
  buffer_store_dwordx2 v[16:17], v20, s[48:51], s12 offen sc1
L_hs_116:
  s_waitcnt vmcnt(0)
  s_barrier
  s_lshr_b32 s70, s8, 1
  s_and_b32 s71, s8, 1
  s_lshl_b32 s76, s4, 4
  s_lshl_b32 s12, s6, 3
  s_add_u32 s76, s76, s12
  s_lshl_b32 s12, s70, 1
  s_add_u32 s76, s76, s12
  s_add_u32 s77, s76, s71
  s_xor_b32 s12, s71, 1
  s_add_u32 s78, s76, s12
  s_mul_i32 s12, s77, 20
  s_mul_i32 s13, s71, 10
  s_add_u32 s12, s12, s13
  s_lshl_b32 s12, s12, 10
  s_add_u32 s80, s12, 14680064
  s_mul_i32 s12, s78, 20
  s_mul_i32 s13, s71, 10
  s_add_u32 s12, s12, s13
  s_lshl_b32 s12, s12, 10
  s_add_u32 s81, s12, 14680064
  s_mul_i32 s12, s71, 6144
  v_add_u32 v12, s12, v2
  v_add_u32 v13, 65536, v12
  v_add_u32 v14, 131072, v12
  s_mul_i32 s12, s8, 6144
  s_add_u32 s12, s12, 114688
  v_add_u32 v10, s12, v2
  s_xor_b32 s13, s8, 1
  s_mul_i32 s13, s13, 6144
  s_add_u32 s13, s13, 114688
  v_add_u32 v11, s13, v2
  s_barrier
  buffer_load_dwordx4 v[16:19], v2, s[48:51], s80 offen offset:0 sc1
  buffer_load_dwordx4 v[20:23], v2, s[48:51], s81 offen offset:0 sc1
  buffer_load_dwordx4 v[24:27], v2, s[48:51], s80 offen offset:1024 sc1
  buffer_load_dwordx4 v[28:31], v2, s[48:51], s81 offen offset:1024 sc1
  buffer_load_dwordx4 v[32:35], v2, s[48:51], s80 offen offset:2048 sc1
  buffer_load_dwordx4 v[36:39], v2, s[48:51], s81 offen offset:2048 sc1
  buffer_load_dwordx4 v[40:43], v2, s[48:51], s80 offen offset:3072 sc1
  buffer_load_dwordx4 v[44:47], v2, s[48:51], s81 offen offset:3072 sc1
  ds_read_b128 v[56:59], v13 offset:49152
  ds_read_b128 v[60:63], v13 offset:50176
  ds_read_b128 v[64:67], v13 offset:51200
  ds_read_b128 v[68:71], v13 offset:52224
  ds_read_b128 v[72:75], v13 offset:53248
  ds_read_b128 v[76:79], v13 offset:54272
  s_waitcnt vmcnt(6) lgkmcnt(0)
  v_mfma_f32_16x16x32_bf16 v[104:107], v[56:59], v[16:19], 0
  ds_read_b128 v[80:83], v13 offset:61440
  v_mfma_f32_16x16x32_bf16 v[108:111], v[60:63], v[16:19], 0
  ds_read_b128 v[84:87], v13 offset:62464
  v_mfma_f32_16x16x32_bf16 v[112:115], v[64:67], v[16:19], 0
  ds_read_b128 v[88:91], v13 offset:63488
  v_mfma_f32_16x16x32_bf16 v[116:119], v[68:71], v[16:19], 0
  ds_read_b128 v[92:95], v13 offset:64512
  v_mfma_f32_16x16x32_bf16 v[120:123], v[72:75], v[16:19], 0
  ds_read_b128 v[96:99], v14 offset:0
  v_mfma_f32_16x16x32_bf16 v[124:127], v[76:79], v[16:19], 0
  ds_read_b128 v[100:103], v14 offset:1024
  v_mfma_f32_16x16x32_bf16 v[128:131], v[56:59], v[20:23], 0
  v_mfma_f32_16x16x32_bf16 v[132:135], v[60:63], v[20:23], 0
  s_add_u32 s80, s80, 4096
  buffer_load_dwordx4 v[48:51], v2, s[48:51], s80 offen offset:0 sc1
  s_add_u32 s81, s81, 4096
  buffer_load_dwordx4 v[52:55], v2, s[48:51], s81 offen offset:0 sc1
  v_mfma_f32_16x16x32_bf16 v[136:139], v[64:67], v[20:23], 0
  v_mfma_f32_16x16x32_bf16 v[140:143], v[68:71], v[20:23], 0
  v_mfma_f32_16x16x32_bf16 v[144:147], v[72:75], v[20:23], 0
  v_mfma_f32_16x16x32_bf16 v[148:151], v[76:79], v[20:23], 0
  s_waitcnt vmcnt(6) lgkmcnt(0)
  v_mfma_f32_16x16x32_bf16 v[104:107], v[80:83], v[24:27], v[104:107]
  ds_read_b128 v[56:59], v14 offset:8192
  v_mfma_f32_16x16x32_bf16 v[108:111], v[84:87], v[24:27], v[108:111]
  ds_read_b128 v[60:63], v14 offset:9216
  v_mfma_f32_16x16x32_bf16 v[112:115], v[88:91], v[24:27], v[112:115]
  ds_read_b128 v[64:67], v14 offset:10240
  v_mfma_f32_16x16x32_bf16 v[116:119], v[92:95], v[24:27], v[116:119]
  ds_read_b128 v[68:71], v14 offset:11264
  v_mfma_f32_16x16x32_bf16 v[120:123], v[96:99], v[24:27], v[120:123]
  ds_read_b128 v[72:75], v14 offset:12288
  v_mfma_f32_16x16x32_bf16 v[124:127], v[100:103], v[24:27], v[124:127]
  ds_read_b128 v[76:79], v14 offset:13312
  v_mfma_f32_16x16x32_bf16 v[128:131], v[80:83], v[28:31], v[128:131]
  v_mfma_f32_16x16x32_bf16 v[132:135], v[84:87], v[28:31], v[132:135]
  buffer_load_dwordx4 v[16:19], v2, s[48:51], s80 offen offset:1024 sc1
  buffer_load_dwordx4 v[20:23], v2, s[48:51], s81 offen offset:1024 sc1
  v_mfma_f32_16x16x32_bf16 v[136:139], v[88:91], v[28:31], v[136:139]
  v_mfma_f32_16x16x32_bf16 v[140:143], v[92:95], v[28:31], v[140:143]
  v_mfma_f32_16x16x32_bf16 v[144:147], v[96:99], v[28:31], v[144:147]
  v_mfma_f32_16x16x32_bf16 v[148:151], v[100:103], v[28:31], v[148:151]
  s_waitcnt vmcnt(6) lgkmcnt(0)
  v_mfma_f32_16x16x32_bf16 v[104:107], v[56:59], v[32:35], v[104:107]
  ds_read_b128 v[80:83], v14 offset:20480
  v_mfma_f32_16x16x32_bf16 v[108:111], v[60:63], v[32:35], v[108:111]
  ds_read_b128 v[84:87], v14 offset:21504
  v_mfma_f32_16x16x32_bf16 v[112:115], v[64:67], v[32:35], v[112:115]
  ds_read_b128 v[88:91], v14 offset:22528
  v_mfma_f32_16x16x32_bf16 v[116:119], v[68:71], v[32:35], v[116:119]
  ds_read_b128 v[92:95], v14 offset:23552
  v_mfma_f32_16x16x32_bf16 v[120:123], v[72:75], v[32:35], v[120:123]
  ds_read_b128 v[96:99], v14 offset:24576
  v_mfma_f32_16x16x32_bf16 v[124:127], v[76:79], v[32:35], v[124:127]
  ds_read_b128 v[100:103], v14 offset:25600
  v_mfma_f32_16x16x32_bf16 v[128:131], v[56:59], v[36:39], v[128:131]
  v_mfma_f32_16x16x32_bf16 v[132:135], v[60:63], v[36:39], v[132:135]
  buffer_load_dwordx4 v[24:27], v2, s[48:51], s80 offen offset:2048 sc1
  buffer_load_dwordx4 v[28:31], v2, s[48:51], s81 offen offset:2048 sc1
  v_mfma_f32_16x16x32_bf16 v[136:139], v[64:67], v[36:39], v[136:139]
  v_mfma_f32_16x16x32_bf16 v[140:143], v[68:71], v[36:39], v[140:143]
  v_mfma_f32_16x16x32_bf16 v[144:147], v[72:75], v[36:39], v[144:147]
  v_mfma_f32_16x16x32_bf16 v[148:151], v[76:79], v[36:39], v[148:151]
  s_waitcnt vmcnt(6) lgkmcnt(0)
  v_mfma_f32_16x16x32_bf16 v[104:107], v[80:83], v[40:43], v[104:107]
  ds_read_b128 v[56:59], v12 offset:0
  v_mfma_f32_16x16x32_bf16 v[108:111], v[84:87], v[40:43], v[108:111]
  ds_read_b128 v[60:63], v12 offset:1024
  v_mfma_f32_16x16x32_bf16 v[112:115], v[88:91], v[40:43], v[112:115]
  ds_read_b128 v[64:67], v12 offset:2048
  v_mfma_f32_16x16x32_bf16 v[116:119], v[92:95], v[40:43], v[116:119]
  ds_read_b128 v[68:71], v12 offset:3072
  v_mfma_f32_16x16x32_bf16 v[120:123], v[96:99], v[40:43], v[120:123]
  ds_read_b128 v[72:75], v12 offset:4096
  v_mfma_f32_16x16x32_bf16 v[124:127], v[100:103], v[40:43], v[124:127]
  ds_read_b128 v[76:79], v12 offset:5120
  v_mfma_f32_16x16x32_bf16 v[128:131], v[80:83], v[44:47], v[128:131]
  v_mfma_f32_16x16x32_bf16 v[132:135], v[84:87], v[44:47], v[132:135]
  buffer_load_dwordx4 v[32:35], v2, s[48:51], s80 offen offset:3072 sc1
  buffer_load_dwordx4 v[36:39], v2, s[48:51], s81 offen offset:3072 sc1
  v_mfma_f32_16x16x32_bf16 v[136:139], v[88:91], v[44:47], v[136:139]
  v_mfma_f32_16x16x32_bf16 v[140:143], v[92:95], v[44:47], v[140:143]
  v_mfma_f32_16x16x32_bf16 v[144:147], v[96:99], v[44:47], v[144:147]
  v_mfma_f32_16x16x32_bf16 v[148:151], v[100:103], v[44:47], v[148:151]
  s_waitcnt vmcnt(6) lgkmcnt(0)
  s_barrier
  v_mfma_f32_16x16x32_bf16 v[104:107], v[56:59], v[48:51], v[104:107]
  ds_read_b128 v[80:83], v12 offset:12288
  v_mfma_f32_16x16x32_bf16 v[108:111], v[60:63], v[48:51], v[108:111]
  ds_read_b128 v[84:87], v12 offset:13312
  v_mfma_f32_16x16x32_bf16 v[112:115], v[64:67], v[48:51], v[112:115]
  ds_read_b128 v[88:91], v12 offset:14336
  v_mfma_f32_16x16x32_bf16 v[116:119], v[68:71], v[48:51], v[116:119]
  ds_read_b128 v[92:95], v12 offset:15360
  v_mfma_f32_16x16x32_bf16 v[120:123], v[72:75], v[48:51], v[120:123]
  ds_read_b128 v[96:99], v12 offset:16384
  v_mfma_f32_16x16x32_bf16 v[124:127], v[76:79], v[48:51], v[124:127]
  ds_read_b128 v[100:103], v12 offset:17408
  v_mfma_f32_16x16x32_bf16 v[128:131], v[56:59], v[52:55], v[128:131]
  v_mfma_f32_16x16x32_bf16 v[132:135], v[60:63], v[52:55], v[132:135]
  s_add_u32 s80, s80, 4096
  buffer_load_dwordx4 v[40:43], v2, s[48:51], s80 offen offset:0 sc1
  s_add_u32 s81, s81, 4096
  buffer_load_dwordx4 v[44:47], v2, s[48:51], s81 offen offset:0 sc1
  v_mfma_f32_16x16x32_bf16 v[136:139], v[64:67], v[52:55], v[136:139]
  v_mfma_f32_16x16x32_bf16 v[140:143], v[68:71], v[52:55], v[140:143]
  v_mfma_f32_16x16x32_bf16 v[144:147], v[72:75], v[52:55], v[144:147]
  v_mfma_f32_16x16x32_bf16 v[148:151], v[76:79], v[52:55], v[148:151]
  s_waitcnt vmcnt(6) lgkmcnt(0)
  v_mfma_f32_16x16x32_bf16 v[104:107], v[80:83], v[16:19], v[104:107]
  ds_read_b128 v[56:59], v12 offset:24576
  v_mfma_f32_16x16x32_bf16 v[108:111], v[84:87], v[16:19], v[108:111]
  ds_read_b128 v[60:63], v12 offset:25600
  v_mfma_f32_16x16x32_bf16 v[112:115], v[88:91], v[16:19], v[112:115]
  ds_read_b128 v[64:67], v12 offset:26624
  v_mfma_f32_16x16x32_bf16 v[116:119], v[92:95], v[16:19], v[116:119]
  ds_read_b128 v[68:71], v12 offset:27648
  v_mfma_f32_16x16x32_bf16 v[120:123], v[96:99], v[16:19], v[120:123]
  ds_read_b128 v[72:75], v12 offset:28672
  v_mfma_f32_16x16x32_bf16 v[124:127], v[100:103], v[16:19], v[124:127]
  ds_read_b128 v[76:79], v12 offset:29696
  v_mfma_f32_16x16x32_bf16 v[128:131], v[80:83], v[20:23], v[128:131]
  v_mfma_f32_16x16x32_bf16 v[132:135], v[84:87], v[20:23], v[132:135]
  buffer_load_dwordx4 v[48:51], v2, s[48:51], s80 offen offset:1024 sc1
  buffer_load_dwordx4 v[52:55], v2, s[48:51], s81 offen offset:1024 sc1
  v_mfma_f32_16x16x32_bf16 v[136:139], v[88:91], v[20:23], v[136:139]
  v_mfma_f32_16x16x32_bf16 v[140:143], v[92:95], v[20:23], v[140:143]
  v_mfma_f32_16x16x32_bf16 v[144:147], v[96:99], v[20:23], v[144:147]
  v_mfma_f32_16x16x32_bf16 v[148:151], v[100:103], v[20:23], v[148:151]
  s_lshl_b32 s12, s77, 11
  s_add_u32 s12, s12, 17825792
  buffer_load_dwordx4 v[152:155], v2, s[48:51], s12 offen offset:0 sc1
  buffer_load_dwordx4 v[156:159], v2, s[48:51], s12 offen offset:1024 sc1
  s_waitcnt vmcnt(8) lgkmcnt(0)
  v_mfma_f32_16x16x32_bf16 v[104:107], v[56:59], v[24:27], v[104:107]
  ds_read_b128 v[80:83], v12 offset:36864
  v_mfma_f32_16x16x32_bf16 v[108:111], v[60:63], v[24:27], v[108:111]
  ds_read_b128 v[84:87], v12 offset:37888
  v_mfma_f32_16x16x32_bf16 v[112:115], v[64:67], v[24:27], v[112:115]
  ds_read_b128 v[88:91], v12 offset:38912
  v_mfma_f32_16x16x32_bf16 v[116:119], v[68:71], v[24:27], v[116:119]
  ds_read_b128 v[92:95], v12 offset:39936
  v_mfma_f32_16x16x32_bf16 v[120:123], v[72:75], v[24:27], v[120:123]
  ds_read_b128 v[96:99], v12 offset:40960
  v_mfma_f32_16x16x32_bf16 v[124:127], v[76:79], v[24:27], v[124:127]
  ds_read_b128 v[100:103], v12 offset:41984
  v_mfma_f32_16x16x32_bf16 v[128:131], v[56:59], v[28:31], v[128:131]
  v_mfma_f32_16x16x32_bf16 v[132:135], v[60:63], v[28:31], v[132:135]
  v_mfma_f32_16x16x32_bf16 v[136:139], v[64:67], v[28:31], v[136:139]
  v_mfma_f32_16x16x32_bf16 v[140:143], v[68:71], v[28:31], v[140:143]
  v_mfma_f32_16x16x32_bf16 v[144:147], v[72:75], v[28:31], v[144:147]
  v_mfma_f32_16x16x32_bf16 v[148:151], v[76:79], v[28:31], v[148:151]
  s_waitcnt vmcnt(6) lgkmcnt(0)
  v_mfma_f32_16x16x32_bf16 v[104:107], v[80:83], v[32:35], v[104:107]
  ds_read_b128 v[56:59], v12 offset:49152
  v_mfma_f32_16x16x32_bf16 v[108:111], v[84:87], v[32:35], v[108:111]
  ds_read_b128 v[60:63], v12 offset:50176
  v_mfma_f32_16x16x32_bf16 v[112:115], v[88:91], v[32:35], v[112:115]
  ds_read_b128 v[64:67], v12 offset:51200
  v_mfma_f32_16x16x32_bf16 v[116:119], v[92:95], v[32:35], v[116:119]
  ds_read_b128 v[68:71], v12 offset:52224
  v_mfma_f32_16x16x32_bf16 v[120:123], v[96:99], v[32:35], v[120:123]
  ds_read_b128 v[72:75], v12 offset:53248
  v_mfma_f32_16x16x32_bf16 v[124:127], v[100:103], v[32:35], v[124:127]
  ds_read_b128 v[76:79], v12 offset:54272
  v_mfma_f32_16x16x32_bf16 v[128:131], v[80:83], v[36:39], v[128:131]
  v_mfma_f32_16x16x32_bf16 v[132:135], v[84:87], v[36:39], v[132:135]
  v_mfma_f32_16x16x32_bf16 v[136:139], v[88:91], v[36:39], v[136:139]
  v_mfma_f32_16x16x32_bf16 v[140:143], v[92:95], v[36:39], v[140:143]
  v_mfma_f32_16x16x32_bf16 v[144:147], v[96:99], v[36:39], v[144:147]
  v_mfma_f32_16x16x32_bf16 v[148:151], v[100:103], v[36:39], v[148:151]
  s_waitcnt vmcnt(4) lgkmcnt(0)
  v_mfma_f32_16x16x32_bf16 v[104:107], v[56:59], v[40:43], v[104:107]
  ds_read_b128 v[80:83], v12 offset:61440
  v_mfma_f32_16x16x32_bf16 v[108:111], v[60:63], v[40:43], v[108:111]
  ds_read_b128 v[84:87], v12 offset:62464
  v_mfma_f32_16x16x32_bf16 v[112:115], v[64:67], v[40:43], v[112:115]
  ds_read_b128 v[88:91], v12 offset:63488
  v_mfma_f32_16x16x32_bf16 v[116:119], v[68:71], v[40:43], v[116:119]
  ds_read_b128 v[92:95], v12 offset:64512
  v_mfma_f32_16x16x32_bf16 v[120:123], v[72:75], v[40:43], v[120:123]
  ds_read_b128 v[96:99], v13 offset:0
  v_mfma_f32_16x16x32_bf16 v[124:127], v[76:79], v[40:43], v[124:127]
  ds_read_b128 v[100:103], v13 offset:1024
  v_mfma_f32_16x16x32_bf16 v[128:131], v[56:59], v[44:47], v[128:131]
  v_mfma_f32_16x16x32_bf16 v[132:135], v[60:63], v[44:47], v[132:135]
  v_mfma_f32_16x16x32_bf16 v[136:139], v[64:67], v[44:47], v[136:139]
  v_mfma_f32_16x16x32_bf16 v[140:143], v[68:71], v[44:47], v[140:143]
  v_mfma_f32_16x16x32_bf16 v[144:147], v[72:75], v[44:47], v[144:147]
  v_mfma_f32_16x16x32_bf16 v[148:151], v[76:79], v[44:47], v[148:151]
  s_waitcnt vmcnt(2) lgkmcnt(0)
  v_mfma_f32_16x16x32_bf16 v[104:107], v[80:83], v[48:51], v[104:107]
  v_mfma_f32_16x16x32_bf16 v[108:111], v[84:87], v[48:51], v[108:111]
  v_mfma_f32_16x16x32_bf16 v[112:115], v[88:91], v[48:51], v[112:115]
  v_mfma_f32_16x16x32_bf16 v[116:119], v[92:95], v[48:51], v[116:119]
  v_mfma_f32_16x16x32_bf16 v[120:123], v[96:99], v[48:51], v[120:123]
  v_mfma_f32_16x16x32_bf16 v[124:127], v[100:103], v[48:51], v[124:127]
  v_mfma_f32_16x16x32_bf16 v[128:131], v[80:83], v[52:55], v[128:131]
  v_mfma_f32_16x16x32_bf16 v[132:135], v[84:87], v[52:55], v[132:135]
  v_mfma_f32_16x16x32_bf16 v[136:139], v[88:91], v[52:55], v[136:139]
  v_mfma_f32_16x16x32_bf16 v[140:143], v[92:95], v[52:55], v[140:143]
  v_mfma_f32_16x16x32_bf16 v[144:147], v[96:99], v[52:55], v[144:147]
  v_mfma_f32_16x16x32_bf16 v[148:151], v[100:103], v[52:55], v[148:151]
  s_nop 2
  ds_write_b128 v10, v[128:131] offset:0
  ds_write_b128 v10, v[132:135] offset:1024
  ds_write_b128 v10, v[136:139] offset:2048
  ds_write_b128 v10, v[140:143] offset:3072
  ds_write_b128 v10, v[144:147] offset:4096
  ds_write_b128 v10, v[148:151] offset:5120
  s_waitcnt vmcnt(0)
  v_pk_add_f32 v[152:153], v[152:153], v[154:155]
  v_pk_add_f32 v[152:153], v[152:153], v[156:157]
  v_pk_add_f32 v[152:153], v[152:153], v[158:159]
  v_mov_b32 v156, v152
  v_mov_b32 v157, v153
  s_nop 0
  v_permlane32_swap_b32 v152, v156
  v_permlane32_swap_b32 v153, v157
  v_pk_add_f32 v[152:153], v[152:153], v[156:157]
  v_mov_b32 v156, v152
  v_mov_b32 v157, v153
  s_nop 0
  v_permlane16_swap_b32 v152, v156
  v_permlane16_swap_b32 v153, v157
  v_pk_add_f32 v[152:153], v[152:153], v[156:157]
  v_mul_f32 v152, 0x3acccccd, v152
  v_mul_f32 v153, 0x3acccccd, v153
  v_fma_f32 v153, -v152, v152, v153
  v_max_f32 v153, 0, v153
  v_add_f32 v154, 0x3727c5ac, v153
  v_rsq_f32 v154, v154
  s_nop 0
  v_mul_f32 v155, v154, v154
  v_fmaak_f32 v155, v153, v155, 0x3727c5ac
  v_rsq_f32 v155, v155
  s_nop 0
  v_mul_f32 v154, v154, v155
  s_waitcnt lgkmcnt(0)
  s_barrier
  ds_read_b128 v[128:131], v11 offset:0
  ds_read_b128 v[132:135], v11 offset:1024
  ds_read_b128 v[136:139], v11 offset:2048
  ds_read_b128 v[140:143], v11 offset:3072
  ds_read_b128 v[144:147], v11 offset:4096
  ds_read_b128 v[148:151], v11 offset:5120
  v_lshlrev_b32 v12, 4, v3
  v_add_u32 v12, 73728, v12
  ds_read_b128 v[16:19], v12 offset:0
  ds_read_b128 v[40:43], v12 offset:512
  ds_read_b128 v[20:23], v12 offset:64
  ds_read_b128 v[44:47], v12 offset:576
  ds_read_b128 v[24:27], v12 offset:128
  ds_read_b128 v[48:51], v12 offset:640
  ds_read_b128 v[28:31], v12 offset:192
  ds_read_b128 v[52:55], v12 offset:704
  ds_read_b128 v[32:35], v12 offset:256
  ds_read_b128 v[56:59], v12 offset:768
  ds_read_b128 v[36:39], v12 offset:320
  ds_read_b128 v[60:63], v12 offset:832
  s_mov_b32 s80, 0xc0135761
  s_mov_b32 s81, 0xc0135761
  s_mov_b32 s82, 0xbdd2d3e8
  s_mov_b32 s83, 0xbdd2d3e8
  v_mov_b32 v70, s80
  v_mov_b32 v71, s81
  s_waitcnt lgkmcnt(0)
  s_barrier
  v_pk_add_f32 v[104:105], v[104:105], v[128:129]
  v_pk_fma_f32 v[104:105], v[16:17], v[152:153], v[104:105] op_sel_hi:[1,0,1] neg_lo:[1,0,0] neg_hi:[1,0,0]
  v_pk_fma_f32 v[104:105], v[104:105], v[154:155], v[40:41] op_sel_hi:[1,0,1]
  v_pk_mul_f32 v[64:65], v[104:105], v[104:105]
  v_pk_fma_f32 v[64:65], v[64:65], s[82:83], v[70:71]
  v_pk_mul_f32 v[64:65], v[64:65], v[104:105]
  v_pk_add_f32 v[106:107], v[106:107], v[130:131]
  v_pk_fma_f32 v[106:107], v[18:19], v[152:153], v[106:107] op_sel_hi:[1,0,1] neg_lo:[1,0,0] neg_hi:[1,0,0]
  v_pk_fma_f32 v[106:107], v[106:107], v[154:155], v[42:43] op_sel_hi:[1,0,1]
  v_pk_mul_f32 v[66:67], v[106:107], v[106:107]
  v_pk_fma_f32 v[66:67], v[66:67], s[82:83], v[70:71]
  v_pk_mul_f32 v[66:67], v[66:67], v[106:107]
  v_exp_f32 v64, v64
  v_exp_f32 v65, v65
  v_exp_f32 v66, v66
  v_exp_f32 v67, v67
  v_pk_add_f32 v[64:65], v[64:65], 1.0 op_sel_hi:[1,0]
  v_pk_add_f32 v[66:67], v[66:67], 1.0 op_sel_hi:[1,0]
  v_rcp_f32 v64, v64
  v_rcp_f32 v65, v65
  v_rcp_f32 v66, v66
  v_rcp_f32 v67, v67
  v_pk_mul_f32 v[104:105], v[104:105], v[64:65]
  v_pk_mul_f32 v[106:107], v[106:107], v[66:67]
  v_cvt_pk_bf16_f32 v72, v104, v105
  v_cvt_pk_bf16_f32 v73, v106, v107
  v_pk_add_f32 v[108:109], v[108:109], v[132:133]
  v_pk_fma_f32 v[108:109], v[20:21], v[152:153], v[108:109] op_sel_hi:[1,0,1] neg_lo:[1,0,0] neg_hi:[1,0,0]
  v_pk_fma_f32 v[108:109], v[108:109], v[154:155], v[44:45] op_sel_hi:[1,0,1]
  v_pk_mul_f32 v[64:65], v[108:109], v[108:109]
  v_pk_fma_f32 v[64:65], v[64:65], s[82:83], v[70:71]
  v_pk_mul_f32 v[64:65], v[64:65], v[108:109]
  v_pk_add_f32 v[110:111], v[110:111], v[134:135]
  v_pk_fma_f32 v[110:111], v[22:23], v[152:153], v[110:111] op_sel_hi:[1,0,1] neg_lo:[1,0,0] neg_hi:[1,0,0]
  v_pk_fma_f32 v[110:111], v[110:111], v[154:155], v[46:47] op_sel_hi:[1,0,1]
  v_pk_mul_f32 v[66:67], v[110:111], v[110:111]
  v_pk_fma_f32 v[66:67], v[66:67], s[82:83], v[70:71]
  v_pk_mul_f32 v[66:67], v[66:67], v[110:111]
  v_exp_f32 v64, v64
  v_exp_f32 v65, v65
  v_exp_f32 v66, v66
  v_exp_f32 v67, v67
  v_pk_add_f32 v[64:65], v[64:65], 1.0 op_sel_hi:[1,0]
  v_pk_add_f32 v[66:67], v[66:67], 1.0 op_sel_hi:[1,0]
  v_rcp_f32 v64, v64
  v_rcp_f32 v65, v65
  v_rcp_f32 v66, v66
  v_rcp_f32 v67, v67
  v_pk_mul_f32 v[108:109], v[108:109], v[64:65]
  v_pk_mul_f32 v[110:111], v[110:111], v[66:67]
  v_cvt_pk_bf16_f32 v74, v108, v109
  v_cvt_pk_bf16_f32 v75, v110, v111
  s_mul_i32 s12, s77, 48
  s_mul_i32 s13, s7, 3
  s_add_u32 s12, s12, s13
  s_add_u32 s12, s12, 0
  s_lshl_b32 s12, s12, 10
  s_add_u32 s12, s12, 18874368
  s_cmp_eq_u32 s10, 0
  s_cbranch_scc1 L_hs_117
  buffer_store_dwordx4 v[72:75], v2, s[48:51], s12 offen
  s_branch L_hs_118
L_hs_117:
  buffer_store_dwordx4 v[72:75], v2, s[48:51], s12 offen sc1
L_hs_118:
  v_pk_add_f32 v[112:113], v[112:113], v[136:137]
  v_pk_fma_f32 v[112:113], v[24:25], v[152:153], v[112:113] op_sel_hi:[1,0,1] neg_lo:[1,0,0] neg_hi:[1,0,0]
  v_pk_fma_f32 v[112:113], v[112:113], v[154:155], v[48:49] op_sel_hi:[1,0,1]
  v_pk_mul_f32 v[64:65], v[112:113], v[112:113]
  v_pk_fma_f32 v[64:65], v[64:65], s[82:83], v[70:71]
  v_pk_mul_f32 v[64:65], v[64:65], v[112:113]
  v_pk_add_f32 v[114:115], v[114:115], v[138:139]
  v_pk_fma_f32 v[114:115], v[26:27], v[152:153], v[114:115] op_sel_hi:[1,0,1] neg_lo:[1,0,0] neg_hi:[1,0,0]
  v_pk_fma_f32 v[114:115], v[114:115], v[154:155], v[50:51] op_sel_hi:[1,0,1]
  v_pk_mul_f32 v[66:67], v[114:115], v[114:115]
  v_pk_fma_f32 v[66:67], v[66:67], s[82:83], v[70:71]
  v_pk_mul_f32 v[66:67], v[66:67], v[114:115]
  v_exp_f32 v64, v64
  v_exp_f32 v65, v65
  v_exp_f32 v66, v66
  v_exp_f32 v67, v67
  v_pk_add_f32 v[64:65], v[64:65], 1.0 op_sel_hi:[1,0]
  v_pk_add_f32 v[66:67], v[66:67], 1.0 op_sel_hi:[1,0]
  v_rcp_f32 v64, v64
  v_rcp_f32 v65, v65
  v_rcp_f32 v66, v66
  v_rcp_f32 v67, v67
  v_pk_mul_f32 v[112:113], v[112:113], v[64:65]
  v_pk_mul_f32 v[114:115], v[114:115], v[66:67]
  v_cvt_pk_bf16_f32 v76, v112, v113
  v_cvt_pk_bf16_f32 v77, v114, v115
  v_pk_add_f32 v[116:117], v[116:117], v[140:141]
  v_pk_fma_f32 v[116:117], v[28:29], v[152:153], v[116:117] op_sel_hi:[1,0,1] neg_lo:[1,0,0] neg_hi:[1,0,0]
  v_pk_fma_f32 v[116:117], v[116:117], v[154:155], v[52:53] op_sel_hi:[1,0,1]
  v_pk_mul_f32 v[64:65], v[116:117], v[116:117]
  v_pk_fma_f32 v[64:65], v[64:65], s[82:83], v[70:71]
  v_pk_mul_f32 v[64:65], v[64:65], v[116:117]
  v_pk_add_f32 v[118:119], v[118:119], v[142:143]
  v_pk_fma_f32 v[118:119], v[30:31], v[152:153], v[118:119] op_sel_hi:[1,0,1] neg_lo:[1,0,0] neg_hi:[1,0,0]
  v_pk_fma_f32 v[118:119], v[118:119], v[154:155], v[54:55] op_sel_hi:[1,0,1]
  v_pk_mul_f32 v[66:67], v[118:119], v[118:119]
  v_pk_fma_f32 v[66:67], v[66:67], s[82:83], v[70:71]
  v_pk_mul_f32 v[66:67], v[66:67], v[118:119]
  v_exp_f32 v64, v64
  v_exp_f32 v65, v65
  v_exp_f32 v66, v66
  v_exp_f32 v67, v67
  v_pk_add_f32 v[64:65], v[64:65], 1.0 op_sel_hi:[1,0]
  v_pk_add_f32 v[66:67], v[66:67], 1.0 op_sel_hi:[1,0]
  v_rcp_f32 v64, v64
  v_rcp_f32 v65, v65
  v_rcp_f32 v66, v66
  v_rcp_f32 v67, v67
  v_pk_mul_f32 v[116:117], v[116:117], v[64:65]
  v_pk_mul_f32 v[118:119], v[118:119], v[66:67]
  v_cvt_pk_bf16_f32 v78, v116, v117
  v_cvt_pk_bf16_f32 v79, v118, v119
  s_mul_i32 s12, s77, 48
  s_mul_i32 s13, s7, 3
  s_add_u32 s12, s12, s13
  s_add_u32 s12, s12, 1
  s_lshl_b32 s12, s12, 10
  s_add_u32 s12, s12, 18874368
  s_cmp_eq_u32 s10, 0
  s_cbranch_scc1 L_hs_119
  buffer_store_dwordx4 v[76:79], v2, s[48:51], s12 offen
  s_branch L_hs_120
L_hs_119:
  buffer_store_dwordx4 v[76:79], v2, s[48:51], s12 offen sc1
L_hs_120:
  v_pk_add_f32 v[120:121], v[120:121], v[144:145]
  v_pk_fma_f32 v[120:121], v[32:33], v[152:153], v[120:121] op_sel_hi:[1,0,1] neg_lo:[1,0,0] neg_hi:[1,0,0]
  v_pk_fma_f32 v[120:121], v[120:121], v[154:155], v[56:57] op_sel_hi:[1,0,1]
  v_pk_mul_f32 v[64:65], v[120:121], v[120:121]
  v_pk_fma_f32 v[64:65], v[64:65], s[82:83], v[70:71]
  v_pk_mul_f32 v[64:65], v[64:65], v[120:121]
  v_pk_add_f32 v[122:123], v[122:123], v[146:147]
  v_pk_fma_f32 v[122:123], v[34:35], v[152:153], v[122:123] op_sel_hi:[1,0,1] neg_lo:[1,0,0] neg_hi:[1,0,0]
  v_pk_fma_f32 v[122:123], v[122:123], v[154:155], v[58:59] op_sel_hi:[1,0,1]
  v_pk_mul_f32 v[66:67], v[122:123], v[122:123]
  v_pk_fma_f32 v[66:67], v[66:67], s[82:83], v[70:71]
  v_pk_mul_f32 v[66:67], v[66:67], v[122:123]
  v_exp_f32 v64, v64
  v_exp_f32 v65, v65
  v_exp_f32 v66, v66
  v_exp_f32 v67, v67
  v_pk_add_f32 v[64:65], v[64:65], 1.0 op_sel_hi:[1,0]
  v_pk_add_f32 v[66:67], v[66:67], 1.0 op_sel_hi:[1,0]
  v_rcp_f32 v64, v64
  v_rcp_f32 v65, v65
  v_rcp_f32 v66, v66
  v_rcp_f32 v67, v67
  v_pk_mul_f32 v[120:121], v[120:121], v[64:65]
  v_pk_mul_f32 v[122:123], v[122:123], v[66:67]
  v_cvt_pk_bf16_f32 v80, v120, v121
  v_cvt_pk_bf16_f32 v81, v122, v123
  v_pk_add_f32 v[124:125], v[124:125], v[148:149]
  v_pk_fma_f32 v[124:125], v[36:37], v[152:153], v[124:125] op_sel_hi:[1,0,1] neg_lo:[1,0,0] neg_hi:[1,0,0]
  v_pk_fma_f32 v[124:125], v[124:125], v[154:155], v[60:61] op_sel_hi:[1,0,1]
  v_pk_mul_f32 v[64:65], v[124:125], v[124:125]
  v_pk_fma_f32 v[64:65], v[64:65], s[82:83], v[70:71]
  v_pk_mul_f32 v[64:65], v[64:65], v[124:125]
  v_pk_add_f32 v[126:127], v[126:127], v[150:151]
  v_pk_fma_f32 v[126:127], v[38:39], v[152:153], v[126:127] op_sel_hi:[1,0,1] neg_lo:[1,0,0] neg_hi:[1,0,0]
  v_pk_fma_f32 v[126:127], v[126:127], v[154:155], v[62:63] op_sel_hi:[1,0,1]
  v_pk_mul_f32 v[66:67], v[126:127], v[126:127]
  v_pk_fma_f32 v[66:67], v[66:67], s[82:83], v[70:71]
  v_pk_mul_f32 v[66:67], v[66:67], v[126:127]
  v_exp_f32 v64, v64
  v_exp_f32 v65, v65
  v_exp_f32 v66, v66
  v_exp_f32 v67, v67
  v_pk_add_f32 v[64:65], v[64:65], 1.0 op_sel_hi:[1,0]
  v_pk_add_f32 v[66:67], v[66:67], 1.0 op_sel_hi:[1,0]
  v_rcp_f32 v64, v64
  v_rcp_f32 v65, v65
  v_rcp_f32 v66, v66
  v_rcp_f32 v67, v67
  v_pk_mul_f32 v[124:125], v[124:125], v[64:65]
  v_pk_mul_f32 v[126:127], v[126:127], v[66:67]
  v_cvt_pk_bf16_f32 v82, v124, v125
  v_cvt_pk_bf16_f32 v83, v126, v127
  s_mul_i32 s12, s77, 48
  s_mul_i32 s13, s7, 3
  s_add_u32 s12, s12, s13
  s_add_u32 s12, s12, 2
  s_lshl_b32 s12, s12, 10
  s_add_u32 s12, s12, 18874368
  s_cmp_eq_u32 s10, 0
  s_cbranch_scc1 L_hs_121
  buffer_store_dwordx4 v[80:83], v2, s[48:51], s12 offen
  s_branch L_hs_122
L_hs_121:
  buffer_store_dwordx4 v[80:83], v2, s[48:51], s12 offen sc1
L_hs_122:
  s_waitcnt vmcnt(0)
  s_barrier
  s_lshr_b32 s70, s5, 3
  s_and_b32 s71, s5, 7
  s_lshr_b32 s72, s8, 1
  s_and_b32 s73, s8, 1
  s_lshl_b32 s76, s4, 4
  s_lshl_b32 s12, s70, 2
  s_add_u32 s76, s76, s12
  s_lshl_b32 s12, s73, 1
  s_add_u32 s76, s76, s12
  s_and_b32 s12, s72, 1
  s_add_u32 s77, s76, s12
  s_xor_b32 s12, s12, 1
  s_add_u32 s78, s76, s12
  s_mov_b32 s64, s30
  s_mov_b32 s65, s31
  s_mov_b32 s66, 1280
  s_mov_b32 s67, 0x20000
  s_cmp_ge_u32 s72, 2
  s_cbranch_scc1 L_x_123
  s_mul_i32 s12, s71, 5
  s_add_u32 s12, s12, 0
  s_and_b32 s13, s12, 1
  s_lshl_b32 s13, s13, 3
  s_lshr_b32 s12, s12, 1
  s_mul_i32 s14, s77, 20
  s_add_u32 s12, s12, s14
  s_lshl_b32 s12, s12, 10
  s_add_u32 s12, s12, s13
  s_add_u32 s12, s12, 14680064
  buffer_load_dwordx2 v[140:141], v2, s[48:51], s12 offen sc1
  s_mul_i32 s12, s71, 5
  s_add_u32 s12, s12, 1
  s_and_b32 s13, s12, 1
  s_lshl_b32 s13, s13, 3
  s_lshr_b32 s12, s12, 1
  s_mul_i32 s14, s77, 20
  s_add_u32 s12, s12, s14
  s_lshl_b32 s12, s12, 10
  s_add_u32 s12, s12, s13
  s_add_u32 s12, s12, 14680064
  buffer_load_dwordx2 v[142:143], v2, s[48:51], s12 offen sc1
  s_mul_i32 s12, s71, 5
  s_add_u32 s12, s12, 2
  s_and_b32 s13, s12, 1
  s_lshl_b32 s13, s13, 3
  s_lshr_b32 s12, s12, 1
  s_mul_i32 s14, s77, 20
  s_add_u32 s12, s12, s14
  s_lshl_b32 s12, s12, 10
  s_add_u32 s12, s12, s13
  s_add_u32 s12, s12, 14680064
  buffer_load_dwordx2 v[144:145], v2, s[48:51], s12 offen sc1
  s_mul_i32 s12, s71, 5
  s_add_u32 s12, s12, 3
  s_and_b32 s13, s12, 1
  s_lshl_b32 s13, s13, 3
  s_lshr_b32 s12, s12, 1
  s_mul_i32 s14, s77, 20
  s_add_u32 s12, s12, s14
  s_lshl_b32 s12, s12, 10
  s_add_u32 s12, s12, s13
  s_add_u32 s12, s12, 14680064
  buffer_load_dwordx2 v[146:147], v2, s[48:51], s12 offen sc1
  s_mul_i32 s12, s71, 5
  s_add_u32 s12, s12, 4
  s_and_b32 s13, s12, 1
  s_lshl_b32 s13, s13, 3
  s_lshr_b32 s12, s12, 1
  s_mul_i32 s14, s77, 20
  s_add_u32 s12, s12, s14
  s_lshl_b32 s12, s12, 10
  s_add_u32 s12, s12, s13
  s_add_u32 s12, s12, 14680064
  buffer_load_dwordx2 v[148:149], v2, s[48:51], s12 offen sc1
  v_lshlrev_b32 v12, 3, v3
  s_mul_i32 s12, s71, 160
  buffer_load_dwordx2 v[150:151], v12, s[64:67], s12 offen offset:0
  buffer_load_dwordx2 v[152:153], v12, s[64:67], s12 offen offset:32
  buffer_load_dwordx2 v[154:155], v12, s[64:67], s12 offen offset:64
  buffer_load_dwordx2 v[156:157], v12, s[64:67], s12 offen offset:96
  buffer_load_dwordx2 v[158:159], v12, s[64:67], s12 offen offset:128
L_x_123:
  s_mul_i32 s12, s77, 48
  s_mul_i32 s13, s72, 12
  s_add_u32 s12, s12, s13
  s_lshl_b32 s12, s12, 10
  s_add_u32 s80, s12, 18874368
  s_mul_i32 s12, s78, 48
  s_mul_i32 s13, s72, 12
  s_add_u32 s12, s12, s13
  s_lshl_b32 s12, s12, 10
  s_add_u32 s81, s12, 18874368
  s_mul_i32 s12, s72, 5120
  v_add_u32 v13, s12, v2
  v_add_u32 v14, 65536, v13
  v_add_u32 v12, 131072, v13
  s_barrier
  buffer_load_dwordx4 v[16:19], v2, s[48:51], s80 offen offset:0 sc1
  buffer_load_dwordx4 v[20:23], v2, s[48:51], s81 offen offset:0 sc1
  buffer_load_dwordx4 v[24:27], v2, s[48:51], s80 offen offset:1024 sc1
  buffer_load_dwordx4 v[28:31], v2, s[48:51], s81 offen offset:1024 sc1
  buffer_load_dwordx4 v[32:35], v2, s[48:51], s80 offen offset:2048 sc1
  buffer_load_dwordx4 v[36:39], v2, s[48:51], s81 offen offset:2048 sc1
  buffer_load_dwordx4 v[40:43], v2, s[48:51], s80 offen offset:3072 sc1
  buffer_load_dwordx4 v[44:47], v2, s[48:51], s81 offen offset:3072 sc1
  ds_read_b128 v[56:59], v14 offset:16384
  ds_read_b128 v[60:63], v14 offset:17408
  ds_read_b128 v[64:67], v14 offset:18432
  ds_read_b128 v[68:71], v14 offset:19456
  ds_read_b128 v[72:75], v14 offset:20480
  s_waitcnt vmcnt(6) lgkmcnt(0)
  v_mfma_f32_16x16x32_bf16 v[96:99], v[56:59], v[16:19], 0
  ds_read_b128 v[76:79], v13 offset:0
  v_mfma_f32_16x16x32_bf16 v[100:103], v[60:63], v[16:19], 0
  ds_read_b128 v[80:83], v13 offset:1024
  v_mfma_f32_16x16x32_bf16 v[104:107], v[64:67], v[16:19], 0
  ds_read_b128 v[84:87], v13 offset:2048
  v_mfma_f32_16x16x32_bf16 v[108:111], v[68:71], v[16:19], 0
  ds_read_b128 v[88:91], v13 offset:3072
  v_mfma_f32_16x16x32_bf16 v[112:115], v[72:75], v[16:19], 0
  ds_read_b128 v[92:95], v13 offset:4096
  v_mfma_f32_16x16x32_bf16 v[116:119], v[56:59], v[20:23], 0
  v_mfma_f32_16x16x32_bf16 v[120:123], v[60:63], v[20:23], 0
  s_add_u32 s80, s80, 4096
  buffer_load_dwordx4 v[48:51], v2, s[48:51], s80 offen offset:0 sc1
  s_add_u32 s81, s81, 4096
  buffer_load_dwordx4 v[52:55], v2, s[48:51], s81 offen offset:0 sc1
  v_mfma_f32_16x16x32_bf16 v[124:127], v[64:67], v[20:23], 0
  v_mfma_f32_16x16x32_bf16 v[128:131], v[68:71], v[20:23], 0
  v_mfma_f32_16x16x32_bf16 v[132:135], v[72:75], v[20:23], 0
  s_waitcnt vmcnt(6) lgkmcnt(0)
  v_mfma_f32_16x16x32_bf16 v[96:99], v[76:79], v[24:27], v[96:99]
  ds_read_b128 v[56:59], v13 offset:20480
  v_mfma_f32_16x16x32_bf16 v[100:103], v[80:83], v[24:27], v[100:103]
  ds_read_b128 v[60:63], v13 offset:21504
  v_mfma_f32_16x16x32_bf16 v[104:107], v[84:87], v[24:27], v[104:107]
  ds_read_b128 v[64:67], v13 offset:22528
  v_mfma_f32_16x16x32_bf16 v[108:111], v[88:91], v[24:27], v[108:111]
  ds_read_b128 v[68:71], v13 offset:23552
  v_mfma_f32_16x16x32_bf16 v[112:115], v[92:95], v[24:27], v[112:115]
  ds_read_b128 v[72:75], v13 offset:24576
  v_mfma_f32_16x16x32_bf16 v[116:119], v[76:79], v[28:31], v[116:119]
  v_mfma_f32_16x16x32_bf16 v[120:123], v[80:83], v[28:31], v[120:123]
  buffer_load_dwordx4 v[16:19], v2, s[48:51], s80 offen offset:1024 sc1
  buffer_load_dwordx4 v[20:23], v2, s[48:51], s81 offen offset:1024 sc1
  v_mfma_f32_16x16x32_bf16 v[124:127], v[84:87], v[28:31], v[124:127]
  v_mfma_f32_16x16x32_bf16 v[128:131], v[88:91], v[28:31], v[128:131]
  v_mfma_f32_16x16x32_bf16 v[132:135], v[92:95], v[28:31], v[132:135]
  s_waitcnt vmcnt(6) lgkmcnt(0)
  v_mfma_f32_16x16x32_bf16 v[96:99], v[56:59], v[32:35], v[96:99]
  ds_read_b128 v[76:79], v13 offset:40960
  v_mfma_f32_16x16x32_bf16 v[100:103], v[60:63], v[32:35], v[100:103]
  ds_read_b128 v[80:83], v13 offset:41984
  v_mfma_f32_16x16x32_bf16 v[104:107], v[64:67], v[32:35], v[104:107]
  ds_read_b128 v[84:87], v13 offset:43008
  v_mfma_f32_16x16x32_bf16 v[108:111], v[68:71], v[32:35], v[108:111]
  ds_read_b128 v[88:91], v13 offset:44032
  v_mfma_f32_16x16x32_bf16 v[112:115], v[72:75], v[32:35], v[112:115]
  ds_read_b128 v[92:95], v13 offset:45056
  v_mfma_f32_16x16x32_bf16 v[116:119], v[56:59], v[36:39], v[116:119]
  v_mfma_f32_16x16x32_bf16 v[120:123], v[60:63], v[36:39], v[120:123]
  buffer_load_dwordx4 v[24:27], v2, s[48:51], s80 offen offset:2048 sc1
  buffer_load_dwordx4 v[28:31], v2, s[48:51], s81 offen offset:2048 sc1
  v_mfma_f32_16x16x32_bf16 v[124:127], v[64:67], v[36:39], v[124:127]
  v_mfma_f32_16x16x32_bf16 v[128:131], v[68:71], v[36:39], v[128:131]
  v_mfma_f32_16x16x32_bf16 v[132:135], v[72:75], v[36:39], v[132:135]
  s_waitcnt vmcnt(6) lgkmcnt(0)
  s_barrier
  v_mfma_f32_16x16x32_bf16 v[96:99], v[76:79], v[40:43], v[96:99]
  ds_read_b128 v[56:59], v13 offset:61440
  v_mfma_f32_16x16x32_bf16 v[100:103], v[80:83], v[40:43], v[100:103]
  ds_read_b128 v[60:63], v13 offset:62464
  v_mfma_f32_16x16x32_bf16 v[104:107], v[84:87], v[40:43], v[104:107]
  ds_read_b128 v[64:67], v13 offset:63488
  v_mfma_f32_16x16x32_bf16 v[108:111], v[88:91], v[40:43], v[108:111]
  ds_read_b128 v[68:71], v13 offset:64512
  v_mfma_f32_16x16x32_bf16 v[112:115], v[92:95], v[40:43], v[112:115]
  ds_read_b128 v[72:75], v14 offset:0
  v_mfma_f32_16x16x32_bf16 v[116:119], v[76:79], v[44:47], v[116:119]
  v_mfma_f32_16x16x32_bf16 v[120:123], v[80:83], v[44:47], v[120:123]
  buffer_load_dwordx4 v[32:35], v2, s[48:51], s80 offen offset:3072 sc1
  buffer_load_dwordx4 v[36:39], v2, s[48:51], s81 offen offset:3072 sc1
  v_mfma_f32_16x16x32_bf16 v[124:127], v[84:87], v[44:47], v[124:127]
  v_mfma_f32_16x16x32_bf16 v[128:131], v[88:91], v[44:47], v[128:131]
  v_mfma_f32_16x16x32_bf16 v[132:135], v[92:95], v[44:47], v[132:135]
  s_waitcnt vmcnt(6) lgkmcnt(0)
  v_mfma_f32_16x16x32_bf16 v[96:99], v[56:59], v[48:51], v[96:99]
  ds_read_b128 v[76:79], v14 offset:36864
  v_mfma_f32_16x16x32_bf16 v[100:103], v[60:63], v[48:51], v[100:103]
  ds_read_b128 v[80:83], v14 offset:37888
  v_mfma_f32_16x16x32_bf16 v[104:107], v[64:67], v[48:51], v[104:107]
  ds_read_b128 v[84:87], v14 offset:38912
  v_mfma_f32_16x16x32_bf16 v[108:111], v[68:71], v[48:51], v[108:111]
  ds_read_b128 v[88:91], v14 offset:39936
  v_mfma_f32_16x16x32_bf16 v[112:115], v[72:75], v[48:51], v[112:115]
  ds_read_b128 v[92:95], v14 offset:40960
  v_mfma_f32_16x16x32_bf16 v[116:119], v[56:59], v[52:55], v[116:119]
  v_mfma_f32_16x16x32_bf16 v[120:123], v[60:63], v[52:55], v[120:123]
  s_add_u32 s80, s80, 4096
  buffer_load_dwordx4 v[40:43], v2, s[48:51], s80 offen offset:0 sc1
  s_add_u32 s81, s81, 4096
  buffer_load_dwordx4 v[44:47], v2, s[48:51], s81 offen offset:0 sc1
  v_mfma_f32_16x16x32_bf16 v[124:127], v[64:67], v[52:55], v[124:127]
  v_mfma_f32_16x16x32_bf16 v[128:131], v[68:71], v[52:55], v[128:131]
  v_mfma_f32_16x16x32_bf16 v[132:135], v[72:75], v[52:55], v[132:135]
  s_waitcnt vmcnt(6) lgkmcnt(0)
  v_mfma_f32_16x16x32_bf16 v[96:99], v[76:79], v[16:19], v[96:99]
  ds_read_b128 v[56:59], v14 offset:57344
  v_mfma_f32_16x16x32_bf16 v[100:103], v[80:83], v[16:19], v[100:103]
  ds_read_b128 v[60:63], v14 offset:58368
  v_mfma_f32_16x16x32_bf16 v[104:107], v[84:87], v[16:19], v[104:107]
  ds_read_b128 v[64:67], v14 offset:59392
  v_mfma_f32_16x16x32_bf16 v[108:111], v[88:91], v[16:19], v[108:111]
  ds_read_b128 v[68:71], v14 offset:60416
  v_mfma_f32_16x16x32_bf16 v[112:115], v[92:95], v[16:19], v[112:115]
  ds_read_b128 v[72:75], v14 offset:61440
  v_mfma_f32_16x16x32_bf16 v[116:119], v[76:79], v[20:23], v[116:119]
  v_mfma_f32_16x16x32_bf16 v[120:123], v[80:83], v[20:23], v[120:123]
  buffer_load_dwordx4 v[48:51], v2, s[48:51], s80 offen offset:1024 sc1
  buffer_load_dwordx4 v[52:55], v2, s[48:51], s81 offen offset:1024 sc1
  v_mfma_f32_16x16x32_bf16 v[124:127], v[84:87], v[20:23], v[124:127]
  v_mfma_f32_16x16x32_bf16 v[128:131], v[88:91], v[20:23], v[128:131]
  v_mfma_f32_16x16x32_bf16 v[132:135], v[92:95], v[20:23], v[132:135]
  s_waitcnt vmcnt(6) lgkmcnt(0)
  v_mfma_f32_16x16x32_bf16 v[96:99], v[56:59], v[24:27], v[96:99]
  ds_read_b128 v[76:79], v12 offset:12288
  v_mfma_f32_16x16x32_bf16 v[100:103], v[60:63], v[24:27], v[100:103]
  ds_read_b128 v[80:83], v12 offset:13312
  v_mfma_f32_16x16x32_bf16 v[104:107], v[64:67], v[24:27], v[104:107]
  ds_read_b128 v[84:87], v12 offset:14336
  v_mfma_f32_16x16x32_bf16 v[108:111], v[68:71], v[24:27], v[108:111]
  ds_read_b128 v[88:91], v12 offset:15360
  v_mfma_f32_16x16x32_bf16 v[112:115], v[72:75], v[24:27], v[112:115]
  ds_read_b128 v[92:95], v12 offset:16384
  v_mfma_f32_16x16x32_bf16 v[116:119], v[56:59], v[28:31], v[116:119]
  v_mfma_f32_16x16x32_bf16 v[120:123], v[60:63], v[28:31], v[120:123]
  buffer_load_dwordx4 v[16:19], v2, s[48:51], s80 offen offset:2048 sc1
  buffer_load_dwordx4 v[20:23], v2, s[48:51], s81 offen offset:2048 sc1
  v_mfma_f32_16x16x32_bf16 v[124:127], v[64:67], v[28:31], v[124:127]
  v_mfma_f32_16x16x32_bf16 v[128:131], v[68:71], v[28:31], v[128:131]
  v_mfma_f32_16x16x32_bf16 v[132:135], v[72:75], v[28:31], v[132:135]
  s_waitcnt vmcnt(6) lgkmcnt(0)
  s_barrier
  v_mfma_f32_16x16x32_bf16 v[96:99], v[76:79], v[32:35], v[96:99]
  ds_read_b128 v[56:59], v14 offset:16384
  v_mfma_f32_16x16x32_bf16 v[100:103], v[80:83], v[32:35], v[100:103]
  ds_read_b128 v[60:63], v14 offset:17408
  v_mfma_f32_16x16x32_bf16 v[104:107], v[84:87], v[32:35], v[104:107]
  ds_read_b128 v[64:67], v14 offset:18432
  v_mfma_f32_16x16x32_bf16 v[108:111], v[88:91], v[32:35], v[108:111]
  ds_read_b128 v[68:71], v14 offset:19456
  v_mfma_f32_16x16x32_bf16 v[112:115], v[92:95], v[32:35], v[112:115]
  ds_read_b128 v[72:75], v14 offset:20480
  v_mfma_f32_16x16x32_bf16 v[116:119], v[76:79], v[36:39], v[116:119]
  v_mfma_f32_16x16x32_bf16 v[120:123], v[80:83], v[36:39], v[120:123]
  buffer_load_dwordx4 v[24:27], v2, s[48:51], s80 offen offset:3072 sc1
  buffer_load_dwordx4 v[28:31], v2, s[48:51], s81 offen offset:3072 sc1
  v_mfma_f32_16x16x32_bf16 v[124:127], v[84:87], v[36:39], v[124:127]
  v_mfma_f32_16x16x32_bf16 v[128:131], v[88:91], v[36:39], v[128:131]
  v_mfma_f32_16x16x32_bf16 v[132:135], v[92:95], v[36:39], v[132:135]
  s_waitcnt vmcnt(6) lgkmcnt(0)
  v_mfma_f32_16x16x32_bf16 v[96:99], v[56:59], v[40:43], v[96:99]
  ds_read_b128 v[76:79], v13 offset:0
  v_mfma_f32_16x16x32_bf16 v[100:103], v[60:63], v[40:43], v[100:103]
  ds_read_b128 v[80:83], v13 offset:1024
  v_mfma_f32_16x16x32_bf16 v[104:107], v[64:67], v[40:43], v[104:107]
  ds_read_b128 v[84:87], v13 offset:2048
  v_mfma_f32_16x16x32_bf16 v[108:111], v[68:71], v[40:43], v[108:111]
  ds_read_b128 v[88:91], v13 offset:3072
  v_mfma_f32_16x16x32_bf16 v[112:115], v[72:75], v[40:43], v[112:115]
  ds_read_b128 v[92:95], v13 offset:4096
  v_mfma_f32_16x16x32_bf16 v[116:119], v[56:59], v[44:47], v[116:119]
  v_mfma_f32_16x16x32_bf16 v[120:123], v[60:63], v[44:47], v[120:123]
  v_mfma_f32_16x16x32_bf16 v[124:127], v[64:67], v[44:47], v[124:127]
  v_mfma_f32_16x16x32_bf16 v[128:131], v[68:71], v[44:47], v[128:131]
  v_mfma_f32_16x16x32_bf16 v[132:135], v[72:75], v[44:47], v[132:135]
  s_waitcnt vmcnt(4) lgkmcnt(0)
  v_mfma_f32_16x16x32_bf16 v[96:99], v[76:79], v[48:51], v[96:99]
  ds_read_b128 v[56:59], v13 offset:20480
  v_mfma_f32_16x16x32_bf16 v[100:103], v[80:83], v[48:51], v[100:103]
  ds_read_b128 v[60:63], v13 offset:21504
  v_mfma_f32_16x16x32_bf16 v[104:107], v[84:87], v[48:51], v[104:107]
  ds_read_b128 v[64:67], v13 offset:22528
  v_mfma_f32_16x16x32_bf16 v[108:111], v[88:91], v[48:51], v[108:111]
  ds_read_b128 v[68:71], v13 offset:23552
  v_mfma_f32_16x16x32_bf16 v[112:115], v[92:95], v[48:51], v[112:115]
  ds_read_b128 v[72:75], v13 offset:24576
  v_mfma_f32_16x16x32_bf16 v[116:119], v[76:79], v[52:55], v[116:119]
  v_mfma_f32_16x16x32_bf16 v[120:123], v[80:83], v[52:55], v[120:123]
  v_mfma_f32_16x16x32_bf16 v[124:127], v[84:87], v[52:55], v[124:127]
  v_mfma_f32_16x16x32_bf16 v[128:131], v[88:91], v[52:55], v[128:131]
  v_mfma_f32_16x16x32_bf16 v[132:135], v[92:95], v[52:55], v[132:135]
  s_waitcnt vmcnt(2) lgkmcnt(0)
  v_mfma_f32_16x16x32_bf16 v[96:99], v[56:59], v[16:19], v[96:99]
  ds_read_b128 v[76:79], v13 offset:40960
  v_mfma_f32_16x16x32_bf16 v[100:103], v[60:63], v[16:19], v[100:103]
  ds_read_b128 v[80:83], v13 offset:41984
  v_mfma_f32_16x16x32_bf16 v[104:107], v[64:67], v[16:19], v[104:107]
  ds_read_b128 v[84:87], v13 offset:43008
  v_mfma_f32_16x16x32_bf16 v[108:111], v[68:71], v[16:19], v[108:111]
  ds_read_b128 v[88:91], v13 offset:44032
  v_mfma_f32_16x16x32_bf16 v[112:115], v[72:75], v[16:19], v[112:115]
  ds_read_b128 v[92:95], v13 offset:45056
  v_mfma_f32_16x16x32_bf16 v[116:119], v[56:59], v[20:23], v[116:119]
  v_mfma_f32_16x16x32_bf16 v[120:123], v[60:63], v[20:23], v[120:123]
  v_mfma_f32_16x16x32_bf16 v[124:127], v[64:67], v[20:23], v[124:127]
  v_mfma_f32_16x16x32_bf16 v[128:131], v[68:71], v[20:23], v[128:131]
  v_mfma_f32_16x16x32_bf16 v[132:135], v[72:75], v[20:23], v[132:135]
  s_waitcnt vmcnt(0) lgkmcnt(0)
  v_mfma_f32_16x16x32_bf16 v[96:99], v[76:79], v[24:27], v[96:99]
  v_mfma_f32_16x16x32_bf16 v[100:103], v[80:83], v[24:27], v[100:103]
  v_mfma_f32_16x16x32_bf16 v[104:107], v[84:87], v[24:27], v[104:107]
  v_mfma_f32_16x16x32_bf16 v[108:111], v[88:91], v[24:27], v[108:111]
  v_mfma_f32_16x16x32_bf16 v[112:115], v[92:95], v[24:27], v[112:115]
  v_mfma_f32_16x16x32_bf16 v[116:119], v[76:79], v[28:31], v[116:119]
  v_mfma_f32_16x16x32_bf16 v[120:123], v[80:83], v[28:31], v[120:123]
  v_mfma_f32_16x16x32_bf16 v[124:127], v[84:87], v[28:31], v[124:127]
  v_mfma_f32_16x16x32_bf16 v[128:131], v[88:91], v[28:31], v[128:131]
  v_mfma_f32_16x16x32_bf16 v[132:135], v[92:95], v[28:31], v[132:135]
  s_barrier
  s_mul_i32 s12, s73, 30720
  s_lshr_b32 s13, s72, 1
  s_add_u32 s13, s13, s72
  s_mul_i32 s13, s13, 5120
  s_add_u32 s13, s13, s12
  v_add_u32 v10, s13, v2
  ds_write_b128 v10, v[116:119] offset:0
  ds_write_b128 v10, v[120:123] offset:1024
  ds_write_b128 v10, v[124:127] offset:2048
  ds_write_b128 v10, v[128:131] offset:3072
  ds_write_b128 v10, v[132:135] offset:4096
  s_cmp_lt_u32 s72, 2
  s_cbranch_scc1 L_kr_124
  s_and_b32 s13, s72, 1
  s_mul_i32 s13, s13, 15360
  s_add_u32 s13, s13, 10240
  s_add_u32 s13, s13, s12
  v_add_u32 v10, s13, v2
  ds_write_b128 v10, v[96:99] offset:0
  ds_write_b128 v10, v[100:103] offset:1024
  ds_write_b128 v10, v[104:107] offset:2048
  ds_write_b128 v10, v[108:111] offset:3072
  ds_write_b128 v10, v[112:115] offset:4096
L_kr_124:
  s_waitcnt lgkmcnt(0)
  s_barrier
  s_cmp_ge_u32 s72, 2
  s_cbranch_scc1 L_krend_125
  s_mul_i32 s13, s72, 5120
  s_add_u32 s14, s12, s13
  s_sub_u32 s15, s12, s13
  s_add_u32 s15, s15, 5120
  v_add_u32 v10, s15, v2
  v_add_u32 v11, s14, v2
  ds_read_b128 v[16:19], v10 offset:0
  ds_read_b128 v[20:23], v10 offset:1024
  ds_read_b128 v[24:27], v10 offset:2048
  ds_read_b128 v[28:31], v10 offset:3072
  ds_read_b128 v[32:35], v10 offset:4096
  ds_read_b128 v[36:39], v11 offset:10240
  ds_read_b128 v[40:43], v11 offset:11264
  ds_read_b128 v[44:47], v11 offset:12288
  ds_read_b128 v[48:51], v11 offset:13312
  ds_read_b128 v[52:55], v11 offset:14336
  ds_read_b128 v[56:59], v11 offset:20480
  ds_read_b128 v[60:63], v11 offset:21504
  ds_read_b128 v[64:67], v11 offset:22528
  ds_read_b128 v[68:71], v11 offset:23552
  ds_read_b128 v[72:75], v11 offset:24576
  v_mul_u32_u24 v12, 1280, v4
  v_lshl_add_u32 v12, v3, 3, v12
  s_mul_i32 s12, s77, 20480
  s_mul_i32 s13, s71, 160
  s_add_u32 s79, s12, s13
  s_waitcnt lgkmcnt(10)
  v_pk_add_f32 v[96:97], v[96:97], v[16:17]
  v_pk_add_f32 v[98:99], v[98:99], v[18:19]
  v_pk_add_f32 v[100:101], v[100:101], v[20:21]
  v_pk_add_f32 v[102:103], v[102:103], v[22:23]
  v_pk_add_f32 v[104:105], v[104:105], v[24:25]
  v_pk_add_f32 v[106:107], v[106:107], v[26:27]
  v_pk_add_f32 v[108:109], v[108:109], v[28:29]
  v_pk_add_f32 v[110:111], v[110:111], v[30:31]
  v_pk_add_f32 v[112:113], v[112:113], v[32:33]
  v_pk_add_f32 v[114:115], v[114:115], v[34:35]
  s_waitcnt lgkmcnt(5)
  v_pk_add_f32 v[96:97], v[96:97], v[36:37]
  v_pk_add_f32 v[98:99], v[98:99], v[38:39]
  v_pk_add_f32 v[100:101], v[100:101], v[40:41]
  v_pk_add_f32 v[102:103], v[102:103], v[42:43]
  v_pk_add_f32 v[104:105], v[104:105], v[44:45]
  v_pk_add_f32 v[106:107], v[106:107], v[46:47]
  v_pk_add_f32 v[108:109], v[108:109], v[48:49]
  v_pk_add_f32 v[110:111], v[110:111], v[50:51]
  v_pk_add_f32 v[112:113], v[112:113], v[52:53]
  v_pk_add_f32 v[114:115], v[114:115], v[54:55]
  s_waitcnt lgkmcnt(0)
  v_pk_add_f32 v[96:97], v[96:97], v[56:57]
  v_pk_add_f32 v[98:99], v[98:99], v[58:59]
  v_pk_add_f32 v[100:101], v[100:101], v[60:61]
  v_pk_add_f32 v[102:103], v[102:103], v[62:63]
  v_pk_add_f32 v[104:105], v[104:105], v[64:65]
  v_pk_add_f32 v[106:107], v[106:107], v[66:67]
  v_pk_add_f32 v[108:109], v[108:109], v[68:69]
  v_pk_add_f32 v[110:111], v[110:111], v[70:71]
  v_pk_add_f32 v[112:113], v[112:113], v[72:73]
  v_pk_add_f32 v[114:115], v[114:115], v[74:75]
  v_lshlrev_b32 v80, 16, v140
  v_and_b32 v81, 0xffff0000, v140
  v_pk_add_f32 v[96:97], v[96:97], v[80:81]
  v_lshlrev_b32 v80, 16, v150
  v_and_b32 v81, 0xffff0000, v150
  v_pk_add_f32 v[96:97], v[96:97], v[80:81]
  v_lshlrev_b32 v80, 16, v141
  v_and_b32 v81, 0xffff0000, v141
  v_pk_add_f32 v[98:99], v[98:99], v[80:81]
  v_lshlrev_b32 v80, 16, v151
  v_and_b32 v81, 0xffff0000, v151
  v_pk_add_f32 v[98:99], v[98:99], v[80:81]
  v_cvt_pk_bf16_f32 v96, v96, v97
  v_cvt_pk_bf16_f32 v97, v98, v99
  buffer_store_dwordx2 v[96:97], v12, s[52:55], s79 offen offset:0
  v_lshlrev_b32 v80, 16, v142
  v_and_b32 v81, 0xffff0000, v142
  v_pk_add_f32 v[100:101], v[100:101], v[80:81]
  v_lshlrev_b32 v80, 16, v152
  v_and_b32 v81, 0xffff0000, v152
  v_pk_add_f32 v[100:101], v[100:101], v[80:81]
  v_lshlrev_b32 v80, 16, v143
  v_and_b32 v81, 0xffff0000, v143
  v_pk_add_f32 v[102:103], v[102:103], v[80:81]
  v_lshlrev_b32 v80, 16, v153
  v_and_b32 v81, 0xffff0000, v153
  v_pk_add_f32 v[102:103], v[102:103], v[80:81]
  v_cvt_pk_bf16_f32 v100, v100, v101
  v_cvt_pk_bf16_f32 v101, v102, v103
  buffer_store_dwordx2 v[100:101], v12, s[52:55], s79 offen offset:32
  v_lshlrev_b32 v80, 16, v144
  v_and_b32 v81, 0xffff0000, v144
  v_pk_add_f32 v[104:105], v[104:105], v[80:81]
  v_lshlrev_b32 v80, 16, v154
  v_and_b32 v81, 0xffff0000, v154
  v_pk_add_f32 v[104:105], v[104:105], v[80:81]
  v_lshlrev_b32 v80, 16, v145
  v_and_b32 v81, 0xffff0000, v145
  v_pk_add_f32 v[106:107], v[106:107], v[80:81]
  v_lshlrev_b32 v80, 16, v155
  v_and_b32 v81, 0xffff0000, v155
  v_pk_add_f32 v[106:107], v[106:107], v[80:81]
  v_cvt_pk_bf16_f32 v104, v104, v105
  v_cvt_pk_bf16_f32 v105, v106, v107
  buffer_store_dwordx2 v[104:105], v12, s[52:55], s79 offen offset:64
  v_lshlrev_b32 v80, 16, v146
  v_and_b32 v81, 0xffff0000, v146
  v_pk_add_f32 v[108:109], v[108:109], v[80:81]
  v_lshlrev_b32 v80, 16, v156
  v_and_b32 v81, 0xffff0000, v156
  v_pk_add_f32 v[108:109], v[108:109], v[80:81]
  v_lshlrev_b32 v80, 16, v147
  v_and_b32 v81, 0xffff0000, v147
  v_pk_add_f32 v[110:111], v[110:111], v[80:81]
  v_lshlrev_b32 v80, 16, v157
  v_and_b32 v81, 0xffff0000, v157
  v_pk_add_f32 v[110:111], v[110:111], v[80:81]
  v_cvt_pk_bf16_f32 v108, v108, v109
  v_cvt_pk_bf16_f32 v109, v110, v111
  buffer_store_dwordx2 v[108:109], v12, s[52:55], s79 offen offset:96
  v_lshlrev_b32 v80, 16, v148
  v_and_b32 v81, 0xffff0000, v148
  v_pk_add_f32 v[112:113], v[112:113], v[80:81]
  v_lshlrev_b32 v80, 16, v158
  v_and_b32 v81, 0xffff0000, v158
  v_pk_add_f32 v[112:113], v[112:113], v[80:81]
  v_lshlrev_b32 v80, 16, v149
  v_and_b32 v81, 0xffff0000, v149
  v_pk_add_f32 v[114:115], v[114:115], v[80:81]
  v_lshlrev_b32 v80, 16, v159
  v_and_b32 v81, 0xffff0000, v159
  v_pk_add_f32 v[114:115], v[114:115], v[80:81]
  v_cvt_pk_bf16_f32 v112, v112, v113
  v_cvt_pk_bf16_f32 v113, v114, v115
  buffer_store_dwordx2 v[112:113], v12, s[52:55], s79 offen offset:128
L_krend_125:
  s_branch L_fin
L_helper:
  s_nop 1
  s_cmp_eq_u32 s8, 8
  s_cbranch_scc0 L_loader
  s_setprio 3
  s_xor_b32 s12, s8, 8
  s_or_b32 s12, s2, s12
  s_cmp_lg_u32 s12, 0
  s_cbranch_scc1 L_ep_126
  s_memrealtime s[12:13]
  s_waitcnt lgkmcnt(0)
  s_and_b32 s12, s12, 0xfffffff0
  s_or_b32 s12, s12, 8
  v_mov_b32 v10, s12
  v_mov_b32 v11, 0
  buffer_store_dword v10, v11, s[56:59], 0 offen sc1
L_ep_126:
  s_cmp_eq_u32 s7, 15
  s_cbranch_scc1 L_s_spare
  s_barrier
  s_cmp_lg_u32 s8, 8
  s_cbranch_scc1 L_ei_127
  v_mov_b32 v163, 0
  buffer_load_dword v160, v163, s[56:59], 0 offen sc1
L_ei_127:
  s_barrier
  s_barrier
  s_waitcnt vmcnt(0)
  s_cmp_lg_u32 s8, 8
  s_cbranch_scc1 L_et_128
  s_cmp_lg_u32 s9, 0
  s_cbranch_scc1 L_et_128
  v_readfirstlane_b32 s9, v160
  s_mov_b32 s99, 0
L_et_129:
  s_nop 0
  s_cmp_lg_u32 s9, 0
  s_cbranch_scc1 L_et_130
  s_add_u32 s99, s99, 1
  s_cmp_gt_u32 s99, 0x40000
  s_cbranch_scc1 L_end
  v_mov_b32 v163, 0
  buffer_load_dword v160, v163, s[56:59], 0 offen sc1
  s_waitcnt vmcnt(0)
  v_readfirstlane_b32 s9, v160
  s_branch L_et_129
L_et_130:
  s_lshl_b32 s12, s4, 7
  s_lshl_b32 s13, s5, 2
  s_add_u32 s12, s12, s13
  s_cmp_lg_u32 s8, 8
  s_cbranch_scc1 L_sig_131
  s_or_b32 s15, s9, s11
  v_mov_b32 v164, s15
  v_mov_b32 v163, 0
  s_mov_b64 exec, 1
  buffer_store_dword v164, v163, s[48:51], s12 offen sc1
  s_mov_b64 exec, -1
L_sig_131:
L_et_128:
  s_barrier
  s_barrier
  s_barrier
  s_barrier
  s_mul_i32 s96, s4, 30
  s_add_u32 s96, s96, s5
  s_sub_u32 s96, s96, s6
  s_add_u32 s96, s96, 50
  s_mov_b32 s64, s24
  s_mov_b32 s65, s25
  s_mov_b32 s66, 1966080
  s_mov_b32 s67, 0x20000
  s_mov_b32 s88, s28
  s_mov_b32 s89, s29
  s_mov_b32 s90, 1966080
  s_mov_b32 s91, 0x20000
  v_lshrrev_b32 v16, 3, v1
  v_and_b32 v17, 7, v1
  v_lshrrev_b32 v18, 1, v16
  v_and_b32 v18, 3, v18
  v_lshlrev_b32 v18, 1, v18
  v_xor_b32 v17, v17, v18
  v_lshlrev_b32 v17, 4, v17
  s_cmp_lt_u32 s96, 170
  s_cbranch_scc0 L_r1_132
  s_mov_b32 s70, 1
  s_sub_u32 s75, s96, 50
  s_mul_hi_u32 s74, s75, 178956971
  s_mul_i32 s71, s74, 24
  s_sub_u32 s71, s75, s71
  v_mul_u32_u24 v18, 3072, v16
  v_add_u32 v18, v18, v17
  s_mul_i32 s12, s74, 393216
  s_lshl_b32 s13, s71, 7
  s_add_u32 s12, s12, s13
  s_mov_b32 m0, 16384
  s_nop 0
  buffer_load_dwordx4 v18, s[64:67], s12 offen lds
  s_add_u32 s12, s12, 24576
  s_mov_b32 m0, 17408
  s_nop 0
  buffer_load_dwordx4 v18, s[64:67], s12 offen lds
  s_add_u32 s12, s12, 24576
  s_mov_b32 m0, 18432
  s_nop 0
  buffer_load_dwordx4 v18, s[64:67], s12 offen lds
  s_add_u32 s12, s12, 24576
  s_mov_b32 m0, 19456
  s_nop 0
  buffer_load_dwordx4 v18, s[64:67], s12 offen lds
  s_add_u32 s12, s12, 24576
  s_mov_b32 m0, 20480
  s_nop 0
  buffer_load_dwordx4 v18, s[64:67], s12 offen lds
  s_add_u32 s12, s12, 24576
  s_mov_b32 m0, 21504
  s_nop 0
  buffer_load_dwordx4 v18, s[64:67], s12 offen lds
  s_add_u32 s12, s12, 24576
  s_mov_b32 m0, 22528
  s_nop 0
  buffer_load_dwordx4 v18, s[64:67], s12 offen lds
  s_add_u32 s12, s12, 24576
  s_mov_b32 m0, 23552
  s_nop 0
  buffer_load_dwordx4 v18, s[64:67], s12 offen lds
  s_add_u32 s12, s12, 24576
  s_mov_b32 m0, 24576
  s_nop 0
  buffer_load_dwordx4 v18, s[64:67], s12 offen lds
  s_add_u32 s12, s12, 24576
  s_mov_b32 m0, 25600
  s_nop 0
  buffer_load_dwordx4 v18, s[64:67], s12 offen lds
  s_add_u32 s12, s12, 24576
  s_mov_b32 m0, 26624
  s_nop 0
  buffer_load_dwordx4 v18, s[64:67], s12 offen lds
  s_add_u32 s12, s12, 24576
  s_mov_b32 m0, 27648
  s_nop 0
  buffer_load_dwordx4 v18, s[64:67], s12 offen lds
  s_add_u32 s12, s12, 24576
  s_mov_b32 m0, 28672
  s_nop 0
  buffer_load_dwordx4 v18, s[64:67], s12 offen lds
  s_add_u32 s12, s12, 24576
  s_mov_b32 m0, 29696
  s_nop 0
  buffer_load_dwordx4 v18, s[64:67], s12 offen lds
  s_add_u32 s12, s12, 24576
  s_mov_b32 m0, 30720
  s_nop 0
  buffer_load_dwordx4 v18, s[64:67], s12 offen lds
  s_add_u32 s12, s12, 24576
  s_mov_b32 m0, 31744
  s_nop 0
  buffer_load_dwordx4 v18, s[64:67], s12 offen lds
  s_add_u32 s12, s12, 24576
  s_branch L_r1_133
L_r1_132:
  s_mov_b32 s70, 2
  s_sub_u32 s75, s96, 170
  s_mul_hi_u32 s74, s75, 429496730
  s_mul_i32 s71, s74, 10
  s_sub_u32 s71, s75, s71
  v_mul_u32_u24 v18, 1280, v16
  v_add_u32 v18, v18, v17
  s_mul_i32 s12, s74, 163840
  s_lshl_b32 s13, s71, 7
  s_add_u32 s12, s12, s13
  s_mov_b32 m0, 16384
  s_nop 0
  buffer_load_dwordx4 v18, s[88:91], s12 offen lds
  s_add_u32 s12, s12, 10240
  s_mov_b32 m0, 17408
  s_nop 0
  buffer_load_dwordx4 v18, s[88:91], s12 offen lds
  s_add_u32 s12, s12, 10240
  s_mov_b32 m0, 18432
  s_nop 0
  buffer_load_dwordx4 v18, s[88:91], s12 offen lds
  s_add_u32 s12, s12, 10240
  s_mov_b32 m0, 19456
  s_nop 0
  buffer_load_dwordx4 v18, s[88:91], s12 offen lds
  s_add_u32 s12, s12, 10240
  s_mov_b32 m0, 20480
  s_nop 0
  buffer_load_dwordx4 v18, s[88:91], s12 offen lds
  s_add_u32 s12, s12, 10240
  s_mov_b32 m0, 21504
  s_nop 0
  buffer_load_dwordx4 v18, s[88:91], s12 offen lds
  s_add_u32 s12, s12, 10240
  s_mov_b32 m0, 22528
  s_nop 0
  buffer_load_dwordx4 v18, s[88:91], s12 offen lds
  s_add_u32 s12, s12, 10240
  s_mov_b32 m0, 23552
  s_nop 0
  buffer_load_dwordx4 v18, s[88:91], s12 offen lds
  s_add_u32 s12, s12, 10240
  s_mov_b32 m0, 24576
  s_nop 0
  buffer_load_dwordx4 v18, s[88:91], s12 offen lds
  s_add_u32 s12, s12, 10240
  s_mov_b32 m0, 25600
  s_nop 0
  buffer_load_dwordx4 v18, s[88:91], s12 offen lds
  s_add_u32 s12, s12, 10240
  s_mov_b32 m0, 26624
  s_nop 0
  buffer_load_dwordx4 v18, s[88:91], s12 offen lds
  s_add_u32 s12, s12, 10240
  s_mov_b32 m0, 27648
  s_nop 0
  buffer_load_dwordx4 v18, s[88:91], s12 offen lds
  s_add_u32 s12, s12, 10240
  s_mov_b32 m0, 28672
  s_nop 0
  buffer_load_dwordx4 v18, s[88:91], s12 offen lds
  s_add_u32 s12, s12, 10240
  s_mov_b32 m0, 29696
  s_nop 0
  buffer_load_dwordx4 v18, s[88:91], s12 offen lds
  s_add_u32 s12, s12, 10240
  s_mov_b32 m0, 30720
  s_nop 0
  buffer_load_dwordx4 v18, s[88:91], s12 offen lds
  s_add_u32 s12, s12, 10240
  s_mov_b32 m0, 31744
  s_nop 0
  buffer_load_dwordx4 v18, s[88:91], s12 offen lds
  s_add_u32 s12, s12, 10240
L_r1_133:
  v_lshrrev_b32 v24, 2, v4
  v_and_b32 v25, 3, v4
  v_lshl_add_u32 v26, v3, 2, v24
  v_lshrrev_b32 v27, 1, v26
  v_and_b32 v27, 3, v27
  v_lshlrev_b32 v27, 1, v27
  v_lshrrev_b32 v28, 1, v25
  v_and_b32 v25, 1, v25
  v_lshlrev_b32 v26, 7, v26
  v_lshl_add_u32 v26, v25, 3, v26
  v_add_u32 v26, 16384, v26
  v_or_b32 v29, 0, v28
  v_xor_b32 v29, v29, v27
  v_lshl_add_u32 v20, v29, 4, v26
  v_or_b32 v29, 2, v28
  v_xor_b32 v29, v29, v27
  v_lshl_add_u32 v21, v29, 4, v26
  v_or_b32 v29, 4, v28
  v_xor_b32 v29, v29, v27
  v_lshl_add_u32 v22, v29, 4, v26
  v_or_b32 v29, 6, v28
  v_xor_b32 v29, v29, v27
  v_lshl_add_u32 v23, v29, 4, v26
  v_mov_b32 v32, 0x3f803f80
  v_mov_b32 v33, 0x3f803f80
  v_mov_b32 v34, 0x3f803f80
  v_mov_b32 v35, 0x3f803f80
  v_lshlrev_b32 v30, 4, v3
  v_mov_b32 v31, 0x20000000
  v_cmp_eq_u32 vcc, 0, v4
  s_nop 1
  v_cndmask_b32 v30, v31, v30, vcc
  s_barrier
  s_barrier
  s_barrier
  s_barrier
  s_lshl_b32 s68, s4, 7
  v_min_u32 v161, 15, v1
  v_lshlrev_b32 v161, 2, v161
  s_mov_b32 s14, 24576
  buffer_load_dword v162, v161, s[48:51], s14 offen sc1
  v_min_u32 v163, 31, v1
  v_lshlrev_b32 v163, 2, v163
  s_mov_b32 s99, 0
L_wf_134:
  s_add_u32 s99, s99, 1
  s_cmp_gt_u32 s99, 0x40000
  s_cbranch_scc1 L_end
  buffer_load_dword v164, v163, s[48:51], s68 offen sc1
  s_waitcnt vmcnt(0)
  v_and_b32 v165, -8, v164
  v_cmp_ne_u32 vcc, s9, v165
  s_nop 4
  s_cbranch_vccnz L_wf_134
  v_and_b32 v164, 7, v164
  v_cmp_ne_u32 vcc, s11, v164
  s_nop 1
  s_cmp_eq_u64 vcc, 0
  s_cselect_b32 s10, 1, 0
  v_and_b32 v165, -8, v162
  v_cmp_ne_u32 vcc, s9, v165
  s_nop 1
  s_cmp_eq_u64 vcc, 0
  s_cselect_b32 s13, 2, 0
  s_or_b32 s12, s10, s13
  v_mov_b32 v164, s12
  v_mov_b32 v163, 2560
  ds_write_b32 v163, v164
  s_waitcnt lgkmcnt(0)
  s_barrier
  ds_read_b64_tr_b16 v[40:41], v20 offset:0
  ds_read_b64_tr_b16 v[42:43], v20 offset:2048
  ds_read_b64_tr_b16 v[44:45], v20 offset:4096
  ds_read_b64_tr_b16 v[46:47], v20 offset:6144
  ds_read_b64_tr_b16 v[48:49], v20 offset:8192
  ds_read_b64_tr_b16 v[50:51], v20 offset:10240
  ds_read_b64_tr_b16 v[52:53], v20 offset:12288
  ds_read_b64_tr_b16 v[54:55], v20 offset:14336
  s_lshl_b32 s12, s71, 2
  s_add_u32 s12, s12, 0
  s_cmp_eq_u32 s70, 1
  s_cbranch_scc0 L_d_135
  s_mul_hi_u32 s3, s12, 715827883
  s_mul_i32 s83, s3, 6
  s_sub_u32 s83, s12, s83
  s_mul_i32 s3, s3, 120
  s_add_u32 s3, s3, s83
  s_lshl_b32 s13, s74, 2
  s_mul_hi_u32 s92, s13, 429496730
  s_mul_i32 s93, s92, 10
  s_sub_u32 s93, s13, s93
  s_mul_i32 s93, s93, 12
  s_mul_i32 s92, s92, 6
  s_add_u32 s92, s92, s93
  s_add_u32 s92, s92, s3
  s_lshl_b32 s92, s92, 10
  s_add_u32 s76, s92, 26214400
  s_lshl_b32 s13, s74, 2
  s_add_u32 s13, s13, 1
  s_mul_hi_u32 s92, s13, 429496730
  s_mul_i32 s93, s92, 10
  s_sub_u32 s93, s13, s93
  s_mul_i32 s93, s93, 12
  s_mul_i32 s92, s92, 6
  s_add_u32 s92, s92, s93
  s_add_u32 s92, s92, s3
  s_lshl_b32 s92, s92, 10
  s_add_u32 s77, s92, 26214400
  s_lshl_b32 s13, s74, 2
  s_add_u32 s13, s13, 2
  s_mul_hi_u32 s92, s13, 429496730
  s_mul_i32 s93, s92, 10
  s_sub_u32 s93, s13, s93
  s_mul_i32 s93, s93, 12
  s_mul_i32 s92, s92, 6
  s_add_u32 s92, s92, s93
  s_add_u32 s92, s92, s3
  s_lshl_b32 s92, s92, 10
  s_add_u32 s78, s92, 26214400
  s_lshl_b32 s13, s74, 2
  s_add_u32 s13, s13, 3
  s_mul_hi_u32 s92, s13, 429496730
  s_mul_i32 s93, s92, 10
  s_sub_u32 s93, s13, s93
  s_mul_i32 s93, s93, 12
  s_mul_i32 s92, s92, 6
  s_add_u32 s92, s92, s93
  s_add_u32 s92, s92, s3
  s_lshl_b32 s92, s92, 10
  s_add_u32 s79, s92, 26214400
  s_branch L_d_136
L_d_135:
  s_mul_hi_u32 s3, s12, 858993460
  s_mul_i32 s83, s3, 5
  s_sub_u32 s83, s12, s83
  s_mul_i32 s3, s3, 240
  s_add_u32 s3, s3, s83
  s_lshl_b32 s13, s74, 2
  s_mul_hi_u32 s92, s13, 357913942
  s_mul_i32 s93, s92, 12
  s_sub_u32 s93, s13, s93
  s_mul_i32 s93, s93, 20
  s_mul_i32 s92, s92, 5
  s_add_u32 s92, s92, s93
  s_add_u32 s92, s92, s3
  s_lshl_b32 s92, s92, 10
  s_add_u32 s76, s92, 29360128
  s_lshl_b32 s13, s74, 2
  s_add_u32 s13, s13, 1
  s_mul_hi_u32 s92, s13, 357913942
  s_mul_i32 s93, s92, 12
  s_sub_u32 s93, s13, s93
  s_mul_i32 s93, s93, 20
  s_mul_i32 s92, s92, 5
  s_add_u32 s92, s92, s93
  s_add_u32 s92, s92, s3
  s_lshl_b32 s92, s92, 10
  s_add_u32 s77, s92, 29360128
  s_lshl_b32 s13, s74, 2
  s_add_u32 s13, s13, 2
  s_mul_hi_u32 s92, s13, 357913942
  s_mul_i32 s93, s92, 12
  s_sub_u32 s93, s13, s93
  s_mul_i32 s93, s93, 20
  s_mul_i32 s92, s92, 5
  s_add_u32 s92, s92, s93
  s_add_u32 s92, s92, s3
  s_lshl_b32 s92, s92, 10
  s_add_u32 s78, s92, 29360128
  s_lshl_b32 s13, s74, 2
  s_add_u32 s13, s13, 3
  s_mul_hi_u32 s92, s13, 357913942
  s_mul_i32 s93, s92, 12
  s_sub_u32 s93, s13, s93
  s_mul_i32 s93, s93, 20
  s_mul_i32 s92, s92, 5
  s_add_u32 s92, s92, s93
  s_add_u32 s92, s92, s3
  s_lshl_b32 s92, s92, 10
  s_add_u32 s79, s92, 29360128
L_d_136:
  s_waitcnt lgkmcnt(0)
  buffer_store_dwordx4 v[40:43], v2, s[48:51], s76 offen sc1
  buffer_store_dwordx4 v[44:47], v2, s[48:51], s77 offen sc1
  buffer_store_dwordx4 v[48:51], v2, s[48:51], s78 offen sc1
  buffer_store_dwordx4 v[52:55], v2, s[48:51], s79 offen sc1
  s_cmp_eq_u32 s70, 1
  s_cbranch_scc0 L_cs_137
  v_mfma_f32_16x16x32_bf16 v[36:39], v[40:43], v[32:35], 0
  v_mfma_f32_16x16x32_bf16 v[36:39], v[44:47], v[32:35], v[36:39]
  v_mfma_f32_16x16x32_bf16 v[36:39], v[48:51], v[32:35], v[36:39]
  v_mfma_f32_16x16x32_bf16 v[36:39], v[52:55], v[32:35], v[36:39]
  s_mul_i32 s13, s74, 1536
  s_lshl_b32 s14, s12, 4
  s_add_u32 s13, s13, s14
  s_lshl_b32 s13, s13, 2
  s_add_u32 s13, s13, 32505856
  s_nop 2
  buffer_store_dwordx4 v[36:39], v30, s[48:51], s13 offen sc1
L_cs_137:
  s_nop 2
  ds_read_b64_tr_b16 v[56:57], v21 offset:0
  ds_read_b64_tr_b16 v[58:59], v21 offset:2048
  ds_read_b64_tr_b16 v[60:61], v21 offset:4096
  ds_read_b64_tr_b16 v[62:63], v21 offset:6144
  ds_read_b64_tr_b16 v[64:65], v21 offset:8192
  ds_read_b64_tr_b16 v[66:67], v21 offset:10240
  ds_read_b64_tr_b16 v[68:69], v21 offset:12288
  ds_read_b64_tr_b16 v[70:71], v21 offset:14336
  s_lshl_b32 s12, s71, 2
  s_add_u32 s12, s12, 1
  s_cmp_eq_u32 s70, 1
  s_cbranch_scc0 L_d_138
  s_mul_hi_u32 s3, s12, 715827883
  s_mul_i32 s83, s3, 6
  s_sub_u32 s83, s12, s83
  s_mul_i32 s3, s3, 120
  s_add_u32 s3, s3, s83
  s_lshl_b32 s13, s74, 2
  s_mul_hi_u32 s92, s13, 429496730
  s_mul_i32 s93, s92, 10
  s_sub_u32 s93, s13, s93
  s_mul_i32 s93, s93, 12
  s_mul_i32 s92, s92, 6
  s_add_u32 s92, s92, s93
  s_add_u32 s92, s92, s3
  s_lshl_b32 s92, s92, 10
  s_add_u32 s76, s92, 26214400
  s_lshl_b32 s13, s74, 2
  s_add_u32 s13, s13, 1
  s_mul_hi_u32 s92, s13, 429496730
  s_mul_i32 s93, s92, 10
  s_sub_u32 s93, s13, s93
  s_mul_i32 s93, s93, 12
  s_mul_i32 s92, s92, 6
  s_add_u32 s92, s92, s93
  s_add_u32 s92, s92, s3
  s_lshl_b32 s92, s92, 10
  s_add_u32 s77, s92, 26214400
  s_lshl_b32 s13, s74, 2
  s_add_u32 s13, s13, 2
  s_mul_hi_u32 s92, s13, 429496730
  s_mul_i32 s93, s92, 10
  s_sub_u32 s93, s13, s93
  s_mul_i32 s93, s93, 12
  s_mul_i32 s92, s92, 6
  s_add_u32 s92, s92, s93
  s_add_u32 s92, s92, s3
  s_lshl_b32 s92, s92, 10
  s_add_u32 s78, s92, 26214400
  s_lshl_b32 s13, s74, 2
  s_add_u32 s13, s13, 3
  s_mul_hi_u32 s92, s13, 429496730
  s_mul_i32 s93, s92, 10
  s_sub_u32 s93, s13, s93
  s_mul_i32 s93, s93, 12
  s_mul_i32 s92, s92, 6
  s_add_u32 s92, s92, s93
  s_add_u32 s92, s92, s3
  s_lshl_b32 s92, s92, 10
  s_add_u32 s79, s92, 26214400
  s_branch L_d_139
L_d_138:
  s_mul_hi_u32 s3, s12, 858993460
  s_mul_i32 s83, s3, 5
  s_sub_u32 s83, s12, s83
  s_mul_i32 s3, s3, 240
  s_add_u32 s3, s3, s83
  s_lshl_b32 s13, s74, 2
  s_mul_hi_u32 s92, s13, 357913942
  s_mul_i32 s93, s92, 12
  s_sub_u32 s93, s13, s93
  s_mul_i32 s93, s93, 20
  s_mul_i32 s92, s92, 5
  s_add_u32 s92, s92, s93
  s_add_u32 s92, s92, s3
  s_lshl_b32 s92, s92, 10
  s_add_u32 s76, s92, 29360128
  s_lshl_b32 s13, s74, 2
  s_add_u32 s13, s13, 1
  s_mul_hi_u32 s92, s13, 357913942
  s_mul_i32 s93, s92, 12
  s_sub_u32 s93, s13, s93
  s_mul_i32 s93, s93, 20
  s_mul_i32 s92, s92, 5
  s_add_u32 s92, s92, s93
  s_add_u32 s92, s92, s3
  s_lshl_b32 s92, s92, 10
  s_add_u32 s77, s92, 29360128
  s_lshl_b32 s13, s74, 2
  s_add_u32 s13, s13, 2
  s_mul_hi_u32 s92, s13, 357913942
  s_mul_i32 s93, s92, 12
  s_sub_u32 s93, s13, s93
  s_mul_i32 s93, s93, 20
  s_mul_i32 s92, s92, 5
  s_add_u32 s92, s92, s93
  s_add_u32 s92, s92, s3
  s_lshl_b32 s92, s92, 10
  s_add_u32 s78, s92, 29360128
  s_lshl_b32 s13, s74, 2
  s_add_u32 s13, s13, 3
  s_mul_hi_u32 s92, s13, 357913942
  s_mul_i32 s93, s92, 12
  s_sub_u32 s93, s13, s93
  s_mul_i32 s93, s93, 20
  s_mul_i32 s92, s92, 5
  s_add_u32 s92, s92, s93
  s_add_u32 s92, s92, s3
  s_lshl_b32 s92, s92, 10
  s_add_u32 s79, s92, 29360128
L_d_139:
  s_waitcnt lgkmcnt(0)
  buffer_store_dwordx4 v[56:59], v2, s[48:51], s76 offen sc1
  buffer_store_dwordx4 v[60:63], v2, s[48:51], s77 offen sc1
  buffer_store_dwordx4 v[64:67], v2, s[48:51], s78 offen sc1
  buffer_store_dwordx4 v[68:71], v2, s[48:51], s79 offen sc1
  s_cmp_eq_u32 s70, 1
  s_cbranch_scc0 L_cs_140
  v_mfma_f32_16x16x32_bf16 v[36:39], v[56:59], v[32:35], 0
  v_mfma_f32_16x16x32_bf16 v[36:39], v[60:63], v[32:35], v[36:39]
  v_mfma_f32_16x16x32_bf16 v[36:39], v[64:67], v[32:35], v[36:39]
  v_mfma_f32_16x16x32_bf16 v[36:39], v[68:71], v[32:35], v[36:39]
  s_mul_i32 s13, s74, 1536
  s_lshl_b32 s14, s12, 4
  s_add_u32 s13, s13, s14
  s_lshl_b32 s13, s13, 2
  s_add_u32 s13, s13, 32505856
  s_nop 2
  buffer_store_dwordx4 v[36:39], v30, s[48:51], s13 offen sc1
L_cs_140:
  s_nop 2
  ds_read_b64_tr_b16 v[40:41], v22 offset:0
  ds_read_b64_tr_b16 v[42:43], v22 offset:2048
  ds_read_b64_tr_b16 v[44:45], v22 offset:4096
  ds_read_b64_tr_b16 v[46:47], v22 offset:6144
  ds_read_b64_tr_b16 v[48:49], v22 offset:8192
  ds_read_b64_tr_b16 v[50:51], v22 offset:10240
  ds_read_b64_tr_b16 v[52:53], v22 offset:12288
  ds_read_b64_tr_b16 v[54:55], v22 offset:14336
  s_lshl_b32 s12, s71, 2
  s_add_u32 s12, s12, 2
  s_cmp_eq_u32 s70, 1
  s_cbranch_scc0 L_d_141
  s_mul_hi_u32 s3, s12, 715827883
  s_mul_i32 s83, s3, 6
  s_sub_u32 s83, s12, s83
  s_mul_i32 s3, s3, 120
  s_add_u32 s3, s3, s83
  s_lshl_b32 s13, s74, 2
  s_mul_hi_u32 s92, s13, 429496730
  s_mul_i32 s93, s92, 10
  s_sub_u32 s93, s13, s93
  s_mul_i32 s93, s93, 12
  s_mul_i32 s92, s92, 6
  s_add_u32 s92, s92, s93
  s_add_u32 s92, s92, s3
  s_lshl_b32 s92, s92, 10
  s_add_u32 s76, s92, 26214400
  s_lshl_b32 s13, s74, 2
  s_add_u32 s13, s13, 1
  s_mul_hi_u32 s92, s13, 429496730
  s_mul_i32 s93, s92, 10
  s_sub_u32 s93, s13, s93
  s_mul_i32 s93, s93, 12
  s_mul_i32 s92, s92, 6
  s_add_u32 s92, s92, s93
  s_add_u32 s92, s92, s3
  s_lshl_b32 s92, s92, 10
  s_add_u32 s77, s92, 26214400
  s_lshl_b32 s13, s74, 2
  s_add_u32 s13, s13, 2
  s_mul_hi_u32 s92, s13, 429496730
  s_mul_i32 s93, s92, 10
  s_sub_u32 s93, s13, s93
  s_mul_i32 s93, s93, 12
  s_mul_i32 s92, s92, 6
  s_add_u32 s92, s92, s93
  s_add_u32 s92, s92, s3
  s_lshl_b32 s92, s92, 10
  s_add_u32 s78, s92, 26214400
  s_lshl_b32 s13, s74, 2
  s_add_u32 s13, s13, 3
  s_mul_hi_u32 s92, s13, 429496730
  s_mul_i32 s93, s92, 10
  s_sub_u32 s93, s13, s93
  s_mul_i32 s93, s93, 12
  s_mul_i32 s92, s92, 6
  s_add_u32 s92, s92, s93
  s_add_u32 s92, s92, s3
  s_lshl_b32 s92, s92, 10
  s_add_u32 s79, s92, 26214400
  s_branch L_d_142
L_d_141:
  s_mul_hi_u32 s3, s12, 858993460
  s_mul_i32 s83, s3, 5
  s_sub_u32 s83, s12, s83
  s_mul_i32 s3, s3, 240
  s_add_u32 s3, s3, s83
  s_lshl_b32 s13, s74, 2
  s_mul_hi_u32 s92, s13, 357913942
  s_mul_i32 s93, s92, 12
  s_sub_u32 s93, s13, s93
  s_mul_i32 s93, s93, 20
  s_mul_i32 s92, s92, 5
  s_add_u32 s92, s92, s93
  s_add_u32 s92, s92, s3
  s_lshl_b32 s92, s92, 10
  s_add_u32 s76, s92, 29360128
  s_lshl_b32 s13, s74, 2
  s_add_u32 s13, s13, 1
  s_mul_hi_u32 s92, s13, 357913942
  s_mul_i32 s93, s92, 12
  s_sub_u32 s93, s13, s93
  s_mul_i32 s93, s93, 20
  s_mul_i32 s92, s92, 5
  s_add_u32 s92, s92, s93
  s_add_u32 s92, s92, s3
  s_lshl_b32 s92, s92, 10
  s_add_u32 s77, s92, 29360128
  s_lshl_b32 s13, s74, 2
  s_add_u32 s13, s13, 2
  s_mul_hi_u32 s92, s13, 357913942
  s_mul_i32 s93, s92, 12
  s_sub_u32 s93, s13, s93
  s_mul_i32 s93, s93, 20
  s_mul_i32 s92, s92, 5
  s_add_u32 s92, s92, s93
  s_add_u32 s92, s92, s3
  s_lshl_b32 s92, s92, 10
  s_add_u32 s78, s92, 29360128
  s_lshl_b32 s13, s74, 2
  s_add_u32 s13, s13, 3
  s_mul_hi_u32 s92, s13, 357913942
  s_mul_i32 s93, s92, 12
  s_sub_u32 s93, s13, s93
  s_mul_i32 s93, s93, 20
  s_mul_i32 s92, s92, 5
  s_add_u32 s92, s92, s93
  s_add_u32 s92, s92, s3
  s_lshl_b32 s92, s92, 10
  s_add_u32 s79, s92, 29360128
L_d_142:
  s_waitcnt lgkmcnt(0)
  buffer_store_dwordx4 v[40:43], v2, s[48:51], s76 offen sc1
  buffer_store_dwordx4 v[44:47], v2, s[48:51], s77 offen sc1
  buffer_store_dwordx4 v[48:51], v2, s[48:51], s78 offen sc1
  buffer_store_dwordx4 v[52:55], v2, s[48:51], s79 offen sc1
  s_cmp_eq_u32 s70, 1
  s_cbranch_scc0 L_cs_143
  v_mfma_f32_16x16x32_bf16 v[36:39], v[40:43], v[32:35], 0
  v_mfma_f32_16x16x32_bf16 v[36:39], v[44:47], v[32:35], v[36:39]
  v_mfma_f32_16x16x32_bf16 v[36:39], v[48:51], v[32:35], v[36:39]
  v_mfma_f32_16x16x32_bf16 v[36:39], v[52:55], v[32:35], v[36:39]
  s_mul_i32 s13, s74, 1536
  s_lshl_b32 s14, s12, 4
  s_add_u32 s13, s13, s14
  s_lshl_b32 s13, s13, 2
  s_add_u32 s13, s13, 32505856
  s_nop 2
  buffer_store_dwordx4 v[36:39], v30, s[48:51], s13 offen sc1
L_cs_143:
  s_nop 2
  ds_read_b64_tr_b16 v[56:57], v23 offset:0
  ds_read_b64_tr_b16 v[58:59], v23 offset:2048
  ds_read_b64_tr_b16 v[60:61], v23 offset:4096
  ds_read_b64_tr_b16 v[62:63], v23 offset:6144
  ds_read_b64_tr_b16 v[64:65], v23 offset:8192
  ds_read_b64_tr_b16 v[66:67], v23 offset:10240
  ds_read_b64_tr_b16 v[68:69], v23 offset:12288
  ds_read_b64_tr_b16 v[70:71], v23 offset:14336
  s_lshl_b32 s12, s71, 2
  s_add_u32 s12, s12, 3
  s_cmp_eq_u32 s70, 1
  s_cbranch_scc0 L_d_144
  s_mul_hi_u32 s3, s12, 715827883
  s_mul_i32 s83, s3, 6
  s_sub_u32 s83, s12, s83
  s_mul_i32 s3, s3, 120
  s_add_u32 s3, s3, s83
  s_lshl_b32 s13, s74, 2
  s_mul_hi_u32 s92, s13, 429496730
  s_mul_i32 s93, s92, 10
  s_sub_u32 s93, s13, s93
  s_mul_i32 s93, s93, 12
  s_mul_i32 s92, s92, 6
  s_add_u32 s92, s92, s93
  s_add_u32 s92, s92, s3
  s_lshl_b32 s92, s92, 10
  s_add_u32 s76, s92, 26214400
  s_lshl_b32 s13, s74, 2
  s_add_u32 s13, s13, 1
  s_mul_hi_u32 s92, s13, 429496730
  s_mul_i32 s93, s92, 10
  s_sub_u32 s93, s13, s93
  s_mul_i32 s93, s93, 12
  s_mul_i32 s92, s92, 6
  s_add_u32 s92, s92, s93
  s_add_u32 s92, s92, s3
  s_lshl_b32 s92, s92, 10
  s_add_u32 s77, s92, 26214400
  s_lshl_b32 s13, s74, 2
  s_add_u32 s13, s13, 2
  s_mul_hi_u32 s92, s13, 429496730
  s_mul_i32 s93, s92, 10
  s_sub_u32 s93, s13, s93
  s_mul_i32 s93, s93, 12
  s_mul_i32 s92, s92, 6
  s_add_u32 s92, s92, s93
  s_add_u32 s92, s92, s3
  s_lshl_b32 s92, s92, 10
  s_add_u32 s78, s92, 26214400
  s_lshl_b32 s13, s74, 2
  s_add_u32 s13, s13, 3
  s_mul_hi_u32 s92, s13, 429496730
  s_mul_i32 s93, s92, 10
  s_sub_u32 s93, s13, s93
  s_mul_i32 s93, s93, 12
  s_mul_i32 s92, s92, 6
  s_add_u32 s92, s92, s93
  s_add_u32 s92, s92, s3
  s_lshl_b32 s92, s92, 10
  s_add_u32 s79, s92, 26214400
  s_branch L_d_145
L_d_144:
  s_mul_hi_u32 s3, s12, 858993460
  s_mul_i32 s83, s3, 5
  s_sub_u32 s83, s12, s83
  s_mul_i32 s3, s3, 240
  s_add_u32 s3, s3, s83
  s_lshl_b32 s13, s74, 2
  s_mul_hi_u32 s92, s13, 357913942
  s_mul_i32 s93, s92, 12
  s_sub_u32 s93, s13, s93
  s_mul_i32 s93, s93, 20
  s_mul_i32 s92, s92, 5
  s_add_u32 s92, s92, s93
  s_add_u32 s92, s92, s3
  s_lshl_b32 s92, s92, 10
  s_add_u32 s76, s92, 29360128
  s_lshl_b32 s13, s74, 2
  s_add_u32 s13, s13, 1
  s_mul_hi_u32 s92, s13, 357913942
  s_mul_i32 s93, s92, 12
  s_sub_u32 s93, s13, s93
  s_mul_i32 s93, s93, 20
  s_mul_i32 s92, s92, 5
  s_add_u32 s92, s92, s93
  s_add_u32 s92, s92, s3
  s_lshl_b32 s92, s92, 10
  s_add_u32 s77, s92, 29360128
  s_lshl_b32 s13, s74, 2
  s_add_u32 s13, s13, 2
  s_mul_hi_u32 s92, s13, 357913942
  s_mul_i32 s93, s92, 12
  s_sub_u32 s93, s13, s93
  s_mul_i32 s93, s93, 20
  s_mul_i32 s92, s92, 5
  s_add_u32 s92, s92, s93
  s_add_u32 s92, s92, s3
  s_lshl_b32 s92, s92, 10
  s_add_u32 s78, s92, 29360128
  s_lshl_b32 s13, s74, 2
  s_add_u32 s13, s13, 3
  s_mul_hi_u32 s92, s13, 357913942
  s_mul_i32 s93, s92, 12
  s_sub_u32 s93, s13, s93
  s_mul_i32 s93, s93, 20
  s_mul_i32 s92, s92, 5
  s_add_u32 s92, s92, s93
  s_add_u32 s92, s92, s3
  s_lshl_b32 s92, s92, 10
  s_add_u32 s79, s92, 29360128
L_d_145:
  s_waitcnt lgkmcnt(0)
  buffer_store_dwordx4 v[56:59], v2, s[48:51], s76 offen sc1
  buffer_store_dwordx4 v[60:63], v2, s[48:51], s77 offen sc1
  buffer_store_dwordx4 v[64:67], v2, s[48:51], s78 offen sc1
  buffer_store_dwordx4 v[68:71], v2, s[48:51], s79 offen sc1
  s_cmp_eq_u32 s70, 1
  s_cbranch_scc0 L_cs_146
  v_mfma_f32_16x16x32_bf16 v[36:39], v[56:59], v[32:35], 0
  v_mfma_f32_16x16x32_bf16 v[36:39], v[60:63], v[32:35], v[36:39]
  v_mfma_f32_16x16x32_bf16 v[36:39], v[64:67], v[32:35], v[36:39]
  v_mfma_f32_16x16x32_bf16 v[36:39], v[68:71], v[32:35], v[36:39]
  s_mul_i32 s13, s74, 1536
  s_lshl_b32 s14, s12, 4
  s_add_u32 s13, s13, s14
  s_lshl_b32 s13, s13, 2
  s_add_u32 s13, s13, 32505856
  s_nop 2
  buffer_store_dwordx4 v[36:39], v30, s[48:51], s13 offen sc1
L_cs_146:
  s_nop 2
  s_waitcnt vmcnt(0)
  s_lshl_b32 s97, s96, 2
  s_add_u32 s97, s97, 24840
  s_cmp_lg_u32 s8, 8
  s_cbranch_scc1 L_sig_147
  s_or_b32 s15, s9, s11
  v_mov_b32 v164, s15
  v_mov_b32 v163, 0
  s_mov_b64 exec, 1
  buffer_store_dword v164, v163, s[48:51], s97 offen sc1
  s_mov_b64 exec, -1
L_sig_147:
  s_branch L_s_join
L_s_spare:
  s_nop 1
  s_cmp_lg_u32 s8, 8
  s_cbranch_scc1 L_ei_148
  v_mov_b32 v163, 0
  buffer_load_dword v160, v163, s[56:59], 0 offen sc1
L_ei_148:
  s_waitcnt vmcnt(0)
  s_cmp_lg_u32 s8, 8
  s_cbranch_scc1 L_et_149
  s_cmp_lg_u32 s9, 0
  s_cbranch_scc1 L_et_149
  v_readfirstlane_b32 s9, v160
  s_mov_b32 s99, 0
L_et_150:
  s_nop 0
  s_cmp_lg_u32 s9, 0
  s_cbranch_scc1 L_et_151
  s_add_u32 s99, s99, 1
  s_cmp_gt_u32 s99, 0x40000
  s_cbranch_scc1 L_end
  v_mov_b32 v163, 0
  buffer_load_dword v160, v163, s[56:59], 0 offen sc1
  s_waitcnt vmcnt(0)
  v_readfirstlane_b32 s9, v160
  s_branch L_et_150
L_et_151:
  s_lshl_b32 s12, s4, 7
  s_lshl_b32 s13, s5, 2
  s_add_u32 s12, s12, s13
  s_cmp_lg_u32 s8, 8
  s_cbranch_scc1 L_sig_152
  s_or_b32 s15, s9, s11
  v_mov_b32 v164, s15
  v_mov_b32 v163, 0
  s_mov_b64 exec, 1
  buffer_store_dword v164, v163, s[48:51], s12 offen sc1
  s_mov_b64 exec, -1
L_sig_152:
L_et_149:
  s_barrier
  s_barrier
  s_lshl_b32 s97, s4, 1
  s_add_u32 s97, s97, s6
  s_lshl_b32 s97, s97, 2
  s_add_u32 s97, s97, 24576
  s_cmp_lg_u32 s8, 8
  s_cbranch_scc1 L_sig_153
  s_or_b32 s15, s9, s11
  v_mov_b32 v164, s15
  v_mov_b32 v163, 0
  s_mov_b64 exec, 1
  buffer_store_dword v164, v163, s[48:51], s97 offen sc1
  s_mov_b64 exec, -1
L_sig_153:
  s_barrier
  s_lshl_b32 s68, s4, 7
  v_min_u32 v161, 15, v1
  v_lshlrev_b32 v161, 2, v161
  s_mov_b32 s14, 24576
  buffer_load_dword v162, v161, s[48:51], s14 offen sc1
  v_min_u32 v163, 31, v1
  v_lshlrev_b32 v163, 2, v163
  s_mov_b32 s99, 0
L_wf_154:
  s_add_u32 s99, s99, 1
  s_cmp_gt_u32 s99, 0x40000
  s_cbranch_scc1 L_end
  buffer_load_dword v164, v163, s[48:51], s68 offen sc1
  s_waitcnt vmcnt(0)
  v_and_b32 v165, -8, v164
  v_cmp_ne_u32 vcc, s9, v165
  s_nop 4
  s_cbranch_vccnz L_wf_154
  v_and_b32 v164, 7, v164
  v_cmp_ne_u32 vcc, s11, v164
  s_nop 1
  s_cmp_eq_u64 vcc, 0
  s_cselect_b32 s10, 1, 0
  v_and_b32 v165, -8, v162
  v_cmp_ne_u32 vcc, s9, v165
  s_nop 1
  s_cmp_eq_u64 vcc, 0
  s_cselect_b32 s13, 2, 0
  s_or_b32 s12, s10, s13
  v_mov_b32 v164, s12
  v_mov_b32 v163, 2560
  ds_write_b32 v163, v164
  s_waitcnt lgkmcnt(0)
  s_barrier
L_s_join:
  s_nop 1
  s_mov_b32 s68, s4
  s_lshl_b32 s68, s68, 7
  s_add_u32 s68, s68, 4096
  s_lshl_b32 s69, s5, 2
  s_add_u32 s69, s69, s68
  s_barrier
  s_cmp_lg_u32 s8, 8
  s_cbranch_scc1 L_sig_155
  s_or_b32 s15, s9, s11
  v_mov_b32 v164, s15
  v_mov_b32 v163, 0
  s_mov_b64 exec, 1
  s_cmp_eq_u32 s10, 0
  s_cbranch_scc1 L_hs_156
  buffer_store_dword v164, v163, s[48:51], s69 offen
  s_branch L_hs_157
L_hs_156:
  buffer_store_dword v164, v163, s[48:51], s69 offen sc1
L_hs_157:
  s_mov_b64 exec, -1
L_sig_155:
  v_mov_b32 v16, 0
  v_mov_b32 v17, 0
  v_mov_b32 v18, 0
  v_mov_b32 v19, 0
  ds_write_b128 v2, v[16:19] offset:0
  ds_write_b128 v2, v[16:19] offset:1024
  ds_write_b128 v2, v[16:19] offset:2048
  s_mov_b32 s82, 24576
  v_min_u32 v163, 31, v1
  v_lshlrev_b32 v163, 2, v163
  v_min_u32 v161, 15, v1
  v_lshlrev_b32 v161, 2, v161
  s_mov_b32 s99, 0
L_wf_158:
  s_add_u32 s99, s99, 1
  s_cmp_gt_u32 s99, 0x40000
  s_cbranch_scc1 L_end
  buffer_load_dword v164, v163, s[48:51], s68 offen sc1
  buffer_load_dword v162, v161, s[48:51], s82 offen sc1
  s_waitcnt vmcnt(0)
  v_and_b32 v165, -8, v164
  v_cmp_ne_u32 vcc, s9, v165
  v_and_b32 v165, -8, v162
  v_cmp_ne_u32 s[12:13], s9, v165
  s_nop 1
  s_or_b64 vcc, vcc, s[12:13]
  s_nop 4
  s_cbranch_vccnz L_wf_158
  s_waitcnt lgkmcnt(0)
  s_barrier
  s_barrier
  s_mov_b32 s68, s5
  s_lshl_b32 s68, s68, 7
  s_add_u32 s68, s68, 8192
  s_lshl_b32 s69, s4, 2
  s_add_u32 s69, s69, s68
  s_barrier
  s_cmp_lg_u32 s8, 8
  s_cbranch_scc1 L_sig_159
  s_or_b32 s15, s9, s11
  v_mov_b32 v164, s15
  v_mov_b32 v163, 0
  s_mov_b64 exec, 1
  buffer_store_dword v164, v163, s[48:51], s69 offen sc1
  s_mov_b64 exec, -1
L_sig_159:
  s_mul_i32 s12, s5, 5
  s_and_b32 s81, s12, 7
  s_lshl_b32 s81, s81, 2
  v_min_u32 v12, 40, v1
  v_lshlrev_b32 v12, 4, v12
  v_add_u32 v12, 1024, v12
  v_mov_b32 v20, v1
  v_mul_u32_u24 v21, 52429, v20
  v_lshrrev_b32 v21, 18, v21
  v_mul_u32_u24 v22, 5, v21
  v_sub_u32 v22, v20, v22
  v_mul_u32_u24 v21, 136, v21
  v_lshl_add_u32 v21, v22, 3, v21
  s_lshl_b32 s12, s81, 1
  v_add_u32 v24, s12, v21
  v_min_u32 v20, 40, v1
  v_add_u32 v20, 64, v20
  v_mul_u32_u24 v21, 52429, v20
  v_lshrrev_b32 v21, 18, v21
  v_mul_u32_u24 v22, 5, v21
  v_sub_u32 v22, v20, v22
  v_mul_u32_u24 v21, 136, v21
  v_lshl_add_u32 v21, v22, 3, v21
  s_lshl_b32 s12, s81, 1
  v_add_u32 v25, s12, v21
  v_min_u32 v163, 7, v1
  v_lshlrev_b32 v163, 2, v163
  v_min_u32 v161, 59, v1
  v_lshlrev_b32 v161, 4, v161
  s_mov_b32 s14, 25040
  s_mov_b32 s99, 0
L_wf_160:
  s_add_u32 s99, s99, 1
  s_cmp_gt_u32 s99, 0x40000
  s_cbranch_scc1 L_end
  buffer_load_dword v164, v163, s[48:51], s68 offen sc1
  buffer_load_dwordx4 v[156:159], v161, s[48:51], s14 offen sc1
  s_waitcnt vmcnt(0)
  v_and_b32 v165, -8, v164
  v_cmp_ne_u32 vcc, s9, v165
  v_and_b32 v165, -8, v156
  v_cmp_ne_u32 s[12:13], s9, v165
  s_nop 1
  s_or_b64 vcc, vcc, s[12:13]
  v_and_b32 v165, -8, v157
  v_cmp_ne_u32 s[12:13], s9, v165
  s_nop 1
  s_or_b64 vcc, vcc, s[12:13]
  v_and_b32 v165, -8, v158
  v_cmp_ne_u32 s[12:13], s9, v165
  s_nop 1
  s_or_b64 vcc, vcc, s[12:13]
  v_and_b32 v165, -8, v159
  v_cmp_ne_u32 s[12:13], s9, v165
  s_nop 1
  s_or_b64 vcc, vcc, s[12:13]
  s_nop 4
  s_cbranch_vccnz L_wf_160
  s_lshl_b32 s12, s5, 11
  s_add_u32 s12, s12, 10485760
  buffer_load_dwordx4 v[32:35], v2, s[48:51], s12 offen sc1
  buffer_load_dwordx4 v[64:67], v12, s[48:51], s12 offen sc1
  s_add_u32 s12, s12, 65536
  buffer_load_dwordx4 v[36:39], v2, s[48:51], s12 offen sc1
  buffer_load_dwordx4 v[68:71], v12, s[48:51], s12 offen sc1
  s_add_u32 s12, s12, 65536
  buffer_load_dwordx4 v[40:43], v2, s[48:51], s12 offen sc1
  buffer_load_dwordx4 v[72:75], v12, s[48:51], s12 offen sc1
  s_add_u32 s12, s12, 65536
  buffer_load_dwordx4 v[44:47], v2, s[48:51], s12 offen sc1
  buffer_load_dwordx4 v[76:79], v12, s[48:51], s12 offen sc1
  s_add_u32 s12, s12, 65536
  buffer_load_dwordx4 v[48:51], v2, s[48:51], s12 offen sc1
  buffer_load_dwordx4 v[80:83], v12, s[48:51], s12 offen sc1
  s_add_u32 s12, s12, 65536
  buffer_load_dwordx4 v[52:55], v2, s[48:51], s12 offen sc1
  buffer_load_dwordx4 v[84:87], v12, s[48:51], s12 offen sc1
  s_add_u32 s12, s12, 65536
  buffer_load_dwordx4 v[56:59], v2, s[48:51], s12 offen sc1
  buffer_load_dwordx4 v[88:91], v12, s[48:51], s12 offen sc1
  s_add_u32 s12, s12, 65536
  buffer_load_dwordx4 v[60:63], v2, s[48:51], s12 offen sc1
  buffer_load_dwordx4 v[92:95], v12, s[48:51], s12 offen sc1
  s_add_u32 s12, s12, 65536
  s_barrier
  s_waitcnt vmcnt(0)
  v_pk_add_f32 v[32:33], v[32:33], v[36:37]
  v_pk_add_f32 v[34:35], v[34:35], v[38:39]
  v_pk_add_f32 v[32:33], v[32:33], v[40:41]
  v_pk_add_f32 v[34:35], v[34:35], v[42:43]
  v_pk_add_f32 v[32:33], v[32:33], v[44:45]
  v_pk_add_f32 v[34:35], v[34:35], v[46:47]
  v_pk_add_f32 v[32:33], v[32:33], v[48:49]
  v_pk_add_f32 v[34:35], v[34:35], v[50:51]
  v_pk_add_f32 v[32:33], v[32:33], v[52:53]
  v_pk_add_f32 v[34:35], v[34:35], v[54:55]
  v_pk_add_f32 v[32:33], v[32:33], v[56:57]
  v_pk_add_f32 v[34:35], v[34:35], v[58:59]
  v_pk_add_f32 v[32:33], v[32:33], v[60:61]
  v_pk_add_f32 v[34:35], v[34:35], v[62:63]
  v_cvt_pk_bf16_f32 v32, v32, v33
  v_cvt_pk_bf16_f32 v33, v34, v35
  ds_write_b64 v24, v[32:33]
  v_pk_add_f32 v[64:65], v[64:65], v[68:69]
  v_pk_add_f32 v[66:67], v[66:67], v[70:71]
  v_pk_add_f32 v[64:65], v[64:65], v[72:73]
  v_pk_add_f32 v[66:67], v[66:67], v[74:75]
  v_pk_add_f32 v[64:65], v[64:65], v[76:77]
  v_pk_add_f32 v[66:67], v[66:67], v[78:79]
  v_pk_add_f32 v[64:65], v[64:65], v[80:81]
  v_pk_add_f32 v[66:67], v[66:67], v[82:83]
  v_pk_add_f32 v[64:65], v[64:65], v[84:85]
  v_pk_add_f32 v[66:67], v[66:67], v[86:87]
  v_pk_add_f32 v[64:65], v[64:65], v[88:89]
  v_pk_add_f32 v[66:67], v[66:67], v[90:91]
  v_pk_add_f32 v[64:65], v[64:65], v[92:93]
  v_pk_add_f32 v[66:67], v[66:67], v[94:95]
  v_cvt_pk_bf16_f32 v64, v64, v65
  v_cvt_pk_bf16_f32 v65, v66, v67
  ds_write_b64 v25, v[64:65]
  s_waitcnt lgkmcnt(0)
  s_barrier
  s_mov_b32 s68, s4
  s_lshl_b32 s68, s68, 7
  s_add_u32 s68, s68, 12288
  s_lshl_b32 s69, s5, 2
  s_add_u32 s69, s69, s68
  s_barrier
  s_cmp_lg_u32 s8, 8
  s_cbranch_scc1 L_sig_161
  s_or_b32 s15, s9, s11
  v_mov_b32 v164, s15
  v_mov_b32 v163, 0
  s_mov_b64 exec, 1
  s_cmp_eq_u32 s10, 0
  s_cbranch_scc1 L_hs_162
  buffer_store_dword v164, v163, s[48:51], s69 offen
  s_branch L_hs_163
L_hs_162:
  buffer_store_dword v164, v163, s[48:51], s69 offen sc1
L_hs_163:
  s_mov_b64 exec, -1
L_sig_161:
  v_min_u32 v163, 31, v1
  v_lshlrev_b32 v163, 2, v163
  s_mov_b32 s99, 0
L_wf_164:
  s_add_u32 s99, s99, 1
  s_cmp_gt_u32 s99, 0x40000
  s_cbranch_scc1 L_end
  buffer_load_dword v164, v163, s[48:51], s68 offen sc1
  s_waitcnt vmcnt(0)
  v_and_b32 v165, -8, v164
  v_cmp_ne_u32 vcc, s9, v165
  s_nop 4
  s_cbranch_vccnz L_wf_164
  s_barrier
  s_barrier
  s_barrier
  s_lshl_b32 s68, s4, 1
  s_add_u32 s68, s68, s6
  s_lshl_b32 s68, s68, 7
  s_add_u32 s68, s68, 16384
  s_lshl_b32 s69, s7, 2
  s_add_u32 s69, s69, s68
  s_barrier
  s_cmp_lg_u32 s8, 8
  s_cbranch_scc1 L_sig_165
  s_or_b32 s15, s9, s11
  v_mov_b32 v164, s15
  v_mov_b32 v163, 0
  s_mov_b64 exec, 1
  s_cmp_eq_u32 s10, 0
  s_cbranch_scc1 L_hs_166
  buffer_store_dword v164, v163, s[48:51], s69 offen
  s_branch L_hs_167
L_hs_166:
  buffer_store_dword v164, v163, s[48:51], s69 offen sc1
L_hs_167:
  s_mov_b64 exec, -1
L_sig_165:
  v_min_u32 v163, 15, v1
  v_lshlrev_b32 v163, 2, v163
  s_mov_b32 s99, 0
L_wf_168:
  s_add_u32 s99, s99, 1
  s_cmp_gt_u32 s99, 0x40000
  s_cbranch_scc1 L_end
  buffer_load_dword v164, v163, s[48:51], s68 offen sc1
  s_waitcnt vmcnt(0)
  v_and_b32 v165, -8, v164
  v_cmp_ne_u32 vcc, s9, v165
  s_nop 4
  s_cbranch_vccnz L_wf_168
  s_barrier
  s_mov_b32 s64, s26
  s_mov_b32 s65, s27
  s_mov_b32 s66, 3072
  s_mov_b32 s67, 0x20000
  s_mul_i32 s12, s7, 96
  v_mov_b32 v12, v1
  v_add_u32 v14, s12, v12
  v_lshlrev_b32 v15, 2, v14
  s_mov_b32 s13, 32505856
  buffer_load_dword v16, v15, s[48:51], s13 offen sc1
  s_add_u32 s13, s13, 6144
  buffer_load_dword v17, v15, s[48:51], s13 offen sc1
  s_add_u32 s13, s13, 6144
  buffer_load_dword v18, v15, s[48:51], s13 offen sc1
  s_add_u32 s13, s13, 6144
  buffer_load_dword v19, v15, s[48:51], s13 offen sc1
  s_add_u32 s13, s13, 6144
  buffer_load_dword v20, v15, s[48:51], s13 offen sc1
  s_add_u32 s13, s13, 6144
  v_lshlrev_b32 v15, 1, v14
  buffer_load_ushort v21, v15, s[64:67], 0 offen
  v_min_u32 v13, 31, v1
  v_add_u32 v13, 64, v13
  v_add_u32 v14, s12, v13
  v_lshlrev_b32 v15, 2, v14
  s_mov_b32 s13, 32505856
  buffer_load_dword v24, v15, s[48:51], s13 offen sc1
  s_add_u32 s13, s13, 6144
  buffer_load_dword v25, v15, s[48:51], s13 offen sc1
  s_add_u32 s13, s13, 6144
  buffer_load_dword v26, v15, s[48:51], s13 offen sc1
  s_add_u32 s13, s13, 6144
  buffer_load_dword v27, v15, s[48:51], s13 offen sc1
  s_add_u32 s13, s13, 6144
  buffer_load_dword v28, v15, s[48:51], s13 offen sc1
  s_add_u32 s13, s13, 6144
  v_lshlrev_b32 v15, 1, v14
  buffer_load_ushort v29, v15, s[64:67], 0 offen
  s_barrier
  s_waitcnt vmcnt(0)
  v_add_f32 v16, v16, v17
  v_add_f32 v16, v16, v18
  v_add_f32 v16, v16, v19
  v_add_f32 v16, v16, v20
  v_lshlrev_b32 v21, 16, v21
  v_lshlrev_b32 v22, 2, v12
  v_add_u32 v22, 73728, v22
  ds_write_b32 v22, v16
  ds_write_b32 v22, v21 offset:512
  v_add_f32 v24, v24, v25
  v_add_f32 v24, v24, v26
  v_add_f32 v24, v24, v27
  v_add_f32 v24, v24, v28
  v_lshlrev_b32 v29, 16, v29
  v_lshlrev_b32 v30, 2, v13
  v_add_u32 v30, 73728, v30
  ds_write_b32 v30, v24
  ds_write_b32 v30, v29 offset:512
  s_waitcnt lgkmcnt(0)
  s_barrier
  s_barrier
  s_lshl_b32 s68, s4, 1
  s_add_u32 s68, s68, s6
  s_lshl_b32 s68, s68, 7
  s_add_u32 s68, s68, 20480
  s_lshl_b32 s69, s7, 2
  s_add_u32 s69, s69, s68
  s_barrier
  s_cmp_lg_u32 s8, 8
  s_cbranch_scc1 L_sig_169
  s_or_b32 s15, s9, s11
  v_mov_b32 v164, s15
  v_mov_b32 v163, 0
  s_mov_b64 exec, 1
  s_cmp_eq_u32 s10, 0
  s_cbranch_scc1 L_hs_170
  buffer_store_dword v164, v163, s[48:51], s69 offen
  s_branch L_hs_171
L_hs_170:
  buffer_store_dword v164, v163, s[48:51], s69 offen sc1
L_hs_171:
  s_mov_b64 exec, -1
L_sig_169:
  v_min_u32 v163, 15, v1
  v_lshlrev_b32 v163, 2, v163
  s_mov_b32 s99, 0
L_wf_172:
  s_add_u32 s99, s99, 1
  s_cmp_gt_u32 s99, 0x40000
  s_cbranch_scc1 L_end
  buffer_load_dword v164, v163, s[48:51], s68 offen sc1
  s_waitcnt vmcnt(0)
  v_and_b32 v165, -8, v164
  v_cmp_ne_u32 vcc, s9, v165
  s_nop 4
  s_cbranch_vccnz L_wf_172
  s_barrier
  s_cmp_lg_u32 s2, 0
  s_cbranch_scc1 L_z0_173
  v_mov_b32 v163, 0
  s_mov_b64 exec, 1
  buffer_store_dword v163, v163, s[56:59], 0 offen sc1
  s_mov_b64 exec, -1
L_z0_173:
  s_barrier
  s_barrier
  s_barrier
  s_barrier
  s_branch L_fin
L_loader:
  s_nop 1
  s_setprio 3
  s_sub_u32 s95, s8, 9
  s_cmp_eq_u32 s7, 15
  s_cbranch_scc1 L_l_spare
  s_lshl_b32 s12, s7, 8
  s_add_u32 s13, s12, 128
  s_sub_u32 s14, s7, 5
  s_lshl_b32 s14, s14, 7
  s_add_u32 s15, s14, 2560
  s_add_u32 s14, s14, 1280
  s_cmp_lt_u32 s7, 5
  s_cselect_b32 s68, s12, s14
  s_cselect_b32 s69, s13, s15
  v_lshrrev_b32 v10, 3, v1
  v_and_b32 v11, 7, v1
  v_xor_b32 v11, v11, v10
  v_mul_u32_u24 v10, 1280, v10
  v_lshl_add_u32 v6, v11, 4, v10
  v_lshlrev_b32 v10, 1, v3
  v_xor_b32 v10, v10, v4
  v_and_b32 v11, 7, v10
  v_lshlrev_b32 v11, 4, v11
  v_mov_b32 v12, s68
  v_mov_b32 v13, s69
  v_cmp_gt_u32 vcc, 8, v10
  s_nop 1
  v_cndmask_b32 v12, v13, v12, vcc
  v_add_u32 v11, v11, v12
  v_mul_u32_u24 v12, 3840, v3
  v_add_u32 v7, v11, v12
  v_lshlrev_b32 v10, 1, v3
  v_or_b32 v10, 8, v10
  v_xor_b32 v10, v10, v4
  v_and_b32 v11, 7, v10
  v_lshlrev_b32 v11, 4, v11
  v_mov_b32 v12, s68
  v_mov_b32 v13, s69
  v_cmp_gt_u32 vcc, 8, v10
  s_nop 1
  v_cndmask_b32 v12, v13, v12, vcc
  v_add_u32 v11, v11, v12
  v_mul_u32_u24 v12, 3840, v3
  v_add_u32 v8, v11, v12
  s_lshl_b32 s12, s4, 8
  s_lshl_b32 s13, s6, 7
  s_add_u32 s12, s12, s13
  s_mul_i32 s72, s12, 1280
  s_sub_u32 s73, s95, 1
  s_mul_i32 s73, s73, 122880
  s_sub_u32 s74, s95, 1
  s_lshl_b32 s74, s74, 13
  s_cmp_eq_u32 s95, 0
  s_cbranch_scc0 L_l_B
  s_mov_b32 m0, 0
  s_add_u32 s12, s72, 0
  buffer_load_dwordx4 v6, s[40:43], s12 offen lds
  s_mov_b32 m0, 1024
  s_add_u32 s12, s72, 10240
  buffer_load_dwordx4 v6, s[40:43], s12 offen lds
  s_mov_b32 m0, 2048
  s_add_u32 s12, s72, 20480
  buffer_load_dwordx4 v6, s[40:43], s12 offen lds
  s_mov_b32 m0, 3072
  s_add_u32 s12, s72, 30720
  buffer_load_dwordx4 v6, s[40:43], s12 offen lds
  s_mov_b32 m0, 4096
  s_add_u32 s12, s72, 40960
  buffer_load_dwordx4 v6, s[40:43], s12 offen lds
  s_mov_b32 m0, 5120
  s_add_u32 s12, s72, 51200
  buffer_load_dwordx4 v6, s[40:43], s12 offen lds
  s_mov_b32 m0, 6144
  s_add_u32 s12, s72, 61440
  buffer_load_dwordx4 v6, s[40:43], s12 offen lds
  s_mov_b32 m0, 7168
  s_add_u32 s12, s72, 71680
  buffer_load_dwordx4 v6, s[40:43], s12 offen lds
  s_mov_b32 m0, 8192
  s_add_u32 s12, s72, 81920
  buffer_load_dwordx4 v6, s[40:43], s12 offen lds
  s_mov_b32 m0, 9216
  s_add_u32 s12, s72, 92160
  buffer_load_dwordx4 v6, s[40:43], s12 offen lds
  s_mov_b32 m0, 10240
  s_add_u32 s12, s72, 102400
  buffer_load_dwordx4 v6, s[40:43], s12 offen lds
  s_mov_b32 m0, 11264
  s_add_u32 s12, s72, 112640
  buffer_load_dwordx4 v6, s[40:43], s12 offen lds
  s_mov_b32 m0, 12288
  s_add_u32 s12, s72, 122880
  buffer_load_dwordx4 v6, s[40:43], s12 offen lds
  s_mov_b32 m0, 13312
  s_add_u32 s12, s72, 133120
  buffer_load_dwordx4 v6, s[40:43], s12 offen lds
  s_mov_b32 m0, 14336
  s_add_u32 s12, s72, 143360
  buffer_load_dwordx4 v6, s[40:43], s12 offen lds
  s_mov_b32 m0, 15360
  s_add_u32 s12, s72, 153600
  buffer_load_dwordx4 v6, s[40:43], s12 offen lds
  s_mov_b32 m0, 32768
  s_add_u32 s12, s72, 128
  buffer_load_dwordx4 v6, s[40:43], s12 offen lds
  s_mov_b32 m0, 33792
  s_add_u32 s12, s72, 10368
  buffer_load_dwordx4 v6, s[40:43], s12 offen lds
  s_mov_b32 m0, 34816
  s_add_u32 s12, s72, 20608
  buffer_load_dwordx4 v6, s[40:43], s12 offen lds
  s_mov_b32 m0, 35840
  s_add_u32 s12, s72, 30848
  buffer_load_dwordx4 v6, s[40:43], s12 offen lds
  s_mov_b32 m0, 36864
  s_add_u32 s12, s72, 41088
  buffer_load_dwordx4 v6, s[40:43], s12 offen lds
  s_mov_b32 m0, 37888
  s_add_u32 s12, s72, 51328
  buffer_load_dwordx4 v6, s[40:43], s12 offen lds
  s_mov_b32 m0, 38912
  s_add_u32 s12, s72, 61568
  buffer_load_dwordx4 v6, s[40:43], s12 offen lds
  s_mov_b32 m0, 39936
  s_add_u32 s12, s72, 71808
  buffer_load_dwordx4 v6, s[40:43], s12 offen lds
  s_mov_b32 m0, 40960
  s_add_u32 s12, s72, 82048
  buffer_load_dwordx4 v6, s[40:43], s12 offen lds
  s_mov_b32 m0, 41984
  s_add_u32 s12, s72, 92288
  buffer_load_dwordx4 v6, s[40:43], s12 offen lds
  s_mov_b32 m0, 43008
  s_add_u32 s12, s72, 102528
  buffer_load_dwordx4 v6, s[40:43], s12 offen lds
  s_mov_b32 m0, 44032
  s_add_u32 s12, s72, 112768
  buffer_load_dwordx4 v6, s[40:43], s12 offen lds
  s_mov_b32 m0, 45056
  s_add_u32 s12, s72, 123008
  buffer_load_dwordx4 v6, s[40:43], s12 offen lds
  s_mov_b32 m0, 46080
  s_add_u32 s12, s72, 133248
  buffer_load_dwordx4 v6, s[40:43], s12 offen lds
  s_mov_b32 m0, 47104
  s_add_u32 s12, s72, 143488
  buffer_load_dwordx4 v6, s[40:43], s12 offen lds
  s_mov_b32 m0, 48128
  s_add_u32 s12, s72, 153728
  buffer_load_dwordx4 v6, s[40:43], s12 offen lds
  s_waitcnt vmcnt(16)
  s_barrier
  s_mov_b32 m0, 65536
  s_add_u32 s12, s72, 256
  buffer_load_dwordx4 v6, s[40:43], s12 offen lds
  s_mov_b32 m0, 66560
  s_add_u32 s12, s72, 10496
  buffer_load_dwordx4 v6, s[40:43], s12 offen lds
  s_mov_b32 m0, 67584
  s_add_u32 s12, s72, 20736
  buffer_load_dwordx4 v6, s[40:43], s12 offen lds
  s_mov_b32 m0, 68608
  s_add_u32 s12, s72, 30976
  buffer_load_dwordx4 v6, s[40:43], s12 offen lds
  s_mov_b32 m0, 69632
  s_add_u32 s12, s72, 41216
  buffer_load_dwordx4 v6, s[40:43], s12 offen lds
  s_mov_b32 m0, 70656
  s_add_u32 s12, s72, 51456
  buffer_load_dwordx4 v6, s[40:43], s12 offen lds
  s_mov_b32 m0, 71680
  s_add_u32 s12, s72, 61696
  buffer_load_dwordx4 v6, s[40:43], s12 offen lds
  s_mov_b32 m0, 72704
  s_add_u32 s12, s72, 71936
  buffer_load_dwordx4 v6, s[40:43], s12 offen lds
  s_mov_b32 m0, 73728
  s_add_u32 s12, s72, 82176
  buffer_load_dwordx4 v6, s[40:43], s12 offen lds
  s_mov_b32 m0, 74752
  s_add_u32 s12, s72, 92416
  buffer_load_dwordx4 v6, s[40:43], s12 offen lds
  s_mov_b32 m0, 75776
  s_add_u32 s12, s72, 102656
  buffer_load_dwordx4 v6, s[40:43], s12 offen lds
  s_mov_b32 m0, 76800
  s_add_u32 s12, s72, 112896
  buffer_load_dwordx4 v6, s[40:43], s12 offen lds
  s_mov_b32 m0, 77824
  s_add_u32 s12, s72, 123136
  buffer_load_dwordx4 v6, s[40:43], s12 offen lds
  s_mov_b32 m0, 78848
  s_add_u32 s12, s72, 133376
  buffer_load_dwordx4 v6, s[40:43], s12 offen lds
  s_mov_b32 m0, 79872
  s_add_u32 s12, s72, 143616
  buffer_load_dwordx4 v6, s[40:43], s12 offen lds
  s_mov_b32 m0, 80896
  s_add_u32 s12, s72, 153856
  buffer_load_dwordx4 v6, s[40:43], s12 offen lds
  s_mov_b32 m0, 98304
  s_add_u32 s12, s72, 384
  buffer_load_dwordx4 v6, s[40:43], s12 offen lds
  s_mov_b32 m0, 99328
  s_add_u32 s12, s72, 10624
  buffer_load_dwordx4 v6, s[40:43], s12 offen lds
  s_mov_b32 m0, 100352
  s_add_u32 s12, s72, 20864
  buffer_load_dwordx4 v6, s[40:43], s12 offen lds
  s_mov_b32 m0, 101376
  s_add_u32 s12, s72, 31104
  buffer_load_dwordx4 v6, s[40:43], s12 offen lds
  s_mov_b32 m0, 102400
  s_add_u32 s12, s72, 41344
  buffer_load_dwordx4 v6, s[40:43], s12 offen lds
  s_mov_b32 m0, 103424
  s_add_u32 s12, s72, 51584
  buffer_load_dwordx4 v6, s[40:43], s12 offen lds
  s_mov_b32 m0, 104448
  s_add_u32 s12, s72, 61824
  buffer_load_dwordx4 v6, s[40:43], s12 offen lds
  s_mov_b32 m0, 105472
  s_add_u32 s12, s72, 72064
  buffer_load_dwordx4 v6, s[40:43], s12 offen lds
  s_mov_b32 m0, 106496
  s_add_u32 s12, s72, 82304
  buffer_load_dwordx4 v6, s[40:43], s12 offen lds
  s_mov_b32 m0, 107520
  s_add_u32 s12, s72, 92544
  buffer_load_dwordx4 v6, s[40:43], s12 offen lds
  s_mov_b32 m0, 108544
  s_add_u32 s12, s72, 102784
  buffer_load_dwordx4 v6, s[40:43], s12 offen lds
  s_mov_b32 m0, 109568
  s_add_u32 s12, s72, 113024
  buffer_load_dwordx4 v6, s[40:43], s12 offen lds
  s_mov_b32 m0, 110592
  s_add_u32 s12, s72, 123264
  buffer_load_dwordx4 v6, s[40:43], s12 offen lds
  s_mov_b32 m0, 111616
  s_add_u32 s12, s72, 133504
  buffer_load_dwordx4 v6, s[40:43], s12 offen lds
  s_mov_b32 m0, 112640
  s_add_u32 s12, s72, 143744
  buffer_load_dwordx4 v6, s[40:43], s12 offen lds
  s_mov_b32 m0, 113664
  s_add_u32 s12, s72, 153984
  buffer_load_dwordx4 v6, s[40:43], s12 offen lds
  s_mov_b32 m0, 131072
  s_add_u32 s12, s72, 512
  buffer_load_dwordx4 v6, s[40:43], s12 offen lds
  s_mov_b32 m0, 132096
  s_add_u32 s12, s72, 10752
  buffer_load_dwordx4 v6, s[40:43], s12 offen lds
  s_mov_b32 m0, 133120
  s_add_u32 s12, s72, 20992
  buffer_load_dwordx4 v6, s[40:43], s12 offen lds
  s_mov_b32 m0, 134144
  s_add_u32 s12, s72, 31232
  buffer_load_dwordx4 v6, s[40:43], s12 offen lds
  s_mov_b32 m0, 135168
  s_add_u32 s12, s72, 41472
  buffer_load_dwordx4 v6, s[40:43], s12 offen lds
  s_mov_b32 m0, 136192
  s_add_u32 s12, s72, 51712
  buffer_load_dwordx4 v6, s[40:43], s12 offen lds
  s_mov_b32 m0, 137216
  s_add_u32 s12, s72, 61952
  buffer_load_dwordx4 v6, s[40:43], s12 offen lds
  s_mov_b32 m0, 138240
  s_add_u32 s12, s72, 72192
  buffer_load_dwordx4 v6, s[40:43], s12 offen lds
  s_mov_b32 m0, 139264
  s_add_u32 s12, s72, 82432
  buffer_load_dwordx4 v6, s[40:43], s12 offen lds
  s_mov_b32 m0, 140288
  s_add_u32 s12, s72, 92672
  buffer_load_dwordx4 v6, s[40:43], s12 offen lds
  s_mov_b32 m0, 141312
  s_add_u32 s12, s72, 102912
  buffer_load_dwordx4 v6, s[40:43], s12 offen lds
  s_mov_b32 m0, 142336
  s_add_u32 s12, s72, 113152
  buffer_load_dwordx4 v6, s[40:43], s12 offen lds
  s_mov_b32 m0, 143360
  s_add_u32 s12, s72, 123392
  buffer_load_dwordx4 v6, s[40:43], s12 offen lds
  s_mov_b32 m0, 144384
  s_add_u32 s12, s72, 133632
  buffer_load_dwordx4 v6, s[40:43], s12 offen lds
  s_mov_b32 m0, 145408
  s_add_u32 s12, s72, 143872
  buffer_load_dwordx4 v6, s[40:43], s12 offen lds
  s_mov_b32 m0, 146432
  s_add_u32 s12, s72, 154112
  buffer_load_dwordx4 v6, s[40:43], s12 offen lds
  s_waitcnt vmcnt(48)
  s_barrier
  s_mov_b32 m0, 0
  s_add_u32 s12, s72, 640
  buffer_load_dwordx4 v6, s[40:43], s12 offen lds
  s_mov_b32 m0, 1024
  s_add_u32 s12, s72, 10880
  buffer_load_dwordx4 v6, s[40:43], s12 offen lds
  s_mov_b32 m0, 2048
  s_add_u32 s12, s72, 21120
  buffer_load_dwordx4 v6, s[40:43], s12 offen lds
  s_mov_b32 m0, 3072
  s_add_u32 s12, s72, 31360
  buffer_load_dwordx4 v6, s[40:43], s12 offen lds
  s_mov_b32 m0, 4096
  s_add_u32 s12, s72, 41600
  buffer_load_dwordx4 v6, s[40:43], s12 offen lds
  s_mov_b32 m0, 5120
  s_add_u32 s12, s72, 51840
  buffer_load_dwordx4 v6, s[40:43], s12 offen lds
  s_mov_b32 m0, 6144
  s_add_u32 s12, s72, 62080
  buffer_load_dwordx4 v6, s[40:43], s12 offen lds
  s_mov_b32 m0, 7168
  s_add_u32 s12, s72, 72320
  buffer_load_dwordx4 v6, s[40:43], s12 offen lds
  s_mov_b32 m0, 8192
  s_add_u32 s12, s72, 82560
  buffer_load_dwordx4 v6, s[40:43], s12 offen lds
  s_mov_b32 m0, 9216
  s_add_u32 s12, s72, 92800
  buffer_load_dwordx4 v6, s[40:43], s12 offen lds
  s_mov_b32 m0, 10240
  s_add_u32 s12, s72, 103040
  buffer_load_dwordx4 v6, s[40:43], s12 offen lds
  s_mov_b32 m0, 11264
  s_add_u32 s12, s72, 113280
  buffer_load_dwordx4 v6, s[40:43], s12 offen lds
  s_mov_b32 m0, 12288
  s_add_u32 s12, s72, 123520
  buffer_load_dwordx4 v6, s[40:43], s12 offen lds
  s_mov_b32 m0, 13312
  s_add_u32 s12, s72, 133760
  buffer_load_dwordx4 v6, s[40:43], s12 offen lds
  s_mov_b32 m0, 14336
  s_add_u32 s12, s72, 144000
  buffer_load_dwordx4 v6, s[40:43], s12 offen lds
  s_mov_b32 m0, 15360
  s_add_u32 s12, s72, 154240
  buffer_load_dwordx4 v6, s[40:43], s12 offen lds
  s_waitcnt vmcnt(48)
  s_barrier
  s_mov_b32 m0, 32768
  s_add_u32 s12, s72, 768
  buffer_load_dwordx4 v6, s[40:43], s12 offen lds
  s_mov_b32 m0, 33792
  s_add_u32 s12, s72, 11008
  buffer_load_dwordx4 v6, s[40:43], s12 offen lds
  s_mov_b32 m0, 34816
  s_add_u32 s12, s72, 21248
  buffer_load_dwordx4 v6, s[40:43], s12 offen lds
  s_mov_b32 m0, 35840
  s_add_u32 s12, s72, 31488
  buffer_load_dwordx4 v6, s[40:43], s12 offen lds
  s_mov_b32 m0, 36864
  s_add_u32 s12, s72, 41728
  buffer_load_dwordx4 v6, s[40:43], s12 offen lds
  s_mov_b32 m0, 37888
  s_add_u32 s12, s72, 51968
  buffer_load_dwordx4 v6, s[40:43], s12 offen lds
  s_mov_b32 m0, 38912
  s_add_u32 s12, s72, 62208
  buffer_load_dwordx4 v6, s[40:43], s12 offen lds
  s_mov_b32 m0, 39936
  s_add_u32 s12, s72, 72448
  buffer_load_dwordx4 v6, s[40:43], s12 offen lds
  s_mov_b32 m0, 40960
  s_add_u32 s12, s72, 82688
  buffer_load_dwordx4 v6, s[40:43], s12 offen lds
  s_mov_b32 m0, 41984
  s_add_u32 s12, s72, 92928
  buffer_load_dwordx4 v6, s[40:43], s12 offen lds
  s_mov_b32 m0, 43008
  s_add_u32 s12, s72, 103168
  buffer_load_dwordx4 v6, s[40:43], s12 offen lds
  s_mov_b32 m0, 44032
  s_add_u32 s12, s72, 113408
  buffer_load_dwordx4 v6, s[40:43], s12 offen lds
  s_mov_b32 m0, 45056
  s_add_u32 s12, s72, 123648
  buffer_load_dwordx4 v6, s[40:43], s12 offen lds
  s_mov_b32 m0, 46080
  s_add_u32 s12, s72, 133888
  buffer_load_dwordx4 v6, s[40:43], s12 offen lds
  s_mov_b32 m0, 47104
  s_add_u32 s12, s72, 144128
  buffer_load_dwordx4 v6, s[40:43], s12 offen lds
  s_mov_b32 m0, 48128
  s_add_u32 s12, s72, 154368
  buffer_load_dwordx4 v6, s[40:43], s12 offen lds
  s_waitcnt vmcnt(48)
  s_barrier
  s_mov_b32 m0, 65536
  s_add_u32 s12, s72, 896
  buffer_load_dwordx4 v6, s[40:43], s12 offen lds
  s_mov_b32 m0, 66560
  s_add_u32 s12, s72, 11136
  buffer_load_dwordx4 v6, s[40:43], s12 offen lds
  s_mov_b32 m0, 67584
  s_add_u32 s12, s72, 21376
  buffer_load_dwordx4 v6, s[40:43], s12 offen lds
  s_mov_b32 m0, 68608
  s_add_u32 s12, s72, 31616
  buffer_load_dwordx4 v6, s[40:43], s12 offen lds
  s_mov_b32 m0, 69632
  s_add_u32 s12, s72, 41856
  buffer_load_dwordx4 v6, s[40:43], s12 offen lds
  s_mov_b32 m0, 70656
  s_add_u32 s12, s72, 52096
  buffer_load_dwordx4 v6, s[40:43], s12 offen lds
  s_mov_b32 m0, 71680
  s_add_u32 s12, s72, 62336
  buffer_load_dwordx4 v6, s[40:43], s12 offen lds
  s_mov_b32 m0, 72704
  s_add_u32 s12, s72, 72576
  buffer_load_dwordx4 v6, s[40:43], s12 offen lds
  s_mov_b32 m0, 73728
  s_add_u32 s12, s72, 82816
  buffer_load_dwordx4 v6, s[40:43], s12 offen lds
  s_mov_b32 m0, 74752
  s_add_u32 s12, s72, 93056
  buffer_load_dwordx4 v6, s[40:43], s12 offen lds
  s_mov_b32 m0, 75776
  s_add_u32 s12, s72, 103296
  buffer_load_dwordx4 v6, s[40:43], s12 offen lds
  s_mov_b32 m0, 76800
  s_add_u32 s12, s72, 113536
  buffer_load_dwordx4 v6, s[40:43], s12 offen lds
  s_mov_b32 m0, 77824
  s_add_u32 s12, s72, 123776
  buffer_load_dwordx4 v6, s[40:43], s12 offen lds
  s_mov_b32 m0, 78848
  s_add_u32 s12, s72, 134016
  buffer_load_dwordx4 v6, s[40:43], s12 offen lds
  s_mov_b32 m0, 79872
  s_add_u32 s12, s72, 144256
  buffer_load_dwordx4 v6, s[40:43], s12 offen lds
  s_mov_b32 m0, 80896
  s_add_u32 s12, s72, 154496
  buffer_load_dwordx4 v6, s[40:43], s12 offen lds
  s_waitcnt vmcnt(48)
  s_barrier
  s_mov_b32 m0, 98304
  s_add_u32 s12, s72, 1024
  buffer_load_dwordx4 v6, s[40:43], s12 offen lds
  s_mov_b32 m0, 99328
  s_add_u32 s12, s72, 11264
  buffer_load_dwordx4 v6, s[40:43], s12 offen lds
  s_mov_b32 m0, 100352
  s_add_u32 s12, s72, 21504
  buffer_load_dwordx4 v6, s[40:43], s12 offen lds
  s_mov_b32 m0, 101376
  s_add_u32 s12, s72, 31744
  buffer_load_dwordx4 v6, s[40:43], s12 offen lds
  s_mov_b32 m0, 102400
  s_add_u32 s12, s72, 41984
  buffer_load_dwordx4 v6, s[40:43], s12 offen lds
  s_mov_b32 m0, 103424
  s_add_u32 s12, s72, 52224
  buffer_load_dwordx4 v6, s[40:43], s12 offen lds
  s_mov_b32 m0, 104448
  s_add_u32 s12, s72, 62464
  buffer_load_dwordx4 v6, s[40:43], s12 offen lds
  s_mov_b32 m0, 105472
  s_add_u32 s12, s72, 72704
  buffer_load_dwordx4 v6, s[40:43], s12 offen lds
  s_mov_b32 m0, 106496
  s_add_u32 s12, s72, 82944
  buffer_load_dwordx4 v6, s[40:43], s12 offen lds
  s_mov_b32 m0, 107520
  s_add_u32 s12, s72, 93184
  buffer_load_dwordx4 v6, s[40:43], s12 offen lds
  s_mov_b32 m0, 108544
  s_add_u32 s12, s72, 103424
  buffer_load_dwordx4 v6, s[40:43], s12 offen lds
  s_mov_b32 m0, 109568
  s_add_u32 s12, s72, 113664
  buffer_load_dwordx4 v6, s[40:43], s12 offen lds
  s_mov_b32 m0, 110592
  s_add_u32 s12, s72, 123904
  buffer_load_dwordx4 v6, s[40:43], s12 offen lds
  s_mov_b32 m0, 111616
  s_add_u32 s12, s72, 134144
  buffer_load_dwordx4 v6, s[40:43], s12 offen lds
  s_mov_b32 m0, 112640
  s_add_u32 s12, s72, 144384
  buffer_load_dwordx4 v6, s[40:43], s12 offen lds
  s_mov_b32 m0, 113664
  s_add_u32 s12, s72, 154624
  buffer_load_dwordx4 v6, s[40:43], s12 offen lds
  s_waitcnt vmcnt(48)
  s_barrier
  s_mov_b32 m0, 131072
  s_add_u32 s12, s72, 1152
  buffer_load_dwordx4 v6, s[40:43], s12 offen lds
  s_mov_b32 m0, 132096
  s_add_u32 s12, s72, 11392
  buffer_load_dwordx4 v6, s[40:43], s12 offen lds
  s_mov_b32 m0, 133120
  s_add_u32 s12, s72, 21632
  buffer_load_dwordx4 v6, s[40:43], s12 offen lds
  s_mov_b32 m0, 134144
  s_add_u32 s12, s72, 31872
  buffer_load_dwordx4 v6, s[40:43], s12 offen lds
  s_mov_b32 m0, 135168
  s_add_u32 s12, s72, 42112
  buffer_load_dwordx4 v6, s[40:43], s12 offen lds
  s_mov_b32 m0, 136192
  s_add_u32 s12, s72, 52352
  buffer_load_dwordx4 v6, s[40:43], s12 offen lds
  s_mov_b32 m0, 137216
  s_add_u32 s12, s72, 62592
  buffer_load_dwordx4 v6, s[40:43], s12 offen lds
  s_mov_b32 m0, 138240
  s_add_u32 s12, s72, 72832
  buffer_load_dwordx4 v6, s[40:43], s12 offen lds
  s_mov_b32 m0, 139264
  s_add_u32 s12, s72, 83072
  buffer_load_dwordx4 v6, s[40:43], s12 offen lds
  s_mov_b32 m0, 140288
  s_add_u32 s12, s72, 93312
  buffer_load_dwordx4 v6, s[40:43], s12 offen lds
  s_mov_b32 m0, 141312
  s_add_u32 s12, s72, 103552
  buffer_load_dwordx4 v6, s[40:43], s12 offen lds
  s_mov_b32 m0, 142336
  s_add_u32 s12, s72, 113792
  buffer_load_dwordx4 v6, s[40:43], s12 offen lds
  s_mov_b32 m0, 143360
  s_add_u32 s12, s72, 124032
  buffer_load_dwordx4 v6, s[40:43], s12 offen lds
  s_mov_b32 m0, 144384
  s_add_u32 s12, s72, 134272
  buffer_load_dwordx4 v6, s[40:43], s12 offen lds
  s_mov_b32 m0, 145408
  s_add_u32 s12, s72, 144512
  buffer_load_dwordx4 v6, s[40:43], s12 offen lds
  s_mov_b32 m0, 146432
  s_add_u32 s12, s72, 154752
  buffer_load_dwordx4 v6, s[40:43], s12 offen lds
  s_waitcnt vmcnt(48)
  s_barrier
  s_waitcnt vmcnt(32)
  s_barrier
  s_waitcnt vmcnt(16)
  s_barrier
  s_waitcnt vmcnt(0)
  s_barrier
  s_barrier
  s_branch L_l_p1done
L_l_B:
  s_nop 1
  s_add_u32 m0, s74, 16384
  s_add_u32 s12, s73, 0
  buffer_load_dwordx4 v7, s[44:47], s12 offen lds
  s_add_u32 m0, s74, 17408
  s_add_u32 s12, s73, 15360
  buffer_load_dwordx4 v7, s[44:47], s12 offen lds
  s_add_u32 m0, s74, 18432
  s_add_u32 s12, s73, 30720
  buffer_load_dwordx4 v8, s[44:47], s12 offen lds
  s_add_u32 m0, s74, 19456
  s_add_u32 s12, s73, 46080
  buffer_load_dwordx4 v8, s[44:47], s12 offen lds
  s_add_u32 m0, s74, 20480
  s_add_u32 s12, s73, 61440
  buffer_load_dwordx4 v7, s[44:47], s12 offen lds
  s_add_u32 m0, s74, 21504
  s_add_u32 s12, s73, 76800
  buffer_load_dwordx4 v7, s[44:47], s12 offen lds
  s_add_u32 m0, s74, 22528
  s_add_u32 s12, s73, 92160
  buffer_load_dwordx4 v8, s[44:47], s12 offen lds
  s_add_u32 m0, s74, 23552
  s_add_u32 s12, s73, 107520
  buffer_load_dwordx4 v8, s[44:47], s12 offen lds
  s_add_u32 m0, s74, 49152
  s_add_u32 s12, s73, 245760
  buffer_load_dwordx4 v7, s[44:47], s12 offen lds
  s_add_u32 m0, s74, 50176
  s_add_u32 s12, s73, 261120
  buffer_load_dwordx4 v7, s[44:47], s12 offen lds
  s_add_u32 m0, s74, 51200
  s_add_u32 s12, s73, 276480
  buffer_load_dwordx4 v8, s[44:47], s12 offen lds
  s_add_u32 m0, s74, 52224
  s_add_u32 s12, s73, 291840
  buffer_load_dwordx4 v8, s[44:47], s12 offen lds
  s_add_u32 m0, s74, 53248
  s_add_u32 s12, s73, 307200
  buffer_load_dwordx4 v7, s[44:47], s12 offen lds
  s_add_u32 m0, s74, 54272
  s_add_u32 s12, s73, 322560
  buffer_load_dwordx4 v7, s[44:47], s12 offen lds
  s_add_u32 m0, s74, 55296
  s_add_u32 s12, s73, 337920
  buffer_load_dwordx4 v8, s[44:47], s12 offen lds
  s_add_u32 m0, s74, 56320
  s_add_u32 s12, s73, 353280
  buffer_load_dwordx4 v8, s[44:47], s12 offen lds
  s_waitcnt vmcnt(8)
  s_barrier
  s_add_u32 m0, s74, 81920
  s_add_u32 s12, s73, 491520
  buffer_load_dwordx4 v7, s[44:47], s12 offen lds
  s_add_u32 m0, s74, 82944
  s_add_u32 s12, s73, 506880
  buffer_load_dwordx4 v7, s[44:47], s12 offen lds
  s_add_u32 m0, s74, 83968
  s_add_u32 s12, s73, 522240
  buffer_load_dwordx4 v8, s[44:47], s12 offen lds
  s_add_u32 m0, s74, 84992
  s_add_u32 s12, s73, 537600
  buffer_load_dwordx4 v8, s[44:47], s12 offen lds
  s_add_u32 m0, s74, 86016
  s_add_u32 s12, s73, 552960
  buffer_load_dwordx4 v7, s[44:47], s12 offen lds
  s_add_u32 m0, s74, 87040
  s_add_u32 s12, s73, 568320
  buffer_load_dwordx4 v7, s[44:47], s12 offen lds
  s_add_u32 m0, s74, 88064
  s_add_u32 s12, s73, 583680
  buffer_load_dwordx4 v8, s[44:47], s12 offen lds
  s_add_u32 m0, s74, 89088
  s_add_u32 s12, s73, 599040
  buffer_load_dwordx4 v8, s[44:47], s12 offen lds
  s_add_u32 m0, s74, 114688
  s_add_u32 s12, s73, 737280
  buffer_load_dwordx4 v7, s[44:47], s12 offen lds
  s_add_u32 m0, s74, 115712
  s_add_u32 s12, s73, 752640
  buffer_load_dwordx4 v7, s[44:47], s12 offen lds
  s_add_u32 m0, s74, 116736
  s_add_u32 s12, s73, 768000
  buffer_load_dwordx4 v8, s[44:47], s12 offen lds
  s_add_u32 m0, s74, 117760
  s_add_u32 s12, s73, 783360
  buffer_load_dwordx4 v8, s[44:47], s12 offen lds
  s_add_u32 m0, s74, 118784
  s_add_u32 s12, s73, 798720
  buffer_load_dwordx4 v7, s[44:47], s12 offen lds
  s_add_u32 m0, s74, 119808
  s_add_u32 s12, s73, 814080
  buffer_load_dwordx4 v7, s[44:47], s12 offen lds
  s_add_u32 m0, s74, 120832
  s_add_u32 s12, s73, 829440
  buffer_load_dwordx4 v8, s[44:47], s12 offen lds
  s_add_u32 m0, s74, 121856
  s_add_u32 s12, s73, 844800
  buffer_load_dwordx4 v8, s[44:47], s12 offen lds
  s_add_u32 m0, s74, 147456
  s_add_u32 s12, s73, 983040
  buffer_load_dwordx4 v7, s[44:47], s12 offen lds
  s_add_u32 m0, s74, 148480
  s_add_u32 s12, s73, 998400
  buffer_load_dwordx4 v7, s[44:47], s12 offen lds
  s_add_u32 m0, s74, 149504
  s_add_u32 s12, s73, 1013760
  buffer_load_dwordx4 v8, s[44:47], s12 offen lds
  s_add_u32 m0, s74, 150528
  s_add_u32 s12, s73, 1029120
  buffer_load_dwordx4 v8, s[44:47], s12 offen lds
  s_add_u32 m0, s74, 151552
  s_add_u32 s12, s73, 1044480
  buffer_load_dwordx4 v7, s[44:47], s12 offen lds
  s_add_u32 m0, s74, 152576
  s_add_u32 s12, s73, 1059840
  buffer_load_dwordx4 v7, s[44:47], s12 offen lds
  s_add_u32 m0, s74, 153600
  s_add_u32 s12, s73, 1075200
  buffer_load_dwordx4 v8, s[44:47], s12 offen lds
  s_add_u32 m0, s74, 154624
  s_add_u32 s12, s73, 1090560
  buffer_load_dwordx4 v8, s[44:47], s12 offen lds
  s_waitcnt vmcnt(24)
  s_barrier
  s_add_u32 m0, s74, 16384
  s_add_u32 s12, s73, 1228800
  buffer_load_dwordx4 v7, s[44:47], s12 offen lds
  s_add_u32 m0, s74, 17408
  s_add_u32 s12, s73, 1244160
  buffer_load_dwordx4 v7, s[44:47], s12 offen lds
  s_add_u32 m0, s74, 18432
  s_add_u32 s12, s73, 1259520
  buffer_load_dwordx4 v8, s[44:47], s12 offen lds
  s_add_u32 m0, s74, 19456
  s_add_u32 s12, s73, 1274880
  buffer_load_dwordx4 v8, s[44:47], s12 offen lds
  s_add_u32 m0, s74, 20480
  s_add_u32 s12, s73, 1290240
  buffer_load_dwordx4 v7, s[44:47], s12 offen lds
  s_add_u32 m0, s74, 21504
  s_add_u32 s12, s73, 1305600
  buffer_load_dwordx4 v7, s[44:47], s12 offen lds
  s_add_u32 m0, s74, 22528
  s_add_u32 s12, s73, 1320960
  buffer_load_dwordx4 v8, s[44:47], s12 offen lds
  s_add_u32 m0, s74, 23552
  s_add_u32 s12, s73, 1336320
  buffer_load_dwordx4 v8, s[44:47], s12 offen lds
  s_waitcnt vmcnt(24)
  s_barrier
  s_add_u32 m0, s74, 49152
  s_add_u32 s12, s73, 1474560
  buffer_load_dwordx4 v7, s[44:47], s12 offen lds
  s_add_u32 m0, s74, 50176
  s_add_u32 s12, s73, 1489920
  buffer_load_dwordx4 v7, s[44:47], s12 offen lds
  s_add_u32 m0, s74, 51200
  s_add_u32 s12, s73, 1505280
  buffer_load_dwordx4 v8, s[44:47], s12 offen lds
  s_add_u32 m0, s74, 52224
  s_add_u32 s12, s73, 1520640
  buffer_load_dwordx4 v8, s[44:47], s12 offen lds
  s_add_u32 m0, s74, 53248
  s_add_u32 s12, s73, 1536000
  buffer_load_dwordx4 v7, s[44:47], s12 offen lds
  s_add_u32 m0, s74, 54272
  s_add_u32 s12, s73, 1551360
  buffer_load_dwordx4 v7, s[44:47], s12 offen lds
  s_add_u32 m0, s74, 55296
  s_add_u32 s12, s73, 1566720
  buffer_load_dwordx4 v8, s[44:47], s12 offen lds
  s_add_u32 m0, s74, 56320
  s_add_u32 s12, s73, 1582080
  buffer_load_dwordx4 v8, s[44:47], s12 offen lds
  s_waitcnt vmcnt(24)
  s_barrier
  s_add_u32 m0, s74, 81920
  s_add_u32 s12, s73, 1720320
  buffer_load_dwordx4 v7, s[44:47], s12 offen lds
  s_add_u32 m0, s74, 82944
  s_add_u32 s12, s73, 1735680
  buffer_load_dwordx4 v7, s[44:47], s12 offen lds
  s_add_u32 m0, s74, 83968
  s_add_u32 s12, s73, 1751040
  buffer_load_dwordx4 v8, s[44:47], s12 offen lds
  s_add_u32 m0, s74, 84992
  s_add_u32 s12, s73, 1766400
  buffer_load_dwordx4 v8, s[44:47], s12 offen lds
  s_add_u32 m0, s74, 86016
  s_add_u32 s12, s73, 1781760
  buffer_load_dwordx4 v7, s[44:47], s12 offen lds
  s_add_u32 m0, s74, 87040
  s_add_u32 s12, s73, 1797120
  buffer_load_dwordx4 v7, s[44:47], s12 offen lds
  s_add_u32 m0, s74, 88064
  s_add_u32 s12, s73, 1812480
  buffer_load_dwordx4 v8, s[44:47], s12 offen lds
  s_add_u32 m0, s74, 89088
  s_add_u32 s12, s73, 1827840
  buffer_load_dwordx4 v8, s[44:47], s12 offen lds
  s_waitcnt vmcnt(24)
  s_barrier
  s_add_u32 m0, s74, 114688
  s_add_u32 s12, s73, 1966080
  buffer_load_dwordx4 v7, s[44:47], s12 offen lds
  s_add_u32 m0, s74, 115712
  s_add_u32 s12, s73, 1981440
  buffer_load_dwordx4 v7, s[44:47], s12 offen lds
  s_add_u32 m0, s74, 116736
  s_add_u32 s12, s73, 1996800
  buffer_load_dwordx4 v8, s[44:47], s12 offen lds
  s_add_u32 m0, s74, 117760
  s_add_u32 s12, s73, 2012160
  buffer_load_dwordx4 v8, s[44:47], s12 offen lds
  s_add_u32 m0, s74, 118784
  s_add_u32 s12, s73, 2027520
  buffer_load_dwordx4 v7, s[44:47], s12 offen lds
  s_add_u32 m0, s74, 119808
  s_add_u32 s12, s73, 2042880
  buffer_load_dwordx4 v7, s[44:47], s12 offen lds
  s_add_u32 m0, s74, 120832
  s_add_u32 s12, s73, 2058240
  buffer_load_dwordx4 v8, s[44:47], s12 offen lds
  s_add_u32 m0, s74, 121856
  s_add_u32 s12, s73, 2073600
  buffer_load_dwordx4 v8, s[44:47], s12 offen lds
  s_waitcnt vmcnt(24)
  s_barrier
  s_add_u32 m0, s74, 147456
  s_add_u32 s12, s73, 2211840
  buffer_load_dwordx4 v7, s[44:47], s12 offen lds
  s_add_u32 m0, s74, 148480
  s_add_u32 s12, s73, 2227200
  buffer_load_dwordx4 v7, s[44:47], s12 offen lds
  s_add_u32 m0, s74, 149504
  s_add_u32 s12, s73, 2242560
  buffer_load_dwordx4 v8, s[44:47], s12 offen lds
  s_add_u32 m0, s74, 150528
  s_add_u32 s12, s73, 2257920
  buffer_load_dwordx4 v8, s[44:47], s12 offen lds
  s_add_u32 m0, s74, 151552
  s_add_u32 s12, s73, 2273280
  buffer_load_dwordx4 v7, s[44:47], s12 offen lds
  s_add_u32 m0, s74, 152576
  s_add_u32 s12, s73, 2288640
  buffer_load_dwordx4 v7, s[44:47], s12 offen lds
  s_add_u32 m0, s74, 153600
  s_add_u32 s12, s73, 2304000
  buffer_load_dwordx4 v8, s[44:47], s12 offen lds
  s_add_u32 m0, s74, 154624
  s_add_u32 s12, s73, 2319360
  buffer_load_dwordx4 v8, s[44:47], s12 offen lds
  s_waitcnt vmcnt(24)
  s_barrier
  s_waitcnt vmcnt(16)
  s_barrier
  s_waitcnt vmcnt(8)
  s_barrier
  s_waitcnt vmcnt(0)
  s_barrier
  s_barrier
L_l_p1done:
  s_nop 1
  s_barrier
  s_branch L_l_join
L_l_spare:
  s_nop 1
  s_barrier
  s_barrier
  s_barrier
  s_barrier
L_l_join:
  s_nop 1
  v_mov_b32 v15, 2560
  ds_read_b32 v13, v15
  s_and_b32 s84, s5, 7
  s_mul_i32 s84, s84, 102400
  s_add_u32 s84, s84, 25165824
  s_waitcnt lgkmcnt(0)
  v_readfirstlane_b32 s94, v13
  s_nop 1
  s_bitcmp1_b32 s94, 1
  s_cbranch_scc0 L_wo_174
  s_lshl_b32 s12, s95, 10
  s_add_u32 s13, s12, s84
  s_add_u32 s13, s13, 52224
  s_add_u32 m0, s12, 64512
  s_nop 0
  buffer_load_dwordx4 v2, s[48:51], s13 offen sc1 lds
  s_add_u32 s13, s13, 3072
  s_add_u32 m0, s12, 67584
  s_nop 0
  buffer_load_dwordx4 v2, s[48:51], s13 offen sc1 lds
  s_add_u32 s13, s13, 3072
  s_add_u32 m0, s12, 70656
  s_nop 0
  buffer_load_dwordx4 v2, s[48:51], s13 offen sc1 lds
  s_add_u32 s13, s13, 3072
  s_add_u32 m0, s12, 73728
  s_nop 0
  buffer_load_dwordx4 v2, s[48:51], s13 offen sc1 lds
  s_add_u32 s13, s13, 3072
  s_add_u32 m0, s12, 76800
  s_nop 0
  buffer_load_dwordx4 v2, s[48:51], s13 offen sc1 lds
  s_add_u32 s13, s13, 3072
  s_add_u32 m0, s12, 79872
  s_nop 0
  buffer_load_dwordx4 v2, s[48:51], s13 offen sc1 lds
  s_add_u32 s13, s13, 3072
  s_add_u32 m0, s12, 82944
  s_nop 0
  buffer_load_dwordx4 v2, s[48:51], s13 offen sc1 lds
  s_add_u32 s13, s13, 3072
  s_add_u32 m0, s12, 86016
  s_nop 0
  buffer_load_dwordx4 v2, s[48:51], s13 offen sc1 lds
  s_add_u32 s13, s13, 3072
  s_add_u32 m0, s12, 89088
  s_nop 0
  buffer_load_dwordx4 v2, s[48:51], s13 offen sc1 lds
  s_add_u32 s13, s13, 3072
  s_add_u32 m0, s12, 92160
  s_nop 0
  buffer_load_dwordx4 v2, s[48:51], s13 offen sc1 lds
  s_add_u32 s13, s13, 3072
  s_add_u32 m0, s12, 95232
  s_nop 0
  buffer_load_dwordx4 v2, s[48:51], s13 offen sc1 lds
  s_add_u32 s13, s13, 3072
  s_add_u32 m0, s12, 98304
  s_nop 0
  buffer_load_dwordx4 v2, s[48:51], s13 offen sc1 lds
  s_add_u32 s13, s13, 3072
  s_add_u32 m0, s12, 101376
  s_nop 0
  buffer_load_dwordx4 v2, s[48:51], s13 offen sc1 lds
  s_add_u32 s13, s13, 3072
  s_add_u32 m0, s12, 104448
  s_nop 0
  buffer_load_dwordx4 v2, s[48:51], s13 offen sc1 lds
  s_add_u32 s13, s13, 3072
  s_add_u32 m0, s12, 107520
  s_nop 0
  buffer_load_dwordx4 v2, s[48:51], s13 offen sc1 lds
  s_add_u32 s13, s13, 3072
  s_add_u32 m0, s12, 110592
  s_nop 0
  buffer_load_dwordx4 v2, s[48:51], s13 offen sc1 lds
  s_add_u32 s13, s13, 3072
  s_cmp_ge_u32 s95, 1
  s_cbranch_scc1 L_bd_175
  s_add_u32 m0, s12, 113664
  s_nop 0
  buffer_load_dwordx4 v2, s[48:51], s13 offen sc1 lds
L_bd_175:
L_wo_174:
  s_barrier
  s_barrier
  s_barrier
  s_barrier
  s_bitcmp1_b32 s94, 1
  s_cbranch_scc1 L_wo_176
  s_lshl_b32 s12, s95, 10
  s_add_u32 s13, s12, s84
  s_add_u32 s13, s13, 52224
  s_add_u32 m0, s12, 64512
  s_nop 0
  buffer_load_dwordx4 v2, s[48:51], s13 offen sc1 lds
  s_add_u32 s13, s13, 3072
  s_add_u32 m0, s12, 67584
  s_nop 0
  buffer_load_dwordx4 v2, s[48:51], s13 offen sc1 lds
  s_add_u32 s13, s13, 3072
  s_add_u32 m0, s12, 70656
  s_nop 0
  buffer_load_dwordx4 v2, s[48:51], s13 offen sc1 lds
  s_add_u32 s13, s13, 3072
  s_add_u32 m0, s12, 73728
  s_nop 0
  buffer_load_dwordx4 v2, s[48:51], s13 offen sc1 lds
  s_add_u32 s13, s13, 3072
  s_add_u32 m0, s12, 76800
  s_nop 0
  buffer_load_dwordx4 v2, s[48:51], s13 offen sc1 lds
  s_add_u32 s13, s13, 3072
  s_add_u32 m0, s12, 79872
  s_nop 0
  buffer_load_dwordx4 v2, s[48:51], s13 offen sc1 lds
  s_add_u32 s13, s13, 3072
  s_add_u32 m0, s12, 82944
  s_nop 0
  buffer_load_dwordx4 v2, s[48:51], s13 offen sc1 lds
  s_add_u32 s13, s13, 3072
  s_add_u32 m0, s12, 86016
  s_nop 0
  buffer_load_dwordx4 v2, s[48:51], s13 offen sc1 lds
  s_add_u32 s13, s13, 3072
  s_add_u32 m0, s12, 89088
  s_nop 0
  buffer_load_dwordx4 v2, s[48:51], s13 offen sc1 lds
  s_add_u32 s13, s13, 3072
  s_add_u32 m0, s12, 92160
  s_nop 0
  buffer_load_dwordx4 v2, s[48:51], s13 offen sc1 lds
  s_add_u32 s13, s13, 3072
  s_add_u32 m0, s12, 95232
  s_nop 0
  buffer_load_dwordx4 v2, s[48:51], s13 offen sc1 lds
  s_add_u32 s13, s13, 3072
  s_add_u32 m0, s12, 98304
  s_nop 0
  buffer_load_dwordx4 v2, s[48:51], s13 offen sc1 lds
  s_add_u32 s13, s13, 3072
  s_add_u32 m0, s12, 101376
  s_nop 0
  buffer_load_dwordx4 v2, s[48:51], s13 offen sc1 lds
  s_add_u32 s13, s13, 3072
  s_add_u32 m0, s12, 104448
  s_nop 0
  buffer_load_dwordx4 v2, s[48:51], s13 offen sc1 lds
  s_add_u32 s13, s13, 3072
  s_add_u32 m0, s12, 107520
  s_nop 0
  buffer_load_dwordx4 v2, s[48:51], s13 offen sc1 lds
  s_add_u32 s13, s13, 3072
  s_add_u32 m0, s12, 110592
  s_nop 0
  buffer_load_dwordx4 v2, s[48:51], s13 offen sc1 lds
  s_add_u32 s13, s13, 3072
  s_cmp_ge_u32 s95, 1
  s_cbranch_scc1 L_bd_177
  s_add_u32 m0, s12, 113664
  s_nop 0
  buffer_load_dwordx4 v2, s[48:51], s13 offen sc1 lds
L_bd_177:
L_wo_176:
  s_lshl_b32 s12, s95, 10
  s_add_u32 s13, s12, s84
  s_add_u32 m0, s12, 12288
  s_nop 0
  buffer_load_dwordx4 v2, s[48:51], s13 offen sc1 lds
  s_add_u32 s13, s13, 3072
  s_add_u32 m0, s12, 15360
  s_nop 0
  buffer_load_dwordx4 v2, s[48:51], s13 offen sc1 lds
  s_add_u32 s13, s13, 3072
  s_add_u32 m0, s12, 18432
  s_nop 0
  buffer_load_dwordx4 v2, s[48:51], s13 offen sc1 lds
  s_add_u32 s13, s13, 3072
  s_add_u32 m0, s12, 21504
  s_nop 0
  buffer_load_dwordx4 v2, s[48:51], s13 offen sc1 lds
  s_add_u32 s13, s13, 3072
  s_add_u32 m0, s12, 24576
  s_nop 0
  buffer_load_dwordx4 v2, s[48:51], s13 offen sc1 lds
  s_add_u32 s13, s13, 3072
  s_add_u32 m0, s12, 27648
  s_nop 0
  buffer_load_dwordx4 v2, s[48:51], s13 offen sc1 lds
  s_add_u32 s13, s13, 3072
  s_add_u32 m0, s12, 30720
  s_nop 0
  buffer_load_dwordx4 v2, s[48:51], s13 offen sc1 lds
  s_add_u32 s13, s13, 3072
  s_add_u32 m0, s12, 33792
  s_nop 0
  buffer_load_dwordx4 v2, s[48:51], s13 offen sc1 lds
  s_add_u32 s13, s13, 3072
  s_add_u32 m0, s12, 36864
  s_nop 0
  buffer_load_dwordx4 v2, s[48:51], s13 offen sc1 lds
  s_add_u32 s13, s13, 3072
  s_add_u32 m0, s12, 39936
  s_nop 0
  buffer_load_dwordx4 v2, s[48:51], s13 offen sc1 lds
  s_add_u32 s13, s13, 3072
  s_add_u32 m0, s12, 43008
  s_nop 0
  buffer_load_dwordx4 v2, s[48:51], s13 offen sc1 lds
  s_add_u32 s13, s13, 3072
  s_add_u32 m0, s12, 46080
  s_nop 0
  buffer_load_dwordx4 v2, s[48:51], s13 offen sc1 lds
  s_add_u32 s13, s13, 3072
  s_add_u32 m0, s12, 49152
  s_nop 0
  buffer_load_dwordx4 v2, s[48:51], s13 offen sc1 lds
  s_add_u32 s13, s13, 3072
  s_add_u32 m0, s12, 52224
  s_nop 0
  buffer_load_dwordx4 v2, s[48:51], s13 offen sc1 lds
  s_add_u32 s13, s13, 3072
  s_add_u32 m0, s12, 55296
  s_nop 0
  buffer_load_dwordx4 v2, s[48:51], s13 offen sc1 lds
  s_add_u32 s13, s13, 3072
  s_add_u32 m0, s12, 58368
  s_nop 0
  buffer_load_dwordx4 v2, s[48:51], s13 offen sc1 lds
  s_add_u32 s13, s13, 3072
  s_add_u32 m0, s12, 61440
  s_nop 0
  buffer_load_dwordx4 v2, s[48:51], s13 offen sc1 lds
  s_mul_i32 s84, s7, 122880
  s_add_u32 s84, s84, 26214400
  s_barrier
  s_barrier
  s_lshl_b32 s12, s95, 10
  s_add_u32 s13, s12, s84
  s_add_u32 m0, s12, 114688
  s_nop 0
  buffer_load_dwordx4 v2, s[48:51], s13 offen sc1 lds
  s_add_u32 s13, s13, 3072
  s_add_u32 m0, s12, 117760
  s_nop 0
  buffer_load_dwordx4 v2, s[48:51], s13 offen sc1 lds
  s_add_u32 s13, s13, 3072
  s_add_u32 m0, s12, 120832
  s_nop 0
  buffer_load_dwordx4 v2, s[48:51], s13 offen sc1 lds
  s_add_u32 s13, s13, 3072
  s_add_u32 m0, s12, 123904
  s_nop 0
  buffer_load_dwordx4 v2, s[48:51], s13 offen sc1 lds
  s_add_u32 s13, s13, 3072
  s_add_u32 m0, s12, 126976
  s_nop 0
  buffer_load_dwordx4 v2, s[48:51], s13 offen sc1 lds
  s_add_u32 s13, s13, 3072
  s_add_u32 m0, s12, 130048
  s_nop 0
  buffer_load_dwordx4 v2, s[48:51], s13 offen sc1 lds
  s_add_u32 s13, s13, 3072
  s_add_u32 m0, s12, 133120
  s_nop 0
  buffer_load_dwordx4 v2, s[48:51], s13 offen sc1 lds
  s_add_u32 s13, s13, 3072
  s_add_u32 m0, s12, 136192
  s_nop 0
  buffer_load_dwordx4 v2, s[48:51], s13 offen sc1 lds
  s_add_u32 s13, s13, 3072
  s_add_u32 m0, s12, 139264
  s_nop 0
  buffer_load_dwordx4 v2, s[48:51], s13 offen sc1 lds
  s_add_u32 s13, s13, 3072
  s_add_u32 m0, s12, 142336
  s_nop 0
  buffer_load_dwordx4 v2, s[48:51], s13 offen sc1 lds
  s_add_u32 s13, s13, 3072
  s_add_u32 m0, s12, 145408
  s_nop 0
  buffer_load_dwordx4 v2, s[48:51], s13 offen sc1 lds
  s_add_u32 s13, s13, 3072
  s_add_u32 m0, s12, 148480
  s_nop 0
  buffer_load_dwordx4 v2, s[48:51], s13 offen sc1 lds
  s_add_u32 s13, s13, 3072
  s_add_u32 m0, s12, 151552
  s_nop 0
  buffer_load_dwordx4 v2, s[48:51], s13 offen sc1 lds
  s_add_u32 s13, s13, 3072
  s_add_u32 m0, s12, 154624
  s_nop 0
  buffer_load_dwordx4 v2, s[48:51], s13 offen sc1 lds
  s_add_u32 s13, s13, 3072
  s_add_u32 m0, s12, 157696
  s_nop 0
  buffer_load_dwordx4 v2, s[48:51], s13 offen sc1 lds
  s_add_u32 s13, s13, 3072
  s_add_u32 m0, s12, 160768
  s_nop 0
  buffer_load_dwordx4 v2, s[48:51], s13 offen sc1 lds
  s_barrier
  s_waitcnt vmcnt(0)
  s_barrier
  s_barrier
  s_barrier
  s_lshl_b32 s12, s95, 10
  s_add_u32 s13, s12, s84
  s_add_u32 s13, s13, 49152
  s_add_u32 m0, s12, 0
  s_nop 0
  buffer_load_dwordx4 v2, s[48:51], s13 offen sc1 lds
  s_add_u32 s13, s13, 3072
  s_add_u32 m0, s12, 3072
  s_nop 0
  buffer_load_dwordx4 v2, s[48:51], s13 offen sc1 lds
  s_add_u32 s13, s13, 3072
  s_add_u32 m0, s12, 6144
  s_nop 0
  buffer_load_dwordx4 v2, s[48:51], s13 offen sc1 lds
  s_add_u32 s13, s13, 3072
  s_add_u32 m0, s12, 9216
  s_nop 0
  buffer_load_dwordx4 v2, s[48:51], s13 offen sc1 lds
  s_add_u32 s13, s13, 3072
  s_add_u32 m0, s12, 12288
  s_nop 0
  buffer_load_dwordx4 v2, s[48:51], s13 offen sc1 lds
  s_add_u32 s13, s13, 3072
  s_add_u32 m0, s12, 15360
  s_nop 0
  buffer_load_dwordx4 v2, s[48:51], s13 offen sc1 lds
  s_add_u32 s13, s13, 3072
  s_add_u32 m0, s12, 18432
  s_nop 0
  buffer_load_dwordx4 v2, s[48:51], s13 offen sc1 lds
  s_add_u32 s13, s13, 3072
  s_add_u32 m0, s12, 21504
  s_nop 0
  buffer_load_dwordx4 v2, s[48:51], s13 offen sc1 lds
  s_add_u32 s13, s13, 3072
  s_add_u32 m0, s12, 24576
  s_nop 0
  buffer_load_dwordx4 v2, s[48:51], s13 offen sc1 lds
  s_add_u32 s13, s13, 3072
  s_add_u32 m0, s12, 27648
  s_nop 0
  buffer_load_dwordx4 v2, s[48:51], s13 offen sc1 lds
  s_add_u32 s13, s13, 3072
  s_add_u32 m0, s12, 30720
  s_nop 0
  buffer_load_dwordx4 v2, s[48:51], s13 offen sc1 lds
  s_add_u32 s13, s13, 3072
  s_add_u32 m0, s12, 33792
  s_nop 0
  buffer_load_dwordx4 v2, s[48:51], s13 offen sc1 lds
  s_add_u32 s13, s13, 3072
  s_add_u32 m0, s12, 36864
  s_nop 0
  buffer_load_dwordx4 v2, s[48:51], s13 offen sc1 lds
  s_add_u32 s13, s13, 3072
  s_add_u32 m0, s12, 39936
  s_nop 0
  buffer_load_dwordx4 v2, s[48:51], s13 offen sc1 lds
  s_add_u32 s13, s13, 3072
  s_add_u32 m0, s12, 43008
  s_nop 0
  buffer_load_dwordx4 v2, s[48:51], s13 offen sc1 lds
  s_add_u32 s13, s13, 3072
  s_add_u32 m0, s12, 46080
  s_nop 0
  buffer_load_dwordx4 v2, s[48:51], s13 offen sc1 lds
  s_add_u32 s13, s13, 3072
  s_add_u32 m0, s12, 49152
  s_nop 0
  buffer_load_dwordx4 v2, s[48:51], s13 offen sc1 lds
  s_add_u32 s13, s13, 3072
  s_add_u32 m0, s12, 52224
  s_nop 0
  buffer_load_dwordx4 v2, s[48:51], s13 offen sc1 lds
  s_add_u32 s13, s13, 3072
  s_add_u32 m0, s12, 55296
  s_nop 0
  buffer_load_dwordx4 v2, s[48:51], s13 offen sc1 lds
  s_add_u32 s13, s13, 3072
  s_add_u32 m0, s12, 58368
  s_nop 0
  buffer_load_dwordx4 v2, s[48:51], s13 offen sc1 lds
  s_add_u32 s13, s13, 3072
  s_add_u32 m0, s12, 61440
  s_nop 0
  buffer_load_dwordx4 v2, s[48:51], s13 offen sc1 lds
  s_add_u32 s13, s13, 3072
  s_add_u32 m0, s12, 64512
  s_nop 0
  buffer_load_dwordx4 v2, s[48:51], s13 offen sc1 lds
  s_add_u32 s13, s13, 3072
  s_add_u32 m0, s12, 67584
  s_nop 0
  buffer_load_dwordx4 v2, s[48:51], s13 offen sc1 lds
  s_add_u32 s13, s13, 3072
  s_add_u32 m0, s12, 70656
  s_nop 0
  buffer_load_dwordx4 v2, s[48:51], s13 offen sc1 lds
  s_barrier
  s_waitcnt vmcnt(0)
  s_barrier
  s_and_b32 s84, s5, 7
  s_mul_i32 s84, s84, 245760
  s_add_u32 s84, s84, 29360128
  s_barrier
  s_lshl_b32 s12, s95, 10
  s_add_u32 s13, s12, s84
  s_add_u32 m0, s12, 81920
  s_nop 0
  buffer_load_dwordx4 v2, s[48:51], s13 offen sc1 lds
  s_add_u32 s13, s13, 3072
  s_add_u32 m0, s12, 84992
  s_nop 0
  buffer_load_dwordx4 v2, s[48:51], s13 offen sc1 lds
  s_add_u32 s13, s13, 3072
  s_add_u32 m0, s12, 88064
  s_nop 0
  buffer_load_dwordx4 v2, s[48:51], s13 offen sc1 lds
  s_add_u32 s13, s13, 3072
  s_add_u32 m0, s12, 91136
  s_nop 0
  buffer_load_dwordx4 v2, s[48:51], s13 offen sc1 lds
  s_add_u32 s13, s13, 3072
  s_add_u32 m0, s12, 94208
  s_nop 0
  buffer_load_dwordx4 v2, s[48:51], s13 offen sc1 lds
  s_add_u32 s13, s13, 3072
  s_add_u32 m0, s12, 97280
  s_nop 0
  buffer_load_dwordx4 v2, s[48:51], s13 offen sc1 lds
  s_add_u32 s13, s13, 3072
  s_cmp_ge_u32 s95, 2
  s_cbranch_scc1 L_bd_178
  s_add_u32 m0, s12, 100352
  s_nop 0
  buffer_load_dwordx4 v2, s[48:51], s13 offen sc1 lds
L_bd_178:
  s_barrier
  s_barrier
  s_lshl_b32 s12, s95, 10
  s_add_u32 s13, s12, s84
  s_add_u32 s13, s13, 20480
  s_add_u32 m0, s12, 0
  s_nop 0
  buffer_load_dwordx4 v2, s[48:51], s13 offen sc1 lds
  s_add_u32 s13, s13, 3072
  s_add_u32 m0, s12, 3072
  s_nop 0
  buffer_load_dwordx4 v2, s[48:51], s13 offen sc1 lds
  s_add_u32 s13, s13, 3072
  s_add_u32 m0, s12, 6144
  s_nop 0
  buffer_load_dwordx4 v2, s[48:51], s13 offen sc1 lds
  s_add_u32 s13, s13, 3072
  s_add_u32 m0, s12, 9216
  s_nop 0
  buffer_load_dwordx4 v2, s[48:51], s13 offen sc1 lds
  s_add_u32 s13, s13, 3072
  s_add_u32 m0, s12, 12288
  s_nop 0
  buffer_load_dwordx4 v2, s[48:51], s13 offen sc1 lds
  s_add_u32 s13, s13, 3072
  s_add_u32 m0, s12, 15360
  s_nop 0
  buffer_load_dwordx4 v2, s[48:51], s13 offen sc1 lds
  s_add_u32 s13, s13, 3072
  s_add_u32 m0, s12, 18432
  s_nop 0
  buffer_load_dwordx4 v2, s[48:51], s13 offen sc1 lds
  s_add_u32 s13, s13, 3072
  s_add_u32 m0, s12, 21504
  s_nop 0
  buffer_load_dwordx4 v2, s[48:51], s13 offen sc1 lds
  s_add_u32 s13, s13, 3072
  s_add_u32 m0, s12, 24576
  s_nop 0
  buffer_load_dwordx4 v2, s[48:51], s13 offen sc1 lds
  s_add_u32 s13, s13, 3072
  s_add_u32 m0, s12, 27648
  s_nop 0
  buffer_load_dwordx4 v2, s[48:51], s13 offen sc1 lds
  s_add_u32 s13, s13, 3072
  s_add_u32 m0, s12, 30720
  s_nop 0
  buffer_load_dwordx4 v2, s[48:51], s13 offen sc1 lds
  s_add_u32 s13, s13, 3072
  s_add_u32 m0, s12, 33792
  s_nop 0
  buffer_load_dwordx4 v2, s[48:51], s13 offen sc1 lds
  s_add_u32 s13, s13, 3072
  s_add_u32 m0, s12, 36864
  s_nop 0
  buffer_load_dwordx4 v2, s[48:51], s13 offen sc1 lds
  s_add_u32 s13, s13, 3072
  s_add_u32 m0, s12, 39936
  s_nop 0
  buffer_load_dwordx4 v2, s[48:51], s13 offen sc1 lds
  s_add_u32 s13, s13, 3072
  s_add_u32 m0, s12, 43008
  s_nop 0
  buffer_load_dwordx4 v2, s[48:51], s13 offen sc1 lds
  s_add_u32 s13, s13, 3072
  s_add_u32 m0, s12, 46080
  s_nop 0
  buffer_load_dwordx4 v2, s[48:51], s13 offen sc1 lds
  s_add_u32 s13, s13, 3072
  s_add_u32 m0, s12, 49152
  s_nop 0
  buffer_load_dwordx4 v2, s[48:51], s13 offen sc1 lds
  s_add_u32 s13, s13, 3072
  s_add_u32 m0, s12, 52224
  s_nop 0
  buffer_load_dwordx4 v2, s[48:51], s13 offen sc1 lds
  s_add_u32 s13, s13, 3072
  s_add_u32 m0, s12, 55296
  s_nop 0
  buffer_load_dwordx4 v2, s[48:51], s13 offen sc1 lds
  s_add_u32 s13, s13, 3072
  s_add_u32 m0, s12, 58368
  s_nop 0
  buffer_load_dwordx4 v2, s[48:51], s13 offen sc1 lds
  s_add_u32 s13, s13, 3072
  s_add_u32 m0, s12, 61440
  s_nop 0
  buffer_load_dwordx4 v2, s[48:51], s13 offen sc1 lds
  s_add_u32 s13, s13, 3072
  s_add_u32 m0, s12, 64512
  s_nop 0
  buffer_load_dwordx4 v2, s[48:51], s13 offen sc1 lds
  s_add_u32 s13, s13, 3072
  s_add_u32 m0, s12, 67584
  s_nop 0
  buffer_load_dwordx4 v2, s[48:51], s13 offen sc1 lds
  s_add_u32 s13, s13, 3072
  s_add_u32 m0, s12, 70656
  s_nop 0
  buffer_load_dwordx4 v2, s[48:51], s13 offen sc1 lds
  s_add_u32 s13, s13, 3072
  s_add_u32 m0, s12, 73728
  s_nop 0
  buffer_load_dwordx4 v2, s[48:51], s13 offen sc1 lds
  s_add_u32 s13, s13, 3072
  s_add_u32 m0, s12, 76800
  s_nop 0
  buffer_load_dwordx4 v2, s[48:51], s13 offen sc1 lds
  s_add_u32 s13, s13, 3072
  s_cmp_ge_u32 s95, 2
  s_cbranch_scc1 L_bd_179
  s_add_u32 m0, s12, 79872
  s_nop 0
  buffer_load_dwordx4 v2, s[48:51], s13 offen sc1 lds
L_bd_179:
  s_barrier
  s_lshl_b32 s12, s95, 10
  s_add_u32 s13, s12, s84
  s_add_u32 s13, s13, 102400
  s_add_u32 m0, s12, 102400
  s_nop 0
  buffer_load_dwordx4 v2, s[48:51], s13 offen sc1 lds
  s_add_u32 s13, s13, 3072
  s_add_u32 m0, s12, 105472
  s_nop 0
  buffer_load_dwordx4 v2, s[48:51], s13 offen sc1 lds
  s_add_u32 s13, s13, 3072
  s_add_u32 m0, s12, 108544
  s_nop 0
  buffer_load_dwordx4 v2, s[48:51], s13 offen sc1 lds
  s_add_u32 s13, s13, 3072
  s_add_u32 m0, s12, 111616
  s_nop 0
  buffer_load_dwordx4 v2, s[48:51], s13 offen sc1 lds
  s_add_u32 s13, s13, 3072
  s_add_u32 m0, s12, 114688
  s_nop 0
  buffer_load_dwordx4 v2, s[48:51], s13 offen sc1 lds
  s_add_u32 s13, s13, 3072
  s_add_u32 m0, s12, 117760
  s_nop 0
  buffer_load_dwordx4 v2, s[48:51], s13 offen sc1 lds
  s_add_u32 s13, s13, 3072
  s_add_u32 m0, s12, 120832
  s_nop 0
  buffer_load_dwordx4 v2, s[48:51], s13 offen sc1 lds
  s_add_u32 s13, s13, 3072
  s_add_u32 m0, s12, 123904
  s_nop 0
  buffer_load_dwordx4 v2, s[48:51], s13 offen sc1 lds
  s_add_u32 s13, s13, 3072
  s_add_u32 m0, s12, 126976
  s_nop 0
  buffer_load_dwordx4 v2, s[48:51], s13 offen sc1 lds
  s_add_u32 s13, s13, 3072
  s_add_u32 m0, s12, 130048
  s_nop 0
  buffer_load_dwordx4 v2, s[48:51], s13 offen sc1 lds
  s_add_u32 s13, s13, 3072
  s_add_u32 m0, s12, 133120
  s_nop 0
  buffer_load_dwordx4 v2, s[48:51], s13 offen sc1 lds
  s_add_u32 s13, s13, 3072
  s_add_u32 m0, s12, 136192
  s_nop 0
  buffer_load_dwordx4 v2, s[48:51], s13 offen sc1 lds
  s_add_u32 s13, s13, 3072
  s_add_u32 m0, s12, 139264
  s_nop 0
  buffer_load_dwordx4 v2, s[48:51], s13 offen sc1 lds
  s_add_u32 s13, s13, 3072
  s_add_u32 m0, s12, 142336
  s_nop 0
  buffer_load_dwordx4 v2, s[48:51], s13 offen sc1 lds
  s_add_u32 s13, s13, 3072
  s_add_u32 m0, s12, 145408
  s_nop 0
  buffer_load_dwordx4 v2, s[48:51], s13 offen sc1 lds
  s_add_u32 s13, s13, 3072
  s_add_u32 m0, s12, 148480
  s_nop 0
  buffer_load_dwordx4 v2, s[48:51], s13 offen sc1 lds
  s_add_u32 s13, s13, 3072
  s_add_u32 m0, s12, 151552
  s_nop 0
  buffer_load_dwordx4 v2, s[48:51], s13 offen sc1 lds
  s_add_u32 s13, s13, 3072
  s_add_u32 m0, s12, 154624
  s_nop 0
  buffer_load_dwordx4 v2, s[48:51], s13 offen sc1 lds
  s_add_u32 s13, s13, 3072
  s_add_u32 m0, s12, 157696
  s_nop 0
  buffer_load_dwordx4 v2, s[48:51], s13 offen sc1 lds
  s_add_u32 s13, s13, 3072
  s_add_u32 m0, s12, 160768
  s_nop 0
  buffer_load_dwordx4 v2, s[48:51], s13 offen sc1 lds
  s_waitcnt vmcnt(0)
  s_barrier
  s_barrier
  s_lshl_b32 s12, s95, 10
  s_add_u32 s13, s12, s84
  s_add_u32 s13, s13, 163840
  s_add_u32 m0, s12, 81920
  s_nop 0
  buffer_load_dwordx4 v2, s[48:51], s13 offen sc1 lds
  s_add_u32 s13, s13, 3072
  s_add_u32 m0, s12, 84992
  s_nop 0
  buffer_load_dwordx4 v2, s[48:51], s13 offen sc1 lds
  s_add_u32 s13, s13, 3072
  s_add_u32 m0, s12, 88064
  s_nop 0
  buffer_load_dwordx4 v2, s[48:51], s13 offen sc1 lds
  s_add_u32 s13, s13, 3072
  s_add_u32 m0, s12, 91136
  s_nop 0
  buffer_load_dwordx4 v2, s[48:51], s13 offen sc1 lds
  s_add_u32 s13, s13, 3072
  s_add_u32 m0, s12, 94208
  s_nop 0
  buffer_load_dwordx4 v2, s[48:51], s13 offen sc1 lds
  s_add_u32 s13, s13, 3072
  s_add_u32 m0, s12, 97280
  s_nop 0
  buffer_load_dwordx4 v2, s[48:51], s13 offen sc1 lds
  s_add_u32 s13, s13, 3072
  s_cmp_ge_u32 s95, 2
  s_cbranch_scc1 L_bd_180
  s_add_u32 m0, s12, 100352
  s_nop 0
  buffer_load_dwordx4 v2, s[48:51], s13 offen sc1 lds
L_bd_180:
  s_lshl_b32 s12, s95, 10
  s_add_u32 s13, s12, s84
  s_add_u32 s13, s13, 184320
  s_add_u32 m0, s12, 0
  s_nop 0
  buffer_load_dwordx4 v2, s[48:51], s13 offen sc1 lds
  s_add_u32 s13, s13, 3072
  s_add_u32 m0, s12, 3072
  s_nop 0
  buffer_load_dwordx4 v2, s[48:51], s13 offen sc1 lds
  s_add_u32 s13, s13, 3072
  s_add_u32 m0, s12, 6144
  s_nop 0
  buffer_load_dwordx4 v2, s[48:51], s13 offen sc1 lds
  s_add_u32 s13, s13, 3072
  s_add_u32 m0, s12, 9216
  s_nop 0
  buffer_load_dwordx4 v2, s[48:51], s13 offen sc1 lds
  s_add_u32 s13, s13, 3072
  s_add_u32 m0, s12, 12288
  s_nop 0
  buffer_load_dwordx4 v2, s[48:51], s13 offen sc1 lds
  s_add_u32 s13, s13, 3072
  s_add_u32 m0, s12, 15360
  s_nop 0
  buffer_load_dwordx4 v2, s[48:51], s13 offen sc1 lds
  s_add_u32 s13, s13, 3072
  s_add_u32 m0, s12, 18432
  s_nop 0
  buffer_load_dwordx4 v2, s[48:51], s13 offen sc1 lds
  s_add_u32 s13, s13, 3072
  s_add_u32 m0, s12, 21504
  s_nop 0
  buffer_load_dwordx4 v2, s[48:51], s13 offen sc1 lds
  s_add_u32 s13, s13, 3072
  s_add_u32 m0, s12, 24576
  s_nop 0
  buffer_load_dwordx4 v2, s[48:51], s13 offen sc1 lds
  s_add_u32 s13, s13, 3072
  s_add_u32 m0, s12, 27648
  s_nop 0
  buffer_load_dwordx4 v2, s[48:51], s13 offen sc1 lds
  s_add_u32 s13, s13, 3072
  s_add_u32 m0, s12, 30720
  s_nop 0
  buffer_load_dwordx4 v2, s[48:51], s13 offen sc1 lds
  s_add_u32 s13, s13, 3072
  s_add_u32 m0, s12, 33792
  s_nop 0
  buffer_load_dwordx4 v2, s[48:51], s13 offen sc1 lds
  s_add_u32 s13, s13, 3072
  s_add_u32 m0, s12, 36864
  s_nop 0
  buffer_load_dwordx4 v2, s[48:51], s13 offen sc1 lds
  s_add_u32 s13, s13, 3072
  s_add_u32 m0, s12, 39936
  s_nop 0
  buffer_load_dwordx4 v2, s[48:51], s13 offen sc1 lds
  s_add_u32 s13, s13, 3072
  s_add_u32 m0, s12, 43008
  s_nop 0
  buffer_load_dwordx4 v2, s[48:51], s13 offen sc1 lds
  s_add_u32 s13, s13, 3072
  s_add_u32 m0, s12, 46080
  s_nop 0
  buffer_load_dwordx4 v2, s[48:51], s13 offen sc1 lds
  s_add_u32 s13, s13, 3072
  s_add_u32 m0, s12, 49152
  s_nop 0
  buffer_load_dwordx4 v2, s[48:51], s13 offen sc1 lds
  s_add_u32 s13, s13, 3072
  s_add_u32 m0, s12, 52224
  s_nop 0
  buffer_load_dwordx4 v2, s[48:51], s13 offen sc1 lds
  s_add_u32 s13, s13, 3072
  s_add_u32 m0, s12, 55296
  s_nop 0
  buffer_load_dwordx4 v2, s[48:51], s13 offen sc1 lds
  s_add_u32 s13, s13, 3072
  s_add_u32 m0, s12, 58368
  s_nop 0
  buffer_load_dwordx4 v2, s[48:51], s13 offen sc1 lds
  s_waitcnt vmcnt(0)
  s_barrier
  s_barrier
  s_barrier
L_fin:
  s_nop 1
L_end:
  s_endpgm

.section .rodata,"a"
.p2align 6
.amdhsa_kernel sequential_preLN__linear_attn_block__mixer_channel_mlp__prompt_kernel
  .amdhsa_next_free_vgpr 168
  .amdhsa_next_free_sgpr 102
  .amdhsa_accum_offset 168
  .amdhsa_group_segment_fixed_size 0
  .amdhsa_kernarg_size 88
  .amdhsa_user_sgpr_count 2
  .amdhsa_user_sgpr_kernarg_segment_ptr 1
  .amdhsa_system_sgpr_workgroup_id_x 1
.end_amdhsa_kernel
```
